```python
import torch

def _softmax(x, axis=-1):
    return torch.softmax(x, dim=axis)
def _gelu(x):
    return torch.nn.functional.gelu(x, approximate="tanh")
def _silu(x):
    return torch.nn.functional.silu(x)
def _sigmoid(x):
    return torch.sigmoid(x)
def _layernorm(x, axis=-1, eps=1e-5):
    m = x.mean(dim=axis, keepdim=True)
    v = x.var(dim=axis, keepdim=True, unbiased=False)
    return (x - m) / torch.sqrt(v + eps)
def _scatter_add(tgt, idx, src, axis=0):
    return tgt.clone().index_add_(axis, idx, src)
def _segment_sum(src, seg, n):
    out = torch.zeros((n,) + src.shape[1:], dtype=src.dtype)
    return out.index_add_(0, seg, src)
def _pad(x, pw):
    flat = tuple(v for pair in reversed(pw) for v in pair)
    return torch.nn.functional.pad(x, flat)

kernel_name = 'parallel_sum__linear_attn_block__swiglu_ffn__prompt'

def setup_inputs():

    _w = (lambda a: (lambda t: t.to(torch.bfloat16) if t.is_floating_point() else t)(torch.as_tensor(a)))
    def _A_setup():
        B, S, D = 1, 2048, 512
        return {
            "x": _w((lambda *s: torch.randn(*s, dtype=torch.bfloat16) * 0.05)(B, S, D)),
            "wqkv": _w((lambda *s: torch.randn(*s, dtype=torch.bfloat16) * 0.2)(D, 3 * D)),
            "wo": _w((lambda *s: torch.randn(*s, dtype=torch.bfloat16) * 0.2)(D, D)),
        }
    _A_in = _A_setup()

    def _B_setup():
        B, S, D, F = 1, 2048, 512, 1792
        return {
            "x": _w((lambda *s: torch.randn(*s, dtype=torch.bfloat16) * 0.05)(B, S, D)),
            "w_gate": _w((lambda *s: torch.randn(*s, dtype=torch.bfloat16) * 0.05)(D, F)),
            "w_up": _w((lambda *s: torch.randn(*s, dtype=torch.bfloat16) * 0.05)(D, F)),
            "w_down": _w((lambda *s: torch.randn(*s, dtype=torch.bfloat16) * 0.05)(F, D)),
        }
    _B_in = _B_setup()

    return {
        "A_x": _A_in["x"],
        "A_wqkv": _A_in["wqkv"],
        "A_wo": _A_in["wo"],
        "B_x": _B_in["x"],
        "B_w_gate": _B_in["w_gate"],
        "B_w_up": _B_in["w_up"],
        "B_w_down": _B_in["w_down"],
    }

def reference(A_x, A_wqkv, A_wo, B_x, B_w_gate, B_w_up, B_w_down):
    def _A_ref(x, wqkv, wo):
        B, S, D = x.shape
        H = 32; Dh = D // H
        qkv = (lambda x, *d: x.permute(*d))((x @ wqkv).reshape(B, S, 3, H, Dh), 2, 0, 3, 1, 4)
        q, k, v = qkv[0], qkv[1], qkv[2]
        phi = lambda t: torch.where(t > 0, t + 1, torch.exp(t)) + 1e-6
        pq, pk = phi(q), phi(k)
        kv = torch.einsum("bhsd,bhse->bhde", pk, v)
        z = torch.einsum("bhsd->bhd", pk)
        num = torch.einsum("bhqd,bhde->bhqe", pq, kv)
        den = torch.einsum("bhqd,bhd->bhq", pq, z)[..., None] + 1e-6
        o = num / den
        return (lambda x, *d: x.permute(*d))(o, 0, 2, 1, 3).reshape(B, S, D) @ wo

    def _B_ref(x, w_gate, w_up, w_down):
        g = _silu(x @ w_gate)
        u = x @ w_up
        return (g * u) @ w_down

    x = A_x
    xn = _layernorm(x, axis=-1)
    return x + _A_ref(xn, A_wqkv, A_wo) + _B_ref(xn, B_w_gate, B_w_up, B_w_down)
```

```asm
; @launch grid=(256,1,1) block=(256,1,1) lds=163840
.amdgcn_target "amdgcn-amd-amdhsa--gfx950"
.text
.globl parallel_sum__linear_attn_block__swiglu_ffn__prompt_kernel
.p2align 8
.type parallel_sum__linear_attn_block__swiglu_ffn__prompt_kernel,@function
parallel_sum__linear_attn_block__swiglu_ffn__prompt_kernel:
    s_cmp_ge_u32 s2, 256
    s_cbranch_scc1 L_end
    s_load_dwordx2 s[24:25], s[0:1], 0
    s_load_dwordx4 s[8:11], s[0:1], 8
    s_load_dwordx8 s[12:19], s[0:1], 48
    v_lshrrev_b32 v81, 6, v0
    s_getpc_b64 s[96:97]
L_pc:
    s_lshr_b32 s3, s2, 3
    s_mul_i32 s3, s3, 2560
    v_lshl_add_u32 v80, v0, 7, s3
    v_min_u32 v80, L_end-L_pc, v80
    v_cmp_gt_u32 vcc, 20, v0
    v_readfirstlane_b32 s56, v81
    s_and_saveexec_b64 s[98:99], vcc
    s_cbranch_execz L_nopf
    global_load_dword v100, v80, s[96:97]
L_nopf:
    s_mov_b64 exec, -1
    s_lshr_b32 s61, s56, 1
    s_lshl_b32 s72, s61, 3
    s_add_u32 s72, s72, 32
    s_load_dwordx2 s[28:29], s[0:1], s72
    v_and_b32_e64 v81, 63, v0
    s_and_b32 s74, s2, 1
    s_lshl_b32 s57, s74, 3
    s_bfe_u32 s73, s2, 0x30003
    s_add_u32 s57, s57, s73
    s_and_b32 s64, s2, 6
    s_lshr_b32 s73, s2, 7
    s_add_u32 s58, s64, s73
    s_lshl_b32 s74, s74, 2
    s_xor_b32 s64, s64, s74
    s_lshl_b32 s60, s61, 16
    s_and_b32 s75, s56, 1
    s_lshl_b32 s73, s75, 12
    s_add_u32 s60, s60, s73
    v_and_b32 v82, 7, v81
    v_lshrrev_b32 v83, 3, v81
    v_lshrrev_b32 v84, 4, v81
    v_xor_b32 v89, v82, v84
    v_lshlrev_b32_e64 v89, 4, v89
    v_lshl_add_u32 v64, v83, 10, v89
    v_xor_b32_e64 v65, 64, v64
    v_add_u32 v65, 7168, v65
    v_add_u32 v66, 14336, v64
    v_add_u32 v67, 14336, v65
    s_lshl_b32 s63, s57, 2
    s_add_u32 s63, s63, s56
    s_lshl_b32 s62, s63, 8
    s_add_u32 s62, s62, s64
    s_lshl_b32 s62, s62, 7
    s_mov_b32 s26, 2097152
    s_mov_b32 s27, 0x20000
    s_mov_b32 m0, s60
    v_lshlrev_b32 v1, 4, v81
    v_and_b32 v89, 15, v81
    v_bfe_u32 v94, v81, 1, 3
    v_xor_b32 v94, v94, v84
    v_lshlrev_b32 v94, 4, v94
    v_lshl_add_u32 v94, v89, 7, v94
    v_add_u32 v68, s60, v94
    v_xor_b32 v69, 64, v68
    v_mov_b32 v70, 0
    v_mov_b32 v71, 0
    v_mov_b32 v72, 0
    v_mov_b32 v73, 0
    v_mov_b32 v76, 0x3f803f80
    s_mov_b32 s38, 268435456
    s_mov_b32 s39, 0x20000
    s_mov_b32 s30, 1835008
    s_mov_b32 s31, 0x20000
    s_mov_b32 s34, 1572864
    s_mov_b32 s35, 0x20000
    s_mov_b32 s46, 1835008
    s_mov_b32 s47, 0x20000
    s_mov_b32 s50, 524288
    s_mov_b32 s51, 0x20000
    s_mov_b32 s42, 256
    s_mov_b32 s43, 0x20000
    s_mov_b32 s54, 2097152
    s_mov_b32 s55, 0x20000
    s_bfe_u32 s59, s2, 0x10006
    s_mov_b32 s3, 1
    s_mov_b32 s4, s64
    s_waitcnt lgkmcnt(0)
    buffer_load_dwordx4 v64, s[24:27], s62 offen offset:0 lds
    s_mov_b64 s[36:37], s[18:19]
    s_mov_b64 s[32:33], s[8:9]
    s_mov_b64 s[48:49], s[10:11]
    s_mov_b64 s[44:45], s[12:13]
    buffer_load_dwordx4 v65, s[24:27], s62 offen offset:1024 lds
    s_mov_b64 s[52:53], s[14:15]
    s_mov_b64 s[40:41], s[16:17]
    s_lshl_b32 s73, s56, 8
    s_add_u32 s98, s73, s2
    buffer_load_dwordx4 v66, s[24:27], s62 offen offset:2048 lds
    s_lshl_b32 s72, s2, 13
    s_add_u32 s72, s72, 12582912
    s_cmp_lt_u32 s98, 9
    s_cselect_b32 s72, s72, 1073741824
    v_lshlrev_b32 v41, 7, v81
    v_add_u32 v79, s72, v41
    v_mov_b32_e64 v78, 0
    s_lshl_b32 s72, s2, 1
    s_add_u32 s73, s72, s75
    s_mul_i32 s80, s73, 3584
    s_add_u32 s73, s72, s61
    buffer_load_dwordx4 v67, s[24:27], s62 offen offset:3072 lds
    s_add_u32 s62, s62, 128
    s_bitset0_b32 s62, 10
    s_add_u32 m0, s60, 8192
    s_mul_i32 s97, s73, 3072
    s_mul_i32 s73, s75, 512
    s_add_u32 s97, s97, s73
    v_and_b32 v85, 1, v84
    v_lshrrev_b32 v86, 1, v82
    v_and_b32 v87, 16, v1
    v_lshrrev_b32 v90, 5, v81
    s_lshl_b32 s72, s75, 5
    v_add_u32 v88, s72, v83
    v_xor_b32 v89, v86, v85
    v_lshl_add_u32 v89, v89, 5, v87
    v_mul_u32_u24 v2, 3584, v88
    v_add_u32_e64 v2, v2, v89
    buffer_load_dwordx4 v64, s[24:27], s62 offen offset:0 lds
    v_mul_u32_u24 v6, 3072, v88
    v_add_u32 v6, v6, v89
    v_xor_b32 v89, v86, v84
    v_lshl_add_u32 v89, v89, 5, v87
    v_lshl_add_u32 v14, v83, 10, v89
    v_add_u32 v15, 7168, v14
    v_add_u32 v16, 14336, v14
    v_add_u32 v17, 21504, v14
    v_bfe_u32 v91, v81, 2, 2
    v_and_b32_e64 v92, 3, v81
    buffer_load_dwordx4 v65, s[24:27], s62 offen offset:1024 lds
    v_lshlrev_b32 v92, 3, v92
    v_lshrrev_b32 v93, 1, v91
    v_lshl_or_b32 v89, v85, 1, v93
    v_lshl_add_u32 v89, v89, 5, v92
    v_lshl_add_u32 v88, v84, 3, v91
    v_lshl_add_u32 v18, v88, 7, v89
    v_xor_b32 v19, 32, v18
    v_xor_b32 v20, 64, v18
    v_xor_b32 v21, 96, v18
    v_add_u32 v22, 65536, v18
    v_add_u32 v23, 65536, v19
    v_add_u32 v24, 65536, v20
    v_add_u32 v25, 65536, v21
    v_lshl_add_u32 v94, v84, 2, v91
    v_lshl_add_u32 v89, v94, 7, v89
    v_add_u32_e64 v30, s60, v89
    buffer_load_dwordx4 v66, s[24:27], s62 offen offset:2048 lds
    v_xor_b32 v31, 32, v30
    v_xor_b32 v32, 64, v30
    v_xor_b32 v33, 96, v30
    v_mov_b32 v89, 0x3f80
    v_lshlrev_b32 v89, v87, v89
    v_and_b32 v94, 2, v81
    v_cmp_eq_u32 vcc, 0, v94
    v_mov_b32 v94, 0
    s_nop 0
    v_cndmask_b32 v42, v94, v89, vcc
    v_cndmask_b32 v43, v89, v94, vcc
    s_lshl_b32 s99, s56, 13
    s_add_u32 s99, s99, 131072
    buffer_load_dwordx4 v67, s[24:27], s62 offen offset:3072 lds
    buffer_store_dword v78, v79, s[36:39], 0 offen sc1
    s_mov_b64 exec, 0x8000080
    buffer_load_dword v55, v41, s[28:31], s80 offen sc0 sc1
    s_mov_b64 exec, -1
    s_mov_b64 exec, 0x8800
    buffer_load_dword v55, v41, s[32:35], s97 offen sc0 sc1
    s_mov_b64 exec, -1
    s_add_u32 s62, s62, 128
    s_bitset0_b32 s62, 10
    s_add_u32 m0, s60, 16384
    s_nop 0
    buffer_load_dwordx4 v64, s[24:27], s62 offen offset:0 lds
    s_mov_b64 exec, 0
    s_cmp_eq_u32 s59, 0
    s_cbranch_scc0 L_padselB
    s_cmp_eq_u32 s56, 0
    s_cbranch_scc1 L_padA0
    s_cmp_eq_u32 s56, 1
    s_cbranch_scc1 L_padA1
    s_cmp_eq_u32 s56, 2
    s_cbranch_scc1 L_padA2
    s_branch L_padA3
L_padselB:
    s_cmp_eq_u32 s56, 0
    s_cbranch_scc1 L_padB0
    s_cmp_eq_u32 s56, 1
    s_cbranch_scc1 L_padB1
    s_cmp_eq_u32 s56, 2
    s_cbranch_scc1 L_padB2
    s_branch L_padB3
L_padret:
    s_mov_b64 exec, -1
    buffer_load_dwordx4 v65, s[24:27], s62 offen offset:1024 lds
    buffer_load_dwordx4 v66, s[24:27], s62 offen offset:2048 lds
    buffer_load_dwordx4 v67, s[24:27], s62 offen offset:3072 lds
    s_add_u32 s62, s62, 128
    s_bitset0_b32 s62, 10
    s_add_u32 m0, s60, 24576
    s_waitcnt vmcnt(11)
    ds_read_b128 v[128:131], v68 offset:0
    ds_read_b128 v[132:135], v68 offset:2048
    ds_read_b128 v[136:139], v69 offset:0
    ds_read_b128 v[140:143], v69 offset:2048
    buffer_load_dwordx4 v64, s[24:27], s62 offen offset:0 lds
    s_waitcnt lgkmcnt(2)
    buffer_load_dwordx4 v65, s[24:27], s62 offen offset:1024 lds
    v_dot2c_f32_bf16 v70, v128, v76
    v_dot2c_f32_bf16 v72, v128, v128
    v_dot2c_f32_bf16 v70, v129, v76
    v_dot2c_f32_bf16 v72, v129, v129
    v_dot2c_f32_bf16 v70, v130, v76
    v_dot2c_f32_bf16 v72, v130, v130
    v_dot2c_f32_bf16 v70, v131, v76
    v_dot2c_f32_bf16 v72, v131, v131
    v_dot2c_f32_bf16 v71, v132, v76
    v_dot2c_f32_bf16 v73, v132, v132
    v_dot2c_f32_bf16 v71, v133, v76
    v_dot2c_f32_bf16 v73, v133, v133
    v_dot2c_f32_bf16 v71, v134, v76
    v_dot2c_f32_bf16 v73, v134, v134
    v_dot2c_f32_bf16 v71, v135, v76
    v_dot2c_f32_bf16 v73, v135, v135
    s_waitcnt lgkmcnt(0)
    buffer_load_dwordx4 v66, s[24:27], s62 offen offset:2048 lds
    v_dot2c_f32_bf16 v70, v136, v76
    v_dot2c_f32_bf16 v72, v136, v136
    v_dot2c_f32_bf16 v70, v137, v76
    v_dot2c_f32_bf16 v72, v137, v137
    v_dot2c_f32_bf16 v70, v138, v76
    v_dot2c_f32_bf16 v72, v138, v138
    v_dot2c_f32_bf16 v70, v139, v76
    v_dot2c_f32_bf16 v72, v139, v139
    v_dot2c_f32_bf16 v71, v140, v76
    v_dot2c_f32_bf16 v73, v140, v140
    buffer_load_dwordx4 v67, s[24:27], s62 offen offset:3072 lds
    s_add_u32 s62, s62, 128
    s_bitset0_b32 s62, 10
    s_add_u32 m0, s60, 32768
    v_dot2c_f32_bf16 v71, v141, v76
    v_dot2c_f32_bf16 v73, v141, v141
    v_dot2c_f32_bf16 v71, v142, v76
    v_dot2c_f32_bf16 v73, v142, v142
    v_dot2c_f32_bf16 v71, v143, v76
    v_dot2c_f32_bf16 v73, v143, v143
    s_waitcnt vmcnt(11)
    buffer_load_dwordx4 v64, s[24:27], s62 offen offset:0 lds
    ds_read_b128 v[144:147], v68 offset:8192
    ds_read_b128 v[148:151], v68 offset:10240
    ds_read_b128 v[152:155], v69 offset:8192
    ds_read_b128 v[156:159], v69 offset:10240
    buffer_load_dwordx4 v65, s[24:27], s62 offen offset:1024 lds
    s_waitcnt lgkmcnt(2)
    v_dot2c_f32_bf16 v70, v144, v76
    v_dot2c_f32_bf16 v72, v144, v144
    v_dot2c_f32_bf16 v70, v145, v76
    v_dot2c_f32_bf16 v72, v145, v145
    v_dot2c_f32_bf16 v70, v146, v76
    v_dot2c_f32_bf16 v72, v146, v146
    buffer_load_dwordx4 v66, s[24:27], s62 offen offset:2048 lds
    v_dot2c_f32_bf16 v70, v147, v76
    v_dot2c_f32_bf16 v72, v147, v147
    v_dot2c_f32_bf16 v71, v148, v76
    v_dot2c_f32_bf16 v73, v148, v148
    v_dot2c_f32_bf16 v71, v149, v76
    v_dot2c_f32_bf16 v73, v149, v149
    v_dot2c_f32_bf16 v71, v150, v76
    v_dot2c_f32_bf16 v73, v150, v150
    v_dot2c_f32_bf16 v71, v151, v76
    v_dot2c_f32_bf16 v73, v151, v151
    s_waitcnt lgkmcnt(0)
    v_dot2c_f32_bf16 v70, v152, v76
    v_dot2c_f32_bf16 v72, v152, v152
    v_dot2c_f32_bf16 v70, v153, v76
    v_dot2c_f32_bf16 v72, v153, v153
    v_dot2c_f32_bf16 v70, v154, v76
    v_dot2c_f32_bf16 v72, v154, v154
    buffer_load_dwordx4 v67, s[24:27], s62 offen offset:3072 lds
    s_add_u32 s62, s62, 128
    s_bitset0_b32 s62, 10
    s_add_u32 m0, s60, 40960
    v_dot2c_f32_bf16 v70, v155, v76
    s_cmp_eq_u32 s59, 0
    s_cbranch_scc0 L_typeB
    s_branch L_typeA
    .p2align 12
L_typeA:
L_padA0:
    s_cbranch_execz L_padA4
    s_mul_i32 s72, s58, 7
    s_bitcmp0_b32 s58, 0
    s_cselect_b32 s73, 0, 5
    s_cselect_b32 s18, 1, -1
    s_lshl_b32 s18, s18, 7
    s_add_u32 s66, s72, s73
    s_lshl_b32 s74, s66, 6
    v_add_u32_e64 v2, s74, v2
    buffer_load_dwordx4 v64, s[24:27], s62 offen offset:0 lds
    v_xor_b32_e64 v3, 64, v2
    v_add_u32 v3, 27648, v3
    v_add_u32 v4, 55296, v2
    v_add_u32 v5, 55296, v3
    s_mul_i32 s74, s61, 196608
    s_lshl_b32 s73, s58, 7
    s_add_u32 s74, s74, s73
    v_add_u32 v6, s74, v6
    v_xor_b32 v7, 64, v6
    v_add_u32 v7, 23552, v7
    v_add_u32 v8, 47104, v6
    v_add_u32 v9, 47104, v7
    v_add_u32_e64 v52, s99, v1
    v_add_u32 v53, 131072, v1
    v_lshlrev_b32 v39, 3, v81
    v_and_b32_e64 v89, 15, v81
    s_waitcnt vmcnt(9)
    buffer_load_dwordx4 v65, s[24:27], s62 offen offset:1024 lds
    ds_read_b128 v[160:163], v68 offset:16384
    ds_read_b128 v[164:167], v68 offset:18432
    ds_read_b128 v[168:171], v69 offset:16384
    ds_read_b128 v[172:175], v69 offset:18432
    v_mul_u32_u24 v89, 1024, v89
    v_lshl_add_u32 v54, v84, 3, v89
    v_add_u32 v89, 20971648, v1
    v_cmp_eq_u32 vcc, 3, v83
    s_nop 1
    v_cndmask_b32 v1, v1, v89, vcc
    v_dot2c_f32_bf16 v72, v155, v155
    v_dot2c_f32_bf16 v71, v156, v76
    v_dot2c_f32_bf16 v73, v156, v156
    v_dot2c_f32_bf16 v71, v157, v76
    v_dot2c_f32_bf16 v73, v157, v157
    v_dot2c_f32_bf16 v71, v158, v76
    v_dot2c_f32_bf16 v73, v158, v158
    buffer_load_dwordx4 v66, s[24:27], s62 offen offset:2048 lds
    v_dot2c_f32_bf16 v71, v159, v76
    v_dot2c_f32_bf16 v73, v159, v159
    s_waitcnt lgkmcnt(2)
    buffer_load_dwordx4 v67, s[24:27], s62 offen offset:3072 lds
    s_add_u32 s62, s62, 128
    s_bitset0_b32 s62, 10
    s_add_u32 m0, s60, 49152
    v_dot2c_f32_bf16 v70, v160, v76
    v_dot2c_f32_bf16 v72, v160, v160
    v_dot2c_f32_bf16 v70, v161, v76
    v_dot2c_f32_bf16 v72, v161, v161
    v_dot2c_f32_bf16 v70, v162, v76
    v_dot2c_f32_bf16 v72, v162, v162
    v_dot2c_f32_bf16 v70, v163, v76
    v_dot2c_f32_bf16 v72, v163, v163
    v_dot2c_f32_bf16 v71, v164, v76
    v_dot2c_f32_bf16 v73, v164, v164
    v_dot2c_f32_bf16 v71, v165, v76
    v_dot2c_f32_bf16 v73, v165, v165
    v_dot2c_f32_bf16 v71, v166, v76
    buffer_load_dwordx4 v64, s[24:27], s62 offen offset:0 lds
    v_dot2c_f32_bf16 v73, v166, v166
    v_dot2c_f32_bf16 v71, v167, v76
    v_dot2c_f32_bf16 v73, v167, v167
    s_waitcnt lgkmcnt(0)
    v_dot2c_f32_bf16 v70, v168, v76
    v_dot2c_f32_bf16 v72, v168, v168
    v_dot2c_f32_bf16 v70, v169, v76
    v_dot2c_f32_bf16 v72, v169, v169
    v_dot2c_f32_bf16 v70, v170, v76
    v_dot2c_f32_bf16 v72, v170, v170
    v_dot2c_f32_bf16 v70, v171, v76
    v_dot2c_f32_bf16 v72, v171, v171
    v_dot2c_f32_bf16 v71, v172, v76
    v_dot2c_f32_bf16 v73, v172, v172
    v_dot2c_f32_bf16 v71, v173, v76
    v_dot2c_f32_bf16 v73, v173, v173
    s_waitcnt vmcnt(9)
    buffer_load_dwordx4 v65, s[24:27], s62 offen offset:1024 lds
    ds_read_b128 v[176:179], v68 offset:24576
    ds_read_b128 v[180:183], v68 offset:26624
    ds_read_b128 v[184:187], v69 offset:24576
    ds_read_b128 v[188:191], v69 offset:26624
    v_dot2c_f32_bf16 v71, v174, v76
    v_dot2c_f32_bf16 v73, v174, v174
    v_dot2c_f32_bf16 v71, v175, v76
    v_dot2c_f32_bf16 v73, v175, v175
    buffer_load_dwordx4 v66, s[24:27], s62 offen offset:2048 lds
    s_waitcnt lgkmcnt(2)
    v_dot2c_f32_bf16 v70, v176, v76
    v_dot2c_f32_bf16 v72, v176, v176
    v_dot2c_f32_bf16 v70, v177, v76
    v_dot2c_f32_bf16 v72, v177, v177
    v_dot2c_f32_bf16 v70, v178, v76
    v_dot2c_f32_bf16 v72, v178, v178
    buffer_load_dwordx4 v67, s[24:27], s62 offen offset:3072 lds
    s_add_u32 s62, s62, 128
    s_bitset0_b32 s62, 10
    s_add_u32 m0, s60, 57344
    v_dot2c_f32_bf16 v70, v179, v76
    v_dot2c_f32_bf16 v72, v179, v179
    v_dot2c_f32_bf16 v71, v180, v76
    v_dot2c_f32_bf16 v73, v180, v180
    v_dot2c_f32_bf16 v71, v181, v76
    v_dot2c_f32_bf16 v73, v181, v181
    v_dot2c_f32_bf16 v71, v182, v76
    v_dot2c_f32_bf16 v73, v182, v182
    v_dot2c_f32_bf16 v71, v183, v76
    v_dot2c_f32_bf16 v73, v183, v183
    s_waitcnt lgkmcnt(0)
    v_dot2c_f32_bf16 v70, v184, v76
    v_dot2c_f32_bf16 v72, v184, v184
    v_dot2c_f32_bf16 v70, v185, v76
    v_dot2c_f32_bf16 v72, v185, v185
    v_dot2c_f32_bf16 v70, v186, v76
    v_dot2c_f32_bf16 v72, v186, v186
    buffer_load_dwordx4 v64, s[24:27], s62 offen offset:0 lds
    v_dot2c_f32_bf16 v70, v187, v76
    v_dot2c_f32_bf16 v72, v187, v187
    v_dot2c_f32_bf16 v71, v188, v76
    v_dot2c_f32_bf16 v73, v188, v188
    v_dot2c_f32_bf16 v71, v189, v76
    v_dot2c_f32_bf16 v73, v189, v189
    v_dot2c_f32_bf16 v71, v190, v76
    v_dot2c_f32_bf16 v73, v190, v190
    v_dot2c_f32_bf16 v71, v191, v76
    v_dot2c_f32_bf16 v73, v191, v191
    s_waitcnt vmcnt(9)
    buffer_load_dwordx4 v65, s[24:27], s62 offen offset:1024 lds
    ds_read_b128 v[192:195], v68 offset:32768
    ds_read_b128 v[196:199], v68 offset:34816
    ds_read_b128 v[200:203], v69 offset:32768
    ds_read_b128 v[204:207], v69 offset:34816
    buffer_load_dwordx4 v66, s[24:27], s62 offen offset:2048 lds
    s_waitcnt lgkmcnt(2)
    v_dot2c_f32_bf16 v70, v192, v76
    v_dot2c_f32_bf16 v72, v192, v192
    v_dot2c_f32_bf16 v70, v193, v76
    v_dot2c_f32_bf16 v72, v193, v193
    v_dot2c_f32_bf16 v70, v194, v76
    v_dot2c_f32_bf16 v72, v194, v194
    buffer_load_dwordx4 v67, s[24:27], s62 offen offset:3072 lds
    s_mul_i32 s5, s4, 229376
    v_dot2c_f32_bf16 v70, v195, v76
    v_dot2c_f32_bf16 v72, v195, v195
    v_dot2c_f32_bf16 v71, v196, v76
    s_mov_b32 m0, s60
    v_dot2c_f32_bf16 v73, v196, v196
    v_dot2c_f32_bf16 v71, v197, v76
    v_dot2c_f32_bf16 v73, v197, v197
    v_dot2c_f32_bf16 v71, v198, v76
    v_dot2c_f32_bf16 v73, v198, v198
    v_dot2c_f32_bf16 v71, v199, v76
    v_dot2c_f32_bf16 v73, v199, v199
    s_waitcnt lgkmcnt(0)
    buffer_load_dwordx4 v2, s[28:31], s5 offen offset:0 lds
    v_dot2c_f32_bf16 v70, v200, v76
    v_dot2c_f32_bf16 v72, v200, v200
    v_dot2c_f32_bf16 v70, v201, v76
    v_dot2c_f32_bf16 v72, v201, v201
    v_dot2c_f32_bf16 v70, v202, v76
    v_dot2c_f32_bf16 v72, v202, v202
    v_dot2c_f32_bf16 v70, v203, v76
    v_dot2c_f32_bf16 v72, v203, v203
    v_dot2c_f32_bf16 v71, v204, v76
    v_dot2c_f32_bf16 v73, v204, v204
    v_dot2c_f32_bf16 v71, v205, v76
    v_dot2c_f32_bf16 v73, v205, v205
    v_dot2c_f32_bf16 v71, v206, v76
    v_dot2c_f32_bf16 v73, v206, v206
    v_dot2c_f32_bf16 v71, v207, v76
    v_dot2c_f32_bf16 v73, v207, v207
    s_waitcnt vmcnt(9)
    buffer_load_dwordx4 v3, s[28:31], s5 offen offset:1024 lds
    ds_read_b128 v[208:211], v68 offset:40960
    ds_read_b128 v[212:215], v68 offset:43008
    ds_read_b128 v[216:219], v69 offset:40960
    ds_read_b128 v[220:223], v69 offset:43008
    s_cmp_lt_u32 s98, 9
    s_cbranch_scc0 L_noinitA
    s_atomic_add s3, s[40:41], 0
L_noinitA:
    buffer_load_dwordx4 v4, s[28:31], s5 offen offset:2048 lds
    s_waitcnt lgkmcnt(2)
    v_dot2c_f32_bf16 v70, v208, v76
    v_dot2c_f32_bf16 v72, v208, v208
    v_dot2c_f32_bf16 v70, v209, v76
    v_dot2c_f32_bf16 v72, v209, v209
    v_dot2c_f32_bf16 v70, v210, v76
    v_dot2c_f32_bf16 v72, v210, v210
    buffer_load_dwordx4 v5, s[28:31], s5 offen offset:3072 lds
    s_add_u32 s4, s4, 1
    s_and_b32 s4, s4, 7
    s_mul_i32 s5, s4, 229376
    v_dot2c_f32_bf16 v70, v211, v76
    s_add_u32 m0, s60, 8192
    v_dot2c_f32_bf16 v72, v211, v211
    v_dot2c_f32_bf16 v71, v212, v76
    v_dot2c_f32_bf16 v73, v212, v212
    v_dot2c_f32_bf16 v71, v213, v76
    v_dot2c_f32_bf16 v73, v213, v213
    v_dot2c_f32_bf16 v71, v214, v76
    v_dot2c_f32_bf16 v73, v214, v214
    v_dot2c_f32_bf16 v71, v215, v76
    v_dot2c_f32_bf16 v73, v215, v215
    ds_read_b32 v55, v30
    s_waitcnt lgkmcnt(1)
    buffer_load_dwordx4 v2, s[28:31], s5 offen offset:0 lds
    v_dot2c_f32_bf16 v70, v216, v76
    v_dot2c_f32_bf16 v72, v216, v216
    v_dot2c_f32_bf16 v70, v217, v76
    v_dot2c_f32_bf16 v72, v217, v217
    v_dot2c_f32_bf16 v70, v218, v76
    v_dot2c_f32_bf16 v72, v218, v218
    v_dot2c_f32_bf16 v70, v219, v76
    v_dot2c_f32_bf16 v72, v219, v219
    v_dot2c_f32_bf16 v71, v220, v76
    v_dot2c_f32_bf16 v73, v220, v220
    v_dot2c_f32_bf16 v71, v221, v76
    v_dot2c_f32_bf16 v73, v221, v221
    v_dot2c_f32_bf16 v71, v222, v76
    v_dot2c_f32_bf16 v73, v222, v222
    v_dot2c_f32_bf16 v71, v223, v76
    v_dot2c_f32_bf16 v73, v223, v223
    s_waitcnt vmcnt(9)
    buffer_load_dwordx4 v3, s[28:31], s5 offen offset:1024 lds
    ds_read_b128 v[224:227], v68 offset:49152
    ds_read_b128 v[228:231], v68 offset:51200
    ds_read_b128 v[232:235], v69 offset:49152
    ds_read_b128 v[236:239], v69 offset:51200
    buffer_load_dwordx4 v4, s[28:31], s5 offen offset:2048 lds
    s_waitcnt lgkmcnt(2)
    v_dot2c_f32_bf16 v70, v224, v76
    v_dot2c_f32_bf16 v72, v224, v224
    v_dot2c_f32_bf16 v70, v225, v76
    v_dot2c_f32_bf16 v72, v225, v225
    v_dot2c_f32_bf16 v70, v226, v76
    v_dot2c_f32_bf16 v72, v226, v226
    buffer_load_dwordx4 v5, s[28:31], s5 offen offset:3072 lds
    s_add_u32 s4, s4, 1
    s_and_b32 s4, s4, 7
    s_mul_i32 s5, s4, 229376
    v_dot2c_f32_bf16 v70, v227, v76
    s_add_u32 m0, s60, 16384
    v_dot2c_f32_bf16 v72, v227, v227
    v_dot2c_f32_bf16 v71, v228, v76
    v_dot2c_f32_bf16 v73, v228, v228
    v_dot2c_f32_bf16 v71, v229, v76
    v_dot2c_f32_bf16 v73, v229, v229
    v_dot2c_f32_bf16 v71, v230, v76
    v_dot2c_f32_bf16 v73, v230, v230
    v_dot2c_f32_bf16 v71, v231, v76
    v_dot2c_f32_bf16 v73, v231, v231
    ds_read_b32 v55, v30
    s_waitcnt lgkmcnt(1)
    buffer_load_dwordx4 v2, s[28:31], s5 offen offset:0 lds
    v_dot2c_f32_bf16 v70, v232, v76
    v_dot2c_f32_bf16 v72, v232, v232
    v_dot2c_f32_bf16 v70, v233, v76
    v_dot2c_f32_bf16 v72, v233, v233
    v_dot2c_f32_bf16 v70, v234, v76
    v_dot2c_f32_bf16 v72, v234, v234
    v_dot2c_f32_bf16 v70, v235, v76
    v_dot2c_f32_bf16 v72, v235, v235
    v_dot2c_f32_bf16 v71, v236, v76
    v_dot2c_f32_bf16 v73, v236, v236
    v_dot2c_f32_bf16 v71, v237, v76
    v_dot2c_f32_bf16 v73, v237, v237
    v_dot2c_f32_bf16 v71, v238, v76
    v_dot2c_f32_bf16 v73, v238, v238
    v_dot2c_f32_bf16 v71, v239, v76
    v_dot2c_f32_bf16 v73, v239, v239
    s_waitcnt vmcnt(9)
    buffer_load_dwordx4 v3, s[28:31], s5 offen offset:1024 lds
    ds_read_b128 v[240:243], v68 offset:57344
    ds_read_b128 v[244:247], v68 offset:59392
    ds_read_b128 v[248:251], v69 offset:57344
    ds_read_b128 v[252:255], v69 offset:59392
    buffer_load_dwordx4 v4, s[28:31], s5 offen offset:2048 lds
    s_waitcnt lgkmcnt(2)
    v_dot2c_f32_bf16 v70, v240, v76
    v_dot2c_f32_bf16 v72, v240, v240
    v_dot2c_f32_bf16 v70, v241, v76
    v_dot2c_f32_bf16 v72, v241, v241
    v_dot2c_f32_bf16 v70, v242, v76
    v_dot2c_f32_bf16 v72, v242, v242
    buffer_load_dwordx4 v5, s[28:31], s5 offen offset:3072 lds
    s_add_u32 s4, s4, 1
    s_and_b32 s4, s4, 7
    s_mul_i32 s5, s4, 229376
    v_dot2c_f32_bf16 v70, v243, v76
    s_add_u32 m0, s60, 24576
    v_dot2c_f32_bf16 v72, v243, v243
    v_dot2c_f32_bf16 v71, v244, v76
    v_dot2c_f32_bf16 v73, v244, v244
    v_dot2c_f32_bf16 v71, v245, v76
    v_dot2c_f32_bf16 v73, v245, v245
    v_dot2c_f32_bf16 v71, v246, v76
    v_dot2c_f32_bf16 v73, v246, v246
    v_dot2c_f32_bf16 v71, v247, v76
    v_dot2c_f32_bf16 v73, v247, v247
    ds_read_b32 v55, v30
    s_waitcnt lgkmcnt(1)
    buffer_load_dwordx4 v2, s[28:31], s5 offen offset:0 lds
    v_dot2c_f32_bf16 v70, v248, v76
    v_dot2c_f32_bf16 v72, v248, v248
    v_dot2c_f32_bf16 v70, v249, v76
    v_dot2c_f32_bf16 v72, v249, v249
    v_dot2c_f32_bf16 v70, v250, v76
    v_dot2c_f32_bf16 v72, v250, v250
    v_dot2c_f32_bf16 v70, v251, v76
    v_dot2c_f32_bf16 v72, v251, v251
    v_dot2c_f32_bf16 v71, v252, v76
    v_dot2c_f32_bf16 v73, v252, v252
    v_dot2c_f32_bf16 v71, v253, v76
    v_dot2c_f32_bf16 v73, v253, v253
    v_dot2c_f32_bf16 v71, v254, v76
    v_dot2c_f32_bf16 v73, v254, v254
    v_dot2c_f32_bf16 v71, v255, v76
    v_dot2c_f32_bf16 v73, v255, v255
    v_mov_b32 v80, v70
    s_nop 0
    v_mov_b32 v81, v71
    v_mov_b32 v82, v72
    v_mov_b32 v83, v73
    v_permlane32_swap_b32 v70, v80
    v_permlane32_swap_b32 v71, v81
    v_permlane32_swap_b32 v72, v82
    v_permlane32_swap_b32 v73, v83
    v_add_f32 v70, v70, v80
    v_add_f32 v71, v71, v81
    v_add_f32 v72, v72, v82
    v_add_f32 v73, v73, v83
    v_mov_b32 v80, v70
    v_mov_b32 v81, v71
    v_mov_b32 v82, v72
    v_mov_b32 v83, v73
    v_permlane16_swap_b32 v70, v80
    v_permlane16_swap_b32 v71, v81
    v_permlane16_swap_b32 v72, v82
    v_permlane16_swap_b32 v73, v83
    v_add_f32 v70, v70, v80
    v_add_f32 v71, v71, v81
    v_add_f32 v72, v72, v82
    v_add_f32_e64 v73, v73, v83
    v_mul_f32 v34, 0xbb000000, v70
    v_mul_f32 v35, 0xbb000000, v71
    v_cvt_pk_bf16_f32 v80, v34, v35
    v_lshlrev_b32 v44, 16, v80
    v_lshlrev_b32 v45, 16, v80
    v_lshlrev_b32 v46, 16, v80
    v_lshlrev_b32 v47, 16, v80
    v_and_b32 v48, 0xffff0000, v80
    v_and_b32 v49, 0xffff0000, v80
    v_and_b32 v50, 0xffff0000, v80
    v_and_b32 v51, 0xffff0000, v80
    v_mul_f32 v36, 0x3b000000, v72
    v_mul_f32 v37, 0x3b000000, v73
    v_mfma_f32_4x4x4_16b_bf16 v[112:115], v[42:43], v[128:129], v[44:47]
    v_mfma_f32_4x4x4_16b_bf16 v[116:119], v[42:43], v[130:131], v[44:47]
    v_mfma_f32_4x4x4_16b_bf16 v[120:123], v[42:43], v[132:133], v[48:51]
    v_mfma_f32_4x4x4_16b_bf16 v[124:127], v[42:43], v[134:135], v[48:51]
    v_mfma_f32_4x4x4_16b_bf16 v[56:59], v[42:43], v[136:137], v[44:47]
    v_mfma_f32_4x4x4_16b_bf16 v[60:63], v[42:43], v[138:139], v[44:47]
    s_waitcnt vmcnt(9)
    s_barrier
    ds_read_b64_tr_b16 a[64:65], v18 offset:0
    ds_read_b64_tr_b16 a[66:67], v18 offset:512
    ds_read_b64_tr_b16 a[68:69], v19 offset:0
    ds_read_b64_tr_b16 a[70:71], v19 offset:512
    ds_read_b64_tr_b16 a[72:73], v22 offset:0
    ds_read_b64_tr_b16 a[74:75], v22 offset:512
    ds_read_b64_tr_b16 a[76:77], v23 offset:0
    ds_read_b64_tr_b16 a[78:79], v23 offset:512
    ds_read_b64_tr_b16 a[80:81], v20 offset:0
    ds_read_b64_tr_b16 a[82:83], v20 offset:512
    ds_read_b64_tr_b16 a[84:85], v21 offset:0
    ds_read_b64_tr_b16 a[86:87], v21 offset:512
    v_cvt_pk_bf16_f32 v128, v112, v113
    v_cvt_pk_bf16_f32 v129, v114, v115
    v_cvt_pk_bf16_f32 v130, v116, v117
    v_cvt_pk_bf16_f32 v131, v118, v119
    v_cvt_pk_bf16_f32 v132, v120, v121
    v_cvt_pk_bf16_f32 v133, v122, v123
    v_cvt_pk_bf16_f32 v134, v124, v125
    v_cvt_pk_bf16_f32 v135, v126, v127
    s_waitcnt lgkmcnt(10)
    v_mfma_f32_16x16x32_bf16 v[64:67], a[64:67], v[128:131], 0
    s_lshl_b32 s20, s2, 2
    ds_read_b64_tr_b16 a[88:89], v24 offset:0
    ds_read_b64_tr_b16 a[90:91], v24 offset:512
    v_mfma_f32_16x16x32_bf16 v[80:83], a[64:67], v[132:135], 0
    s_waitcnt lgkmcnt(6)
    buffer_load_dwordx4 v3, s[28:31], s5 offen offset:1024 lds
    v_mfma_f32_16x16x32_bf16 v[68:71], a[68:71], v[128:131], 0
    s_add_u32 s20, s20, s56
    ds_read_b64_tr_b16 a[92:93], v25 offset:0
    ds_read_b64_tr_b16 a[94:95], v25 offset:512
    v_mfma_f32_16x16x32_bf16 v[84:87], a[68:71], v[132:135], 0
    buffer_load_dwordx4 v4, s[28:31], s5 offen offset:2048 lds
    v_mfma_f32_16x16x32_bf16 v[72:75], a[72:75], v[128:131], 0
    s_mul_i32 s81, s20, 1792
    ds_read_b64_tr_b16 a[64:65], v18 offset:4096
    ds_read_b64_tr_b16 a[66:67], v18 offset:4608
    v_mfma_f32_16x16x32_bf16 v[88:91], a[72:75], v[132:135], 0
    buffer_load_dwordx4 v5, s[28:31], s5 offen offset:3072 lds
    v_mfma_f32_16x16x32_bf16 v[76:79], a[76:79], v[128:131], 0
    s_add_u32 s4, s4, 1
    ds_read_b64_tr_b16 a[68:69], v19 offset:4096
    ds_read_b64_tr_b16 a[70:71], v19 offset:4608
    v_mfma_f32_16x16x32_bf16 v[92:95], a[76:79], v[132:135], 0
    s_waitcnt lgkmcnt(6)
    v_cvt_pk_bf16_f32 v136, v56, v57
    v_cvt_pk_bf16_f32 v137, v58, v59
    v_cvt_pk_bf16_f32 v138, v60, v61
    v_cvt_pk_bf16_f32 v139, v62, v63
    v_mfma_f32_4x4x4_16b_bf16 v[56:59], v[42:43], v[140:141], v[48:51]
    v_mfma_f32_4x4x4_16b_bf16 v[60:63], v[42:43], v[142:143], v[48:51]
    v_fma_f32 v36, -v34, v34, v36
    v_fma_f32 v37, -v35, v35, v37
    v_mfma_f32_16x16x32_bf16 v[96:99], a[80:83], v[128:131], 0
    s_and_b32 s4, s4, 7
    ds_read_b64_tr_b16 a[72:73], v22 offset:4096
    ds_read_b64_tr_b16 a[74:75], v22 offset:4608
    v_mfma_f32_16x16x32_bf16 v[112:115], a[80:83], v[132:135], 0
    s_nop 0
    v_cvt_pk_bf16_f32 v140, v56, v57
    v_cvt_pk_bf16_f32 v141, v58, v59
    v_mfma_f32_16x16x32_bf16 v[100:103], a[84:87], v[128:131], 0
    s_mul_i32 s5, s4, 229376
    ds_read_b64_tr_b16 a[76:77], v23 offset:4096
    ds_read_b64_tr_b16 a[78:79], v23 offset:4608
    v_mfma_f32_16x16x32_bf16 v[116:119], a[84:87], v[132:135], 0
    v_cvt_pk_bf16_f32 v142, v60, v61
    v_cvt_pk_bf16_f32 v143, v62, v63
    v_mfma_f32_16x16x32_bf16 v[104:107], a[88:91], v[128:131], 0
    s_add_u32 m0, s60, 32768
    ds_read_b64_tr_b16 a[80:81], v20 offset:4096
    ds_read_b64_tr_b16 a[82:83], v20 offset:4608
    v_mfma_f32_16x16x32_bf16 v[120:123], a[88:91], v[132:135], 0
    s_waitcnt lgkmcnt(6)
    buffer_load_dwordx4 v2, s[28:31], s5 offen offset:0 lds
    v_mfma_f32_16x16x32_bf16 v[108:111], a[92:95], v[128:131], 0
    s_lshl_b32 s96, s20, 9
    ds_read_b64_tr_b16 a[84:85], v21 offset:4096
    ds_read_b64_tr_b16 a[86:87], v21 offset:4608
    v_mfma_f32_16x16x32_bf16 v[124:127], a[92:95], v[132:135], 0
    buffer_load_dwordx4 v3, s[28:31], s5 offen offset:1024 lds
    v_mfma_f32_4x4x4_16b_bf16 v[56:59], v[42:43], v[144:145], v[44:47]
    v_mfma_f32_4x4x4_16b_bf16 v[60:63], v[42:43], v[146:147], v[44:47]
    buffer_load_dwordx4 v4, s[28:31], s5 offen offset:2048 lds
    v_mfma_f32_16x16x32_bf16 v[64:67], a[64:67], v[136:139], v[64:67]
    s_nop 0
    ds_read_b64_tr_b16 a[88:89], v24 offset:4096
    ds_read_b64_tr_b16 a[90:91], v24 offset:4608
    v_mfma_f32_16x16x32_bf16 v[80:83], a[64:67], v[140:143], v[80:83]
    s_nop 0
    v_cvt_pk_bf16_f32 v144, v56, v57
    v_cvt_pk_bf16_f32 v145, v58, v59
    v_mfma_f32_16x16x32_bf16 v[68:71], a[68:71], v[136:139], v[68:71]
    s_mov_b32 s93, 200000
    ds_read_b64_tr_b16 a[92:93], v25 offset:4096
    ds_read_b64_tr_b16 a[94:95], v25 offset:4608
    v_mfma_f32_16x16x32_bf16 v[84:87], a[68:71], v[140:143], v[84:87]
    s_waitcnt lgkmcnt(6) vmcnt(11)
    buffer_load_dwordx4 v5, s[28:31], s5 offen offset:3072 lds
    v_mfma_f32_16x16x32_bf16 v[72:75], a[72:75], v[136:139], v[72:75]
    s_barrier
    ds_read_b64_tr_b16 a[64:65], v18 offset:8192
    ds_read_b64_tr_b16 a[66:67], v18 offset:8704
    v_mfma_f32_16x16x32_bf16 v[88:91], a[72:75], v[140:143], v[88:91]
    v_cvt_pk_bf16_f32 v146, v60, v61
    v_cvt_pk_bf16_f32 v147, v62, v63
    v_mfma_f32_16x16x32_bf16 v[76:79], a[76:79], v[136:139], v[76:79]
    s_add_u32 s4, s4, 1
    ds_read_b64_tr_b16 a[68:69], v19 offset:8192
    ds_read_b64_tr_b16 a[70:71], v19 offset:8704
    v_mfma_f32_16x16x32_bf16 v[92:95], a[76:79], v[140:143], v[92:95]
    s_mov_b64 exec, 0x6cd9b36
    buffer_load_dword v55, v41, s[28:31], s80 offen sc0 sc1
    s_mov_b64 exec, -1
    v_mfma_f32_4x4x4_16b_bf16 v[56:59], v[42:43], v[148:149], v[48:51]
    v_mfma_f32_4x4x4_16b_bf16 v[60:63], v[42:43], v[150:151], v[48:51]
    v_max_f32 v36, 0, v36
    v_max_f32 v37, 0, v37
    v_mfma_f32_16x16x32_bf16 v[96:99], a[80:83], v[136:139], v[96:99]
    s_and_b32 s4, s4, 7
    ds_read_b64_tr_b16 a[72:73], v22 offset:8192
    ds_read_b64_tr_b16 a[74:75], v22 offset:8704
    v_mfma_f32_16x16x32_bf16 v[112:115], a[80:83], v[140:143], v[112:115]
    s_waitcnt lgkmcnt(6)
    v_cvt_pk_bf16_f32 v148, v56, v57
    v_cvt_pk_bf16_f32 v149, v58, v59
    v_mfma_f32_16x16x32_bf16 v[100:103], a[84:87], v[136:139], v[100:103]
    s_mul_i32 s5, s4, 229376
    ds_read_b64_tr_b16 a[76:77], v23 offset:8192
    ds_read_b64_tr_b16 a[78:79], v23 offset:8704
    v_mfma_f32_16x16x32_bf16 v[116:119], a[84:87], v[140:143], v[116:119]
    v_cvt_pk_bf16_f32 v150, v60, v61
    v_cvt_pk_bf16_f32 v151, v62, v63
    v_mfma_f32_16x16x32_bf16 v[104:107], a[88:91], v[136:139], v[104:107]
    s_add_u32 m0, s60, 40960
    ds_read_b64_tr_b16 a[80:81], v20 offset:8192
    ds_read_b64_tr_b16 a[82:83], v20 offset:8704
    v_mfma_f32_16x16x32_bf16 v[120:123], a[88:91], v[140:143], v[120:123]
    buffer_load_dwordx4 v2, s[28:31], s5 offen offset:0 lds
    v_mfma_f32_16x16x32_bf16 v[108:111], a[92:95], v[136:139], v[108:111]
    s_lshr_b32 s83, s2, 5
    ds_read_b64_tr_b16 a[84:85], v21 offset:8192
    ds_read_b64_tr_b16 a[86:87], v21 offset:8704
    v_mfma_f32_16x16x32_bf16 v[124:127], a[92:95], v[140:143], v[124:127]
    s_waitcnt lgkmcnt(6)
    v_cvt_pk_bf16_f32 v37, v36, v37
    v_lshlrev_b32_e64 v36, 16, v37
    v_mfma_f32_4x4x4_16b_bf16 v[56:59], v[42:43], v[152:153], v[44:47]
    v_mfma_f32_4x4x4_16b_bf16 v[60:63], v[42:43], v[154:155], v[44:47]
    buffer_load_dwordx4 v3, s[28:31], s5 offen offset:1024 lds
    v_mfma_f32_16x16x32_bf16 v[64:67], a[64:67], v[144:147], v[64:67]
    s_xor_b32 s83, s83, 2
    ds_read_b64_tr_b16 a[88:89], v24 offset:8192
    ds_read_b64_tr_b16 a[90:91], v24 offset:8704
    v_mfma_f32_16x16x32_bf16 v[80:83], a[64:67], v[148:151], v[80:83]
    s_nop 0
    v_cvt_pk_bf16_f32 v152, v56, v57
    v_cvt_pk_bf16_f32 v153, v58, v59
    v_mfma_f32_16x16x32_bf16 v[68:71], a[68:71], v[144:147], v[68:71]
    s_lshl_b32 s83, s83, 7
    ds_read_b64_tr_b16 a[92:93], v25 offset:8192
    ds_read_b64_tr_b16 a[94:95], v25 offset:8704
    v_mfma_f32_16x16x32_bf16 v[84:87], a[68:71], v[148:151], v[84:87]
    s_nop 0
    v_cvt_pk_bf16_f32 v154, v60, v61
    v_cvt_pk_bf16_f32 v155, v62, v63
    v_mfma_f32_16x16x32_bf16 v[72:75], a[72:75], v[144:147], v[72:75]
    s_mul_i32 s84, s56, 458752
    ds_read_b64_tr_b16 a[64:65], v18 offset:12288
    ds_read_b64_tr_b16 a[66:67], v18 offset:12800
    v_mfma_f32_16x16x32_bf16 v[88:91], a[72:75], v[148:151], v[88:91]
    s_waitcnt lgkmcnt(6)
    buffer_load_dwordx4 v4, s[28:31], s5 offen offset:2048 lds
    v_mfma_f32_16x16x32_bf16 v[76:79], a[76:79], v[144:147], v[76:79]
    s_add_u32 s84, s84, s83
    ds_read_b64_tr_b16 a[68:69], v19 offset:12288
    ds_read_b64_tr_b16 a[70:71], v19 offset:12800
    v_mfma_f32_16x16x32_bf16 v[92:95], a[76:79], v[148:151], v[92:95]
    v_and_b32 v37, 0xffff0000, v37
    v_add_f32 v36, 0x3727c5ac, v36
    v_mfma_f32_4x4x4_16b_bf16 v[56:59], v[42:43], v[156:157], v[48:51]
    v_mfma_f32_4x4x4_16b_bf16 v[60:63], v[42:43], v[158:159], v[48:51]
    v_add_f32 v37, 0x3727c5ac, v37
    v_cvt_pk_bf16_f32 v37, v36, v37
    v_mfma_f32_16x16x32_bf16 v[96:99], a[80:83], v[144:147], v[96:99]
    s_bfe_u32 s6, s2, 0x20003
    ds_read_b64_tr_b16 a[72:73], v22 offset:12288
    ds_read_b64_tr_b16 a[74:75], v22 offset:12800
    v_mfma_f32_16x16x32_bf16 v[112:115], a[80:83], v[148:151], v[112:115]
    buffer_load_dwordx4 v5, s[28:31], s5 offen offset:3072 lds
    v_mfma_f32_16x16x32_bf16 v[100:103], a[84:87], v[144:147], v[100:103]
    s_lshr_b32 s20, s83, 6
    ds_read_b64_tr_b16 a[76:77], v23 offset:12288
    ds_read_b64_tr_b16 a[78:79], v23 offset:12800
    v_mfma_f32_16x16x32_bf16 v[116:119], a[84:87], v[148:151], v[116:119]
    s_waitcnt lgkmcnt(6)
    v_cvt_pk_bf16_f32 v156, v56, v57
    v_cvt_pk_bf16_f32 v157, v58, v59
    v_mfma_f32_16x16x32_bf16 v[104:107], a[88:91], v[144:147], v[104:107]
    s_lshr_b32 s20, 192, s20
    ds_read_b64_tr_b16 a[80:81], v20 offset:12288
    ds_read_b64_tr_b16 a[82:83], v20 offset:12800
    v_mfma_f32_16x16x32_bf16 v[120:123], a[88:91], v[148:151], v[120:123]
    s_and_b32 s6, s6, s20
    v_cvt_pk_bf16_f32 v158, v60, v61
    v_cvt_pk_bf16_f32 v159, v62, v63
    v_mfma_f32_16x16x32_bf16 v[108:111], a[92:95], v[144:147], v[108:111]
    s_xor_b32 s6, s6, s2
    ds_read_b64_tr_b16 a[84:85], v21 offset:12288
    ds_read_b64_tr_b16 a[86:87], v21 offset:12800
    v_mfma_f32_16x16x32_bf16 v[124:127], a[92:95], v[148:151], v[124:127]
    s_and_b32 s20, s6, 1
    s_mov_b64 exec, 0x3fff
    buffer_load_dword v55, v41, s[44:47], s81 offen sc0 sc1
    s_mov_b64 exec, -1
    v_mfma_f32_4x4x4_16b_bf16 v[56:59], v[42:43], v[160:161], v[44:47]
    v_mfma_f32_4x4x4_16b_bf16 v[60:63], v[42:43], v[162:163], v[44:47]
    v_lshlrev_b32_e64 v36, 16, v37
    v_and_b32 v37, 0xffff0000, v37
    v_mfma_f32_16x16x32_bf16 v[64:67], a[64:67], v[152:155], v[64:67]
    s_lshl_b32 s10, s20, 12
    ds_read_b64_tr_b16 a[88:89], v24 offset:12288
    ds_read_b64_tr_b16 a[90:91], v24 offset:12800
    v_mfma_f32_16x16x32_bf16 v[80:83], a[64:67], v[156:159], v[80:83]
    s_waitcnt lgkmcnt(6)
    v_cvt_pk_bf16_f32 v160, v56, v57
    v_cvt_pk_bf16_f32 v161, v58, v59
    v_mfma_f32_16x16x32_bf16 v[68:71], a[68:71], v[152:155], v[68:71]
    s_lshl_b32 s20, s20, 13
    ds_read_b64_tr_b16 a[92:93], v25 offset:12288
    ds_read_b64_tr_b16 a[94:95], v25 offset:12800
    v_mfma_f32_16x16x32_bf16 v[84:87], a[68:71], v[156:159], v[84:87]
    s_waitcnt vmcnt(10)
    v_cvt_pk_bf16_f32 v162, v60, v61
    v_cvt_pk_bf16_f32 v163, v62, v63
    v_mfma_f32_16x16x32_bf16 v[72:75], a[72:75], v[152:155], v[72:75]
    s_barrier
    ds_read_b64_tr_b16 a[64:65], v18 offset:16384
    ds_read_b64_tr_b16 a[66:67], v18 offset:16896
    v_mfma_f32_16x16x32_bf16 v[88:91], a[72:75], v[156:159], v[88:91]
    s_sub_u32 s12, 4096, s20
    v_sqrt_f32 v36, v36
    v_mfma_f32_16x16x32_bf16 v[76:79], a[76:79], v[152:155], v[76:79]
    s_sub_u32 s13, s20, 4096
    ds_read_b64_tr_b16 a[68:69], v19 offset:16384
    ds_read_b64_tr_b16 a[70:71], v19 offset:16896
    v_mfma_f32_16x16x32_bf16 v[92:95], a[76:79], v[156:159], v[92:95]
    s_waitcnt lgkmcnt(6)
    v_sqrt_f32 v37, v37
    v_mfma_f32_4x4x4_16b_bf16 v[56:59], v[42:43], v[164:165], v[48:51]
    v_mfma_f32_4x4x4_16b_bf16 v[60:63], v[42:43], v[166:167], v[48:51]
    v_cvt_pk_bf16_f32 v37, v36, v37
    v_lshlrev_b32_e64 v36, 16, v37
    v_mfma_f32_16x16x32_bf16 v[96:99], a[80:83], v[152:155], v[96:99]
    s_and_b32 s20, s6, 2
    ds_read_b64_tr_b16 a[72:73], v22 offset:16384
    ds_read_b64_tr_b16 a[74:75], v22 offset:16896
    v_mfma_f32_16x16x32_bf16 v[112:115], a[80:83], v[156:159], v[112:115]
    s_mul_i32 s21, s20, 24576
    v_cvt_pk_bf16_f32 v164, v56, v57
    v_cvt_pk_bf16_f32 v165, v58, v59
    v_mfma_f32_16x16x32_bf16 v[100:103], a[84:87], v[152:155], v[100:103]
    s_add_u32 s8, s10, s21
    ds_read_b64_tr_b16 a[76:77], v23 offset:16384
    ds_read_b64_tr_b16 a[78:79], v23 offset:16896
    v_mfma_f32_16x16x32_bf16 v[116:119], a[84:87], v[156:159], v[116:119]
    s_lshl_b32 s21, s21, 1
    v_cvt_pk_bf16_f32 v166, v60, v61
    v_cvt_pk_bf16_f32 v167, v62, v63
    v_mfma_f32_16x16x32_bf16 v[104:107], a[88:91], v[152:155], v[104:107]
    s_sub_u32 s17, 49152, s21
    ds_read_b64_tr_b16 a[80:81], v20 offset:16384
    ds_read_b64_tr_b16 a[82:83], v20 offset:16896
    v_mfma_f32_16x16x32_bf16 v[120:123], a[88:91], v[156:159], v[120:123]
    s_waitcnt lgkmcnt(6)
    v_and_b32 v37, 0xffff0000, v37
    v_accvgpr_write_b32 a0, v128
    v_mfma_f32_16x16x32_bf16 v[108:111], a[92:95], v[152:155], v[108:111]
    s_add_u32 s4, s4, 1
    ds_read_b64_tr_b16 a[84:85], v21 offset:16384
    ds_read_b64_tr_b16 a[86:87], v21 offset:16896
    v_mfma_f32_16x16x32_bf16 v[124:127], a[92:95], v[156:159], v[124:127]
    v_rcp_f32 v34, v36
    v_mfma_f32_4x4x4_16b_bf16 v[56:59], v[42:43], v[168:169], v[44:47]
    v_mfma_f32_4x4x4_16b_bf16 v[60:63], v[42:43], v[170:171], v[44:47]
    v_rcp_f32_e64 v35, v37
    v_mfma_f32_16x16x32_bf16 v[64:67], a[64:67], v[160:163], v[64:67]
    s_and_b32 s4, s4, 7
    ds_read_b64_tr_b16 a[88:89], v24 offset:16384
    ds_read_b64_tr_b16 a[90:91], v24 offset:16896
    v_mfma_f32_16x16x32_bf16 v[80:83], a[64:67], v[164:167], v[80:83]
    s_nop 0
    v_cvt_pk_bf16_f32 v168, v56, v57
    v_cvt_pk_bf16_f32 v169, v58, v59
    v_mfma_f32_16x16x32_bf16 v[68:71], a[68:71], v[160:163], v[68:71]
    s_mul_i32 s5, s4, 229376
    ds_read_b64_tr_b16 a[92:93], v25 offset:16384
    ds_read_b64_tr_b16 a[94:95], v25 offset:16896
    v_mfma_f32_16x16x32_bf16 v[84:87], a[68:71], v[164:167], v[84:87]
    s_waitcnt lgkmcnt(6)
    v_cvt_pk_bf16_f32 v170, v60, v61
    v_cvt_pk_bf16_f32 v171, v62, v63
    v_mfma_f32_16x16x32_bf16 v[72:75], a[72:75], v[160:163], v[72:75]
    s_mov_b32 m0, s60
    ds_read_b64_tr_b16 a[64:65], v18 offset:20480
    ds_read_b64_tr_b16 a[66:67], v18 offset:20992
    v_mfma_f32_16x16x32_bf16 v[88:91], a[72:75], v[164:167], v[88:91]
L_padA1:
    s_cbranch_execz L_padA5
    buffer_load_dwordx4 v2, s[28:31], s5 offen offset:0 lds
    v_mfma_f32_16x16x32_bf16 v[76:79], a[76:79], v[160:163], v[76:79]
    s_lshl_b32 s21, s20, 12
    ds_read_b64_tr_b16 a[68:69], v19 offset:20480
    ds_read_b64_tr_b16 a[70:71], v19 offset:20992
    v_mfma_f32_16x16x32_bf16 v[92:95], a[76:79], v[164:167], v[92:95]
    buffer_load_dwordx4 v3, s[28:31], s5 offen offset:1024 lds
    v_mfma_f32_4x4x4_16b_bf16 v[56:59], v[42:43], v[172:173], v[48:51]
    v_mfma_f32_4x4x4_16b_bf16 v[60:63], v[42:43], v[174:175], v[48:51]
    buffer_load_dwordx4 v4, s[28:31], s5 offen offset:2048 lds
    v_mfma_f32_16x16x32_bf16 v[96:99], a[80:83], v[160:163], v[96:99]
    s_add_u32 s11, s10, s21
    ds_read_b64_tr_b16 a[72:73], v22 offset:20480
    ds_read_b64_tr_b16 a[74:75], v22 offset:20992
    v_mfma_f32_16x16x32_bf16 v[112:115], a[80:83], v[164:167], v[112:115]
    s_waitcnt lgkmcnt(6)
    v_cvt_pk_bf16_f32 v172, v56, v57
    v_cvt_pk_bf16_f32 v173, v58, v59
    v_mfma_f32_16x16x32_bf16 v[100:103], a[84:87], v[160:163], v[100:103]
    s_lshl_b32 s21, s21, 1
    ds_read_b64_tr_b16 a[76:77], v23 offset:20480
    ds_read_b64_tr_b16 a[78:79], v23 offset:20992
    v_mfma_f32_16x16x32_bf16 v[116:119], a[84:87], v[164:167], v[116:119]
    buffer_load_dwordx4 v5, s[28:31], s5 offen offset:3072 lds
    v_mfma_f32_16x16x32_bf16 v[104:107], a[88:91], v[160:163], v[104:107]
    s_sub_u32 s14, 8192, s21
    ds_read_b64_tr_b16 a[80:81], v20 offset:20480
    ds_read_b64_tr_b16 a[82:83], v20 offset:20992
    v_mfma_f32_16x16x32_bf16 v[120:123], a[88:91], v[164:167], v[120:123]
    s_sub_u32 s15, s21, 8192
    v_cvt_pk_bf16_f32 v174, v60, v61
    v_cvt_pk_bf16_f32 v175, v62, v63
    v_mfma_f32_16x16x32_bf16 v[108:111], a[92:95], v[160:163], v[108:111]
    s_and_b32 s20, s6, 4
    ds_read_b64_tr_b16 a[84:85], v21 offset:20480
    ds_read_b64_tr_b16 a[86:87], v21 offset:20992
    v_mfma_f32_16x16x32_bf16 v[124:127], a[92:95], v[164:167], v[124:127]
    s_waitcnt lgkmcnt(6)
    v_mul_f32 v36, v36, v36
    v_mul_f32_e64 v37, v37, v37
    v_mfma_f32_4x4x4_16b_bf16 v[56:59], v[42:43], v[176:177], v[44:47]
    v_mfma_f32_4x4x4_16b_bf16 v[60:63], v[42:43], v[178:179], v[44:47]
    v_mul_f32 v34, 0xbfb8aa3b, v34
    v_mul_f32 v35, 0xbfb8aa3b, v35
    v_mfma_f32_16x16x32_bf16 v[64:67], a[64:67], v[168:171], v[64:67]
    s_mul_i32 s21, s20, 6144
    ds_read_b64_tr_b16 a[88:89], v24 offset:20480
    ds_read_b64_tr_b16 a[90:91], v24 offset:20992
    v_mfma_f32_16x16x32_bf16 v[80:83], a[64:67], v[172:175], v[80:83]
    v_cvt_pk_bf16_f32 v176, v56, v57
    v_cvt_pk_bf16_f32 v177, v58, v59
    v_mfma_f32_16x16x32_bf16 v[68:71], a[68:71], v[168:171], v[68:71]
    s_lshl3_add_u32 s62, s8, s84
    ds_read_b64_tr_b16 a[92:93], v25 offset:20480
    ds_read_b64_tr_b16 a[94:95], v25 offset:20992
    v_mfma_f32_16x16x32_bf16 v[84:87], a[68:71], v[172:175], v[84:87]
    s_nop 0
    v_cvt_pk_bf16_f32 v178, v60, v61
    v_cvt_pk_bf16_f32 v179, v62, v63
    v_mfma_f32_16x16x32_bf16 v[72:75], a[72:75], v[168:171], v[72:75]
    s_add_u32 m0, s60, 49152
    ds_read_b64_tr_b16 a[64:65], v18 offset:24576
    ds_read_b64_tr_b16 a[66:67], v18 offset:25088
    v_mfma_f32_16x16x32_bf16 v[88:91], a[72:75], v[172:175], v[88:91]
    s_waitcnt lgkmcnt(6)
    buffer_load_dwordx4 v14, s[44:47], s62 offen offset:0 lds
    v_mfma_f32_16x16x32_bf16 v[76:79], a[76:79], v[168:171], v[76:79]
    s_add_u32 s9, s11, s21
    ds_read_b64_tr_b16 a[68:69], v19 offset:24576
    ds_read_b64_tr_b16 a[70:71], v19 offset:25088
    v_mfma_f32_16x16x32_bf16 v[92:95], a[76:79], v[172:175], v[92:95]
    buffer_load_dwordx4 v15, s[44:47], s62 offen offset:1024 lds
    v_mfma_f32_4x4x4_16b_bf16 v[56:59], v[42:43], v[180:181], v[48:51]
    v_mfma_f32_4x4x4_16b_bf16 v[60:63], v[42:43], v[182:183], v[48:51]
    buffer_load_dwordx4 v16, s[44:47], s62 offen offset:2048 lds
    v_mfma_f32_16x16x32_bf16 v[96:99], a[80:83], v[168:171], v[96:99]
    s_add_u32 s9, s9, 8192
    ds_read_b64_tr_b16 a[72:73], v22 offset:24576
    ds_read_b64_tr_b16 a[74:75], v22 offset:25088
    v_mfma_f32_16x16x32_bf16 v[112:115], a[80:83], v[172:175], v[112:115]
    v_cvt_pk_bf16_f32 v180, v56, v57
    v_cvt_pk_bf16_f32 v181, v58, v59
    v_mfma_f32_16x16x32_bf16 v[100:103], a[84:87], v[168:171], v[100:103]
    s_lshl_b32 s21, s21, 1
    ds_read_b64_tr_b16 a[76:77], v23 offset:24576
    ds_read_b64_tr_b16 a[78:79], v23 offset:25088
    v_mfma_f32_16x16x32_bf16 v[116:119], a[84:87], v[172:175], v[116:119]
    s_waitcnt lgkmcnt(6)
    buffer_load_dwordx4 v17, s[44:47], s62 offen offset:3072 lds
    v_mfma_f32_16x16x32_bf16 v[104:107], a[88:91], v[168:171], v[104:107]
    s_sub_u32 s16, 24576, s21
    ds_read_b64_tr_b16 a[80:81], v20 offset:24576
    ds_read_b64_tr_b16 a[82:83], v20 offset:25088
    v_mfma_f32_16x16x32_bf16 v[120:123], a[88:91], v[172:175], v[120:123]
    s_add_u32 s10, s10, 24576
    v_cvt_pk_bf16_f32 v182, v60, v61
    v_cvt_pk_bf16_f32 v183, v62, v63
    v_mfma_f32_16x16x32_bf16 v[108:111], a[92:95], v[168:171], v[108:111]
    s_lshl_b32 s85, s56, 17
    ds_read_b64_tr_b16 a[84:85], v21 offset:24576
    ds_read_b64_tr_b16 a[86:87], v21 offset:25088
    v_mfma_f32_16x16x32_bf16 v[124:127], a[92:95], v[172:175], v[124:127]
    s_add_u32 s85, s85, s83
    v_accvgpr_write_b32 a1, v129
    v_accvgpr_write_b32 a2, v130
    v_mfma_f32_4x4x4_16b_bf16 v[56:59], v[42:43], v[184:185], v[44:47]
    v_mfma_f32_4x4x4_16b_bf16 v[60:63], v[42:43], v[186:187], v[44:47]
    v_accvgpr_write_b32 a3, v131
    v_accvgpr_write_b32 a4, v132
    v_mfma_f32_16x16x32_bf16 v[64:67], a[64:67], v[176:179], v[64:67]
    s_mov_b32 s70, 0x35c1a2a0
    ds_read_b64_tr_b16 a[88:89], v24 offset:24576
    ds_read_b64_tr_b16 a[90:91], v24 offset:25088
    v_mfma_f32_16x16x32_bf16 v[80:83], a[64:67], v[180:183], v[80:83]
    s_waitcnt lgkmcnt(6)
    v_cvt_pk_bf16_f32 v184, v56, v57
    v_cvt_pk_bf16_f32 v185, v58, v59
    v_mfma_f32_16x16x32_bf16 v[68:71], a[68:71], v[176:179], v[68:71]
    s_mov_b32 s71, 0x3f317218
    ds_read_b64_tr_b16 a[92:93], v25 offset:24576
    ds_read_b64_tr_b16 a[94:95], v25 offset:25088
    v_mfma_f32_16x16x32_bf16 v[84:87], a[68:71], v[180:183], v[84:87]
    s_mov_b32 s69, 0x358637bd
    v_cvt_pk_bf16_f32 v186, v60, v61
    v_cvt_pk_bf16_f32 v187, v62, v63
    v_mfma_f32_16x16x32_bf16 v[72:75], a[72:75], v[176:179], v[72:75]
    s_lshl_b32 s20, s58, 2
    ds_read_b64_tr_b16 a[64:65], v18 offset:28672
    ds_read_b64_tr_b16 a[66:67], v18 offset:29184
    v_mfma_f32_16x16x32_bf16 v[88:91], a[72:75], v[180:183], v[88:91]
    v_accvgpr_write_b32 a5, v133
    v_accvgpr_write_b32 a6, v134
    v_mfma_f32_16x16x32_bf16 v[76:79], a[76:79], v[176:179], v[76:79]
    s_lshl3_add_u32 s62, s12, s62
    ds_read_b64_tr_b16 a[68:69], v19 offset:28672
    ds_read_b64_tr_b16 a[70:71], v19 offset:29184
    v_mfma_f32_16x16x32_bf16 v[92:95], a[76:79], v[180:183], v[92:95]
    s_waitcnt lgkmcnt(6)
    v_accvgpr_write_b32 a7, v135
    v_accvgpr_write_b32 a8, v136
    v_mfma_f32_4x4x4_16b_bf16 v[56:59], v[42:43], v[188:189], v[48:51]
    v_mfma_f32_4x4x4_16b_bf16 v[60:63], v[42:43], v[190:191], v[48:51]
    v_accvgpr_write_b32 a9, v137
    v_accvgpr_write_b32 a10, v138
    v_mfma_f32_16x16x32_bf16 v[96:99], a[80:83], v[176:179], v[96:99]
    s_add_u32 m0, s60, 57344
    ds_read_b64_tr_b16 a[72:73], v22 offset:28672
    ds_read_b64_tr_b16 a[74:75], v22 offset:29184
    v_mfma_f32_16x16x32_bf16 v[112:115], a[80:83], v[180:183], v[112:115]
    buffer_load_dwordx4 v14, s[44:47], s62 offen offset:0 lds
    v_mfma_f32_16x16x32_bf16 v[100:103], a[84:87], v[176:179], v[100:103]
    s_add_u32 s20, s20, s56
    ds_read_b64_tr_b16 a[76:77], v23 offset:28672
    ds_read_b64_tr_b16 a[78:79], v23 offset:29184
    v_mfma_f32_16x16x32_bf16 v[116:119], a[84:87], v[180:183], v[116:119]
    buffer_load_dwordx4 v15, s[44:47], s62 offen offset:1024 lds
    v_mfma_f32_16x16x32_bf16 v[104:107], a[88:91], v[176:179], v[104:107]
    s_mul_i32 s76, s20, 16384
    ds_read_b64_tr_b16 a[80:81], v20 offset:28672
    ds_read_b64_tr_b16 a[82:83], v20 offset:29184
    v_mfma_f32_16x16x32_bf16 v[120:123], a[88:91], v[180:183], v[120:123]
    s_waitcnt lgkmcnt(6)
    buffer_load_dwordx4 v16, s[44:47], s62 offen offset:2048 lds
    v_mfma_f32_16x16x32_bf16 v[108:111], a[92:95], v[176:179], v[108:111]
    s_add_u32 s76, s76, 10485760
    ds_read_b64_tr_b16 a[84:85], v21 offset:28672
    ds_read_b64_tr_b16 a[86:87], v21 offset:29184
    v_mfma_f32_16x16x32_bf16 v[124:127], a[92:95], v[180:183], v[124:127]
    buffer_load_dwordx4 v17, s[44:47], s62 offen offset:3072 lds
    v_cvt_pk_bf16_f32 v188, v56, v57
    v_cvt_pk_bf16_f32 v189, v58, v59
    v_cvt_pk_bf16_f32 v190, v60, v61
    v_cvt_pk_bf16_f32 v191, v62, v63
    v_mfma_f32_4x4x4_16b_bf16 v[56:59], v[42:43], v[192:193], v[44:47]
    v_mfma_f32_4x4x4_16b_bf16 v[60:63], v[42:43], v[194:195], v[44:47]
    v_accvgpr_write_b32 a11, v139
    v_accvgpr_write_b32 a12, v140
    v_mfma_f32_16x16x32_bf16 v[64:67], a[64:67], v[184:187], v[64:67]
    s_lshl_b32 s77, s20, 7
    ds_read_b64_tr_b16 a[88:89], v24 offset:28672
    ds_read_b64_tr_b16 a[90:91], v24 offset:29184
    v_mfma_f32_16x16x32_bf16 v[80:83], a[64:67], v[188:191], v[80:83]
    s_add_u32 s77, s77, 12648448
    v_cvt_pk_bf16_f32 v192, v56, v57
    v_cvt_pk_bf16_f32 v193, v58, v59
    v_mfma_f32_16x16x32_bf16 v[68:71], a[68:71], v[184:187], v[68:71]
    s_lshr_b32 s22, s63, 1
    ds_read_b64_tr_b16 a[92:93], v25 offset:28672
    ds_read_b64_tr_b16 a[94:95], v25 offset:29184
    v_mfma_f32_16x16x32_bf16 v[84:87], a[68:71], v[188:191], v[84:87]
    s_waitcnt lgkmcnt(6) vmcnt(13)
    v_cvt_pk_bf16_f32 v194, v60, v61
    v_cvt_pk_bf16_f32 v195, v62, v63
    v_mfma_f32_16x16x32_bf16 v[72:75], a[72:75], v[184:187], v[72:75]
    s_barrier
    ds_read_b64_tr_b16 a[64:65], v18 offset:32768
    ds_read_b64_tr_b16 a[66:67], v18 offset:33280
    v_mfma_f32_16x16x32_bf16 v[88:91], a[72:75], v[188:191], v[88:91]
    v_accvgpr_write_b32 a13, v141
    v_accvgpr_write_b32 a14, v142
    v_mfma_f32_16x16x32_bf16 v[76:79], a[76:79], v[184:187], v[76:79]
    s_add_u32 s4, s4, 1
    ds_read_b64_tr_b16 a[68:69], v19 offset:32768
    ds_read_b64_tr_b16 a[70:71], v19 offset:33280
    v_mfma_f32_16x16x32_bf16 v[92:95], a[76:79], v[188:191], v[92:95]
    s_mov_b64 exec, 0x1020408
    buffer_load_dword v55, v41, s[28:31], s80 offen sc0 sc1
    s_mov_b64 exec, -1
    v_mfma_f32_4x4x4_16b_bf16 v[56:59], v[42:43], v[196:197], v[48:51]
    v_mfma_f32_4x4x4_16b_bf16 v[60:63], v[42:43], v[198:199], v[48:51]
    s_mov_b64 exec, 0xf
    buffer_load_dword v55, v41, s[48:51], s96 offen sc0 sc1
    buffer_load_dword v55, v41, s[32:35], s97 offen sc0 sc1
    s_mov_b64 exec, -1
    v_mfma_f32_16x16x32_bf16 v[96:99], a[80:83], v[184:187], v[96:99]
    s_and_b32 s4, s4, 7
    ds_read_b64_tr_b16 a[72:73], v22 offset:32768
    ds_read_b64_tr_b16 a[74:75], v22 offset:33280
    v_mfma_f32_16x16x32_bf16 v[112:115], a[80:83], v[188:191], v[112:115]
    s_waitcnt lgkmcnt(6)
    v_cvt_pk_bf16_f32 v196, v56, v57
    v_cvt_pk_bf16_f32 v197, v58, v59
    v_mfma_f32_16x16x32_bf16 v[100:103], a[84:87], v[184:187], v[100:103]
    s_mul_i32 s5, s4, 229376
    ds_read_b64_tr_b16 a[76:77], v23 offset:32768
    ds_read_b64_tr_b16 a[78:79], v23 offset:33280
    v_mfma_f32_16x16x32_bf16 v[116:119], a[84:87], v[188:191], v[116:119]
    s_waitcnt vmcnt(7)
    ds_read_b64_tr_b16 a[96:97], v30 offset:49152
    ds_read_b64_tr_b16 a[98:99], v30 offset:51200
    v_mfma_f32_16x16x32_bf16 v[104:107], a[88:91], v[184:187], v[104:107]
    s_add_u32 m0, s60, 8192
    ds_read_b64_tr_b16 a[80:81], v20 offset:32768
    ds_read_b64_tr_b16 a[82:83], v20 offset:33280
    v_mfma_f32_16x16x32_bf16 v[120:123], a[88:91], v[188:191], v[120:123]
    buffer_load_dwordx4 v2, s[28:31], s5 offen offset:0 lds
    v_mfma_f32_16x16x32_bf16 v[108:111], a[92:95], v[184:187], v[108:111]
    s_lshl_b32 s21, s22, 2
    ds_read_b64_tr_b16 a[84:85], v21 offset:32768
    ds_read_b64_tr_b16 a[86:87], v21 offset:33280
    v_mfma_f32_16x16x32_bf16 v[124:127], a[92:95], v[188:191], v[124:127]
    s_waitcnt lgkmcnt(8)
    buffer_load_dwordx4 v3, s[28:31], s5 offen offset:1024 lds
    v_cvt_pk_bf16_f32 v198, v60, v61
    v_cvt_pk_bf16_f32 v199, v62, v63
    v_mfma_f32_4x4x4_16b_bf16 v[56:59], v[42:43], v[200:201], v[44:47]
    v_mfma_f32_4x4x4_16b_bf16 v[60:63], v[42:43], v[202:203], v[44:47]
    buffer_load_dwordx4 v4, s[28:31], s5 offen offset:2048 lds
    v_mfma_f32_16x16x32_bf16 v[64:67], a[64:67], v[192:195], v[64:67]
    s_lshr_b32 s20, s58, 1
    ds_read_b64_tr_b16 a[88:89], v24 offset:32768
    ds_read_b64_tr_b16 a[90:91], v24 offset:33280
    v_mfma_f32_16x16x32_bf16 v[80:83], a[64:67], v[196:199], v[80:83]
    ds_read_b64_tr_b16 a[100:101], v31 offset:49152
    ds_read_b64_tr_b16 a[102:103], v31 offset:51200
    v_mfma_f32_16x16x32_bf16 v[68:71], a[68:71], v[192:195], v[68:71]
    s_add_u32 s20, s20, s21
    ds_read_b64_tr_b16 a[92:93], v25 offset:32768
    ds_read_b64_tr_b16 a[94:95], v25 offset:33280
    v_mfma_f32_16x16x32_bf16 v[84:87], a[68:71], v[196:199], v[84:87]
    buffer_load_dwordx4 v5, s[28:31], s5 offen offset:3072 lds
    v_mfma_f32_16x16x32_bf16 v[72:75], a[72:75], v[192:195], v[72:75]
    s_lshl_b32 s78, s20, 9
    ds_read_b64_tr_b16 a[64:65], v18 offset:36864
    ds_read_b64_tr_b16 a[66:67], v18 offset:37376
    v_mfma_f32_16x16x32_bf16 v[88:91], a[72:75], v[196:199], v[88:91]
    s_waitcnt lgkmcnt(8)
    ds_read_b64_tr_b16 a[104:105], v32 offset:49152
    ds_read_b64_tr_b16 a[106:107], v32 offset:51200
    v_mfma_f32_16x16x32_bf16 v[76:79], a[76:79], v[192:195], v[76:79]
    s_add_u32 s78, s78, 12582912
    ds_read_b64_tr_b16 a[68:69], v19 offset:36864
    ds_read_b64_tr_b16 a[70:71], v19 offset:37376
    v_mfma_f32_16x16x32_bf16 v[92:95], a[76:79], v[196:199], v[92:95]
    s_nop 0
    ds_read_b64_tr_b16 a[108:109], v33 offset:49152
    ds_read_b64_tr_b16 a[110:111], v33 offset:51200
    v_cvt_pk_bf16_f32 v200, v56, v57
    v_cvt_pk_bf16_f32 v201, v58, v59
    v_cvt_pk_bf16_f32 v202, v60, v61
    v_cvt_pk_bf16_f32 v203, v62, v63
    v_mfma_f32_4x4x4_16b_bf16 v[56:59], v[42:43], v[204:205], v[48:51]
    v_mfma_f32_4x4x4_16b_bf16 v[60:63], v[42:43], v[206:207], v[48:51]
    v_add_u32 v2, s18, v2
    v_add_u32 v3, s18, v3
    v_mfma_f32_16x16x32_bf16 v[96:99], a[80:83], v[192:195], v[96:99]
    s_mul_i32 s22, s22, 294912
    ds_read_b64_tr_b16 a[72:73], v22 offset:36864
    ds_read_b64_tr_b16 a[74:75], v22 offset:37376
    v_mfma_f32_16x16x32_bf16 v[112:115], a[80:83], v[196:199], v[112:115]
    v_cvt_pk_bf16_f32 v204, v56, v57
    v_cvt_pk_bf16_f32 v205, v58, v59
    v_mfma_f32_16x16x32_bf16 v[100:103], a[84:87], v[192:195], v[100:103]
    s_lshl_b32 s21, s75, 11
    ds_read_b64_tr_b16 a[76:77], v23 offset:36864
    ds_read_b64_tr_b16 a[78:79], v23 offset:37376
    v_mfma_f32_16x16x32_bf16 v[116:119], a[84:87], v[196:199], v[116:119]
    s_waitcnt lgkmcnt(10)
    v_cvt_pk_bf16_f32 v206, v60, v61
    v_cvt_pk_bf16_f32 v207, v62, v63
    v_mfma_f32_16x16x32_bf16 v[104:107], a[88:91], v[192:195], v[104:107]
    s_add_u32 s22, s22, s21
    ds_read_b64_tr_b16 a[80:81], v20 offset:36864
    ds_read_b64_tr_b16 a[82:83], v20 offset:37376
    v_mfma_f32_16x16x32_bf16 v[120:123], a[88:91], v[196:199], v[120:123]
    v_add_u32 v4, s18, v4
    v_add_u32_e64 v5, s18, v5
    v_mfma_f32_16x16x32_bf16 v[108:111], a[92:95], v[192:195], v[108:111]
    s_waitcnt vmcnt(7)
    ds_read_b64_tr_b16 a[84:85], v21 offset:36864
    ds_read_b64_tr_b16 a[86:87], v21 offset:37376
    v_mfma_f32_16x16x32_bf16 v[124:127], a[92:95], v[196:199], v[124:127]
    s_nop 0
    ds_read_b64_tr_b16 a[112:113], v30 offset:57344
    ds_read_b64_tr_b16 a[114:115], v30 offset:59392
    v_mfma_f32_4x4x4_16b_bf16 v[56:59], v[42:43], v[208:209], v[44:47]
    v_mfma_f32_4x4x4_16b_bf16 v[60:63], v[42:43], v[210:211], v[44:47]
    ds_read_b64_tr_b16 a[116:117], v31 offset:57344
    ds_read_b64_tr_b16 a[118:119], v31 offset:59392
    v_mfma_f32_16x16x32_bf16 v[64:67], a[64:67], v[200:203], v[64:67]
    s_add_u32 s4, s4, 1
    ds_read_b64_tr_b16 a[88:89], v24 offset:36864
    ds_read_b64_tr_b16 a[90:91], v24 offset:37376
    v_mfma_f32_16x16x32_bf16 v[80:83], a[64:67], v[204:207], v[80:83]
    s_waitcnt lgkmcnt(10)
    ds_read_b64_tr_b16 a[120:121], v32 offset:57344
    ds_read_b64_tr_b16 a[122:123], v32 offset:59392
    v_mfma_f32_16x16x32_bf16 v[68:71], a[68:71], v[200:203], v[68:71]
    s_and_b32 s4, s4, 7
    ds_read_b64_tr_b16 a[92:93], v25 offset:36864
    ds_read_b64_tr_b16 a[94:95], v25 offset:37376
    v_mfma_f32_16x16x32_bf16 v[84:87], a[68:71], v[204:207], v[84:87]
    s_nop 0
    ds_read_b64_tr_b16 a[124:125], v33 offset:57344
    ds_read_b64_tr_b16 a[126:127], v33 offset:59392
    v_mfma_f32_16x16x32_bf16 v[72:75], a[72:75], v[200:203], v[72:75]
    s_mul_i32 s5, s4, 229376
    ds_read_b64_tr_b16 a[64:65], v18 offset:40960
    ds_read_b64_tr_b16 a[66:67], v18 offset:41472
    v_mfma_f32_16x16x32_bf16 v[88:91], a[72:75], v[204:207], v[88:91]
    v_cvt_pk_bf16_f32 v208, v56, v57
    v_cvt_pk_bf16_f32 v209, v58, v59
    v_mfma_f32_16x16x32_bf16 v[76:79], a[76:79], v[200:203], v[76:79]
    s_add_u32 m0, s60, 16384
    ds_read_b64_tr_b16 a[68:69], v19 offset:40960
    ds_read_b64_tr_b16 a[70:71], v19 offset:41472
    v_mfma_f32_16x16x32_bf16 v[92:95], a[76:79], v[204:207], v[92:95]
    s_waitcnt lgkmcnt(10)
    buffer_load_dwordx4 v2, s[28:31], s5 offen offset:0 lds
    v_cvt_pk_bf16_f32 v210, v60, v61
    v_cvt_pk_bf16_f32 v211, v62, v63
    v_mfma_f32_4x4x4_16b_bf16 v[56:59], v[42:43], v[212:213], v[48:51]
    v_mfma_f32_4x4x4_16b_bf16 v[60:63], v[42:43], v[214:215], v[48:51]
    buffer_load_dwordx4 v3, s[28:31], s5 offen offset:1024 lds
    v_mfma_f32_16x16x32_bf16 v[96:99], a[80:83], v[200:203], v[96:99]
    s_lshl_b32 s21, s58, 13
    ds_read_b64_tr_b16 a[72:73], v22 offset:40960
    ds_read_b64_tr_b16 a[74:75], v22 offset:41472
    v_mfma_f32_16x16x32_bf16 v[112:115], a[80:83], v[204:207], v[112:115]
    buffer_load_dwordx4 v4, s[28:31], s5 offen offset:2048 lds
    v_mfma_f32_16x16x32_bf16 v[100:103], a[84:87], v[200:203], v[100:103]
    s_add_u32 s67, s22, s21
    ds_read_b64_tr_b16 a[76:77], v23 offset:40960
    ds_read_b64_tr_b16 a[78:79], v23 offset:41472
    v_mfma_f32_16x16x32_bf16 v[116:119], a[84:87], v[204:207], v[116:119]
    buffer_load_dwordx4 v5, s[28:31], s5 offen offset:3072 lds
    v_mfma_f32_16x16x32_bf16 v[104:107], a[88:91], v[200:203], v[104:107]
    s_add_u32 s67, s67, 229376
    ds_read_b64_tr_b16 a[80:81], v20 offset:40960
    ds_read_b64_tr_b16 a[82:83], v20 offset:41472
    v_mfma_f32_16x16x32_bf16 v[120:123], a[88:91], v[204:207], v[120:123]
    s_waitcnt lgkmcnt(6)
    v_cvt_pk_bf16_f32 v212, v56, v57
    v_cvt_pk_bf16_f32 v213, v58, v59
    v_mfma_f32_16x16x32_bf16 v[108:111], a[92:95], v[200:203], v[108:111]
    s_lshl3_add_u32 s62, s17, s62
    ds_read_b64_tr_b16 a[84:85], v21 offset:40960
    ds_read_b64_tr_b16 a[86:87], v21 offset:41472
    v_mfma_f32_16x16x32_bf16 v[124:127], a[92:95], v[204:207], v[124:127]
    s_nop 0
    v_cvt_pk_bf16_f32 v214, v60, v61
    v_cvt_pk_bf16_f32 v215, v62, v63
    v_mfma_f32_4x4x4_16b_bf16 v[56:59], v[42:43], v[216:217], v[44:47]
    v_mfma_f32_4x4x4_16b_bf16 v[60:63], v[42:43], v[218:219], v[44:47]
    v_accvgpr_write_b32 a15, v143
    v_accvgpr_write_b32 a16, v144
    v_mfma_f32_16x16x32_bf16 v[64:67], a[64:67], v[208:211], v[64:67]
    s_add_u32 m0, s60, 49152
    ds_read_b64_tr_b16 a[88:89], v24 offset:40960
    ds_read_b64_tr_b16 a[90:91], v24 offset:41472
    v_mfma_f32_16x16x32_bf16 v[80:83], a[64:67], v[212:215], v[80:83]
    buffer_load_dwordx4 v14, s[44:47], s62 offen offset:0 lds
    v_mfma_f32_16x16x32_bf16 v[68:71], a[68:71], v[208:211], v[68:71]
    s_lshl_b32 s66, s66, 12
    ds_read_b64_tr_b16 a[92:93], v25 offset:40960
    ds_read_b64_tr_b16 a[94:95], v25 offset:41472
    v_mfma_f32_16x16x32_bf16 v[84:87], a[68:71], v[212:215], v[84:87]
    s_waitcnt lgkmcnt(6)
    buffer_load_dwordx4 v15, s[44:47], s62 offen offset:1024 lds
    v_mfma_f32_16x16x32_bf16 v[72:75], a[72:75], v[208:211], v[72:75]
    s_add_u32 s66, s66, s22
    ds_read_b64_tr_b16 a[64:65], v18 offset:45056
    ds_read_b64_tr_b16 a[66:67], v18 offset:45568
    v_mfma_f32_16x16x32_bf16 v[88:91], a[72:75], v[212:215], v[88:91]
    buffer_load_dwordx4 v16, s[44:47], s62 offen offset:2048 lds
    v_mfma_f32_16x16x32_bf16 v[76:79], a[76:79], v[208:211], v[76:79]
    s_lshl_b32 s21, s18, 6
    ds_read_b64_tr_b16 a[68:69], v19 offset:45056
    ds_read_b64_tr_b16 a[70:71], v19 offset:45568
    v_mfma_f32_16x16x32_bf16 v[92:95], a[76:79], v[212:215], v[92:95]
    v_cvt_pk_bf16_f32 v216, v56, v57
    v_cvt_pk_bf16_f32 v217, v58, v59
    v_cvt_pk_bf16_f32 v218, v60, v61
    v_cvt_pk_bf16_f32 v219, v62, v63
    v_mfma_f32_4x4x4_16b_bf16 v[56:59], v[42:43], v[220:221], v[48:51]
    v_mfma_f32_4x4x4_16b_bf16 v[60:63], v[42:43], v[222:223], v[48:51]
    buffer_load_dwordx4 v17, s[44:47], s62 offen offset:3072 lds
    v_mfma_f32_16x16x32_bf16 v[96:99], a[80:83], v[208:211], v[96:99]
    s_add_u32 s68, s66, s21
    ds_read_b64_tr_b16 a[72:73], v22 offset:45056
    ds_read_b64_tr_b16 a[74:75], v22 offset:45568
    v_mfma_f32_16x16x32_bf16 v[112:115], a[80:83], v[212:215], v[112:115]
    s_waitcnt lgkmcnt(6)
    v_cvt_pk_bf16_f32 v220, v56, v57
    v_cvt_pk_bf16_f32 v221, v58, v59
    v_mfma_f32_16x16x32_bf16 v[100:103], a[84:87], v[208:211], v[100:103]
    s_lshl3_add_u32 s62, s13, s62
    ds_read_b64_tr_b16 a[76:77], v23 offset:45056
    ds_read_b64_tr_b16 a[78:79], v23 offset:45568
    v_mfma_f32_16x16x32_bf16 v[116:119], a[84:87], v[212:215], v[116:119]
    s_nop 0
    v_cvt_pk_bf16_f32 v222, v60, v61
    v_cvt_pk_bf16_f32 v223, v62, v63
    v_mfma_f32_16x16x32_bf16 v[104:107], a[88:91], v[208:211], v[104:107]
    s_add_u32 m0, s60, 57344
    ds_read_b64_tr_b16 a[80:81], v20 offset:45056
    ds_read_b64_tr_b16 a[82:83], v20 offset:45568
    v_mfma_f32_16x16x32_bf16 v[120:123], a[88:91], v[212:215], v[120:123]
    buffer_load_dwordx4 v14, s[44:47], s62 offen offset:0 lds
    v_mfma_f32_16x16x32_bf16 v[108:111], a[92:95], v[208:211], v[108:111]
    s_and_b32 s20, s2, 7
    ds_read_b64_tr_b16 a[84:85], v21 offset:45056
    ds_read_b64_tr_b16 a[86:87], v21 offset:45568
    v_mfma_f32_16x16x32_bf16 v[124:127], a[92:95], v[212:215], v[124:127]
    s_waitcnt lgkmcnt(6)
    v_accvgpr_write_b32 a17, v145
    v_accvgpr_write_b32 a18, v146
    v_mfma_f32_4x4x4_16b_bf16 v[56:59], v[42:43], v[224:225], v[44:47]
    v_mfma_f32_4x4x4_16b_bf16 v[60:63], v[42:43], v[226:227], v[44:47]
    v_accvgpr_write_b32 a19, v147
    v_accvgpr_write_b32 a20, v148
    v_mfma_f32_16x16x32_bf16 v[64:67], a[64:67], v[216:219], v[64:67]
    s_lshl_b32 s20, s20, 2
    ds_read_b64_tr_b16 a[88:89], v24 offset:45056
    ds_read_b64_tr_b16 a[90:91], v24 offset:45568
    v_mfma_f32_16x16x32_bf16 v[80:83], a[64:67], v[220:223], v[80:83]
    s_nop 0
    v_cvt_pk_bf16_f32 v224, v56, v57
    v_cvt_pk_bf16_f32 v225, v58, v59
    v_mfma_f32_16x16x32_bf16 v[68:71], a[68:71], v[216:219], v[68:71]
    s_bfe_u32 s21, s2, 0x20003
    ds_read_b64_tr_b16 a[92:93], v25 offset:45056
    ds_read_b64_tr_b16 a[94:95], v25 offset:45568
    v_mfma_f32_16x16x32_bf16 v[84:87], a[68:71], v[220:223], v[84:87]
    s_waitcnt vmcnt(9)
    buffer_load_dwordx4 v15, s[44:47], s62 offen offset:1024 lds
    v_mfma_f32_16x16x32_bf16 v[72:75], a[72:75], v[216:219], v[72:75]
    s_barrier
    ds_read_b64_tr_b16 a[64:65], v18 offset:0
    ds_read_b64_tr_b16 a[66:67], v18 offset:512
    v_mfma_f32_16x16x32_bf16 v[88:91], a[72:75], v[220:223], v[88:91]
    s_waitcnt lgkmcnt(6)
    buffer_load_dwordx4 v16, s[44:47], s62 offen offset:2048 lds
    v_mfma_f32_16x16x32_bf16 v[76:79], a[76:79], v[216:219], v[76:79]
    s_add_u32 s82, s20, s21
    ds_read_b64_tr_b16 a[68:69], v19 offset:0
    ds_read_b64_tr_b16 a[70:71], v19 offset:512
    v_mfma_f32_16x16x32_bf16 v[92:95], a[76:79], v[220:223], v[92:95]
    v_cvt_pk_bf16_f32 v226, v60, v61
    v_cvt_pk_bf16_f32 v227, v62, v63
    v_mfma_f32_4x4x4_16b_bf16 v[56:59], v[42:43], v[228:229], v[48:51]
    v_mfma_f32_4x4x4_16b_bf16 v[60:63], v[42:43], v[230:231], v[48:51]
    v_accvgpr_write_b32 a21, v149
    v_accvgpr_write_b32 a22, v150
    v_mfma_f32_16x16x32_bf16 v[96:99], a[80:83], v[216:219], v[96:99]
    s_lshl_b32 s20, s82, 2
    ds_read_b64_tr_b16 a[72:73], v22 offset:0
    ds_read_b64_tr_b16 a[74:75], v22 offset:512
    v_mfma_f32_16x16x32_bf16 v[112:115], a[80:83], v[220:223], v[112:115]
    buffer_load_dword v38, off, s[40:43], 0 offset:0 sc1
    v_mfma_f32_16x16x32_bf16 v[100:103], a[84:87], v[216:219], v[100:103]
    s_add_u32 s20, s20, s56
    ds_read_b64_tr_b16 a[76:77], v23 offset:0
    ds_read_b64_tr_b16 a[78:79], v23 offset:512
    v_mfma_f32_16x16x32_bf16 v[116:119], a[84:87], v[220:223], v[116:119]
    s_waitcnt lgkmcnt(6)
    v_cvt_pk_bf16_f32 v228, v56, v57
    v_cvt_pk_bf16_f32 v229, v58, v59
    v_mfma_f32_16x16x32_bf16 v[104:107], a[88:91], v[216:219], v[104:107]
    s_lshl_b32 s79, s20, 9
    ds_read_b64_tr_b16 a[80:81], v20 offset:0
    ds_read_b64_tr_b16 a[82:83], v20 offset:512
    v_mfma_f32_16x16x32_bf16 v[120:123], a[88:91], v[220:223], v[120:123]
    buffer_load_dwordx4 v17, s[44:47], s62 offen offset:3072 lds
    v_mfma_f32_16x16x32_bf16 v[108:111], a[92:95], v[216:219], v[108:111]
    s_add_u32 s4, s4, 1
    ds_read_b64_tr_b16 a[84:85], v21 offset:0
    ds_read_b64_tr_b16 a[86:87], v21 offset:512
    v_mfma_f32_16x16x32_bf16 v[124:127], a[92:95], v[220:223], v[124:127]
    s_nop 0
    v_cvt_pk_bf16_f32 v230, v60, v61
    v_cvt_pk_bf16_f32 v231, v62, v63
    v_mfma_f32_4x4x4_16b_bf16 v[56:59], v[42:43], v[232:233], v[44:47]
    v_mfma_f32_4x4x4_16b_bf16 v[60:63], v[42:43], v[234:235], v[44:47]
    v_accvgpr_write_b32 a23, v151
    v_accvgpr_write_b32 a24, v152
    v_mfma_f32_16x16x32_bf16 v[64:67], a[64:67], v[224:227], v[64:67]
    s_and_b32 s4, s4, 7
    ds_read_b64_tr_b16 a[88:89], v24 offset:0
    ds_read_b64_tr_b16 a[90:91], v24 offset:512
    v_mfma_f32_16x16x32_bf16 v[80:83], a[64:67], v[228:231], v[80:83]
    s_waitcnt lgkmcnt(6)
    v_cvt_pk_bf16_f32 v232, v56, v57
    v_cvt_pk_bf16_f32 v233, v58, v59
    v_mfma_f32_16x16x32_bf16 v[68:71], a[68:71], v[224:227], v[68:71]
    s_mul_i32 s5, s4, 229376
    ds_read_b64_tr_b16 a[92:93], v25 offset:0
    ds_read_b64_tr_b16 a[94:95], v25 offset:512
    v_mfma_f32_16x16x32_bf16 v[84:87], a[68:71], v[228:231], v[84:87]
    v_cvt_pk_bf16_f32 v234, v60, v61
    v_cvt_pk_bf16_f32 v235, v62, v63
    v_mfma_f32_16x16x32_bf16 v[72:75], a[72:75], v[224:227], v[72:75]
    s_add_u32 m0, s60, 24576
    ds_read_b64_tr_b16 a[64:65], v18 offset:4096
    ds_read_b64_tr_b16 a[66:67], v18 offset:4608
    v_mfma_f32_16x16x32_bf16 v[88:91], a[72:75], v[228:231], v[88:91]
    buffer_load_dwordx4 v2, s[28:31], s5 offen offset:0 lds
    v_mfma_f32_16x16x32_bf16 v[76:79], a[76:79], v[224:227], v[76:79]
    s_add_u32 s79, s79, 12582912
    ds_read_b64_tr_b16 a[68:69], v19 offset:4096
    ds_read_b64_tr_b16 a[70:71], v19 offset:4608
    v_mfma_f32_16x16x32_bf16 v[92:95], a[76:79], v[228:231], v[92:95]
    s_waitcnt lgkmcnt(6)
    buffer_load_dwordx4 v3, s[28:31], s5 offen offset:1024 lds
    v_mfma_f32_4x4x4_16b_bf16 v[56:59], v[42:43], v[236:237], v[48:51]
    v_mfma_f32_4x4x4_16b_bf16 v[60:63], v[42:43], v[238:239], v[48:51]
    v_accvgpr_write_b32 a25, v153
    v_accvgpr_write_b32 a26, v154
    v_mfma_f32_16x16x32_bf16 v[96:99], a[80:83], v[224:227], v[96:99]
    s_lshl3_add_u32 s88, s82, s56
    ds_read_b64_tr_b16 a[72:73], v22 offset:4096
    ds_read_b64_tr_b16 a[74:75], v22 offset:4608
    v_mfma_f32_16x16x32_bf16 v[112:115], a[80:83], v[228:231], v[112:115]
L_padA2:
    s_cbranch_execz L_padA6
    buffer_load_dwordx4 v4, s[28:31], s5 offen offset:2048 lds
    v_mfma_f32_16x16x32_bf16 v[100:103], a[84:87], v[224:227], v[100:103]
    s_lshl_b32 s88, s88, 13
    ds_read_b64_tr_b16 a[76:77], v23 offset:4096
    ds_read_b64_tr_b16 a[78:79], v23 offset:4608
    v_mfma_f32_16x16x32_bf16 v[116:119], a[84:87], v[228:231], v[116:119]
    v_cvt_pk_bf16_f32 v236, v56, v57
    v_cvt_pk_bf16_f32 v237, v58, v59
    v_mfma_f32_16x16x32_bf16 v[104:107], a[88:91], v[224:227], v[104:107]
    s_add_u32 s88, s88, s83
    ds_read_b64_tr_b16 a[80:81], v20 offset:4096
    ds_read_b64_tr_b16 a[82:83], v20 offset:4608
    v_mfma_f32_16x16x32_bf16 v[120:123], a[88:91], v[228:231], v[120:123]
    s_waitcnt lgkmcnt(6)
    v_cvt_pk_bf16_f32 v238, v60, v61
    v_cvt_pk_bf16_f32 v239, v62, v63
    v_mfma_f32_16x16x32_bf16 v[108:111], a[92:95], v[224:227], v[108:111]
    s_waitcnt vmcnt(8)
    ds_read_b64_tr_b16 a[84:85], v21 offset:4096
    ds_read_b64_tr_b16 a[86:87], v21 offset:4608
    v_mfma_f32_16x16x32_bf16 v[124:127], a[92:95], v[228:231], v[124:127]
    buffer_load_dwordx4 v5, s[28:31], s5 offen offset:3072 lds
    v_mfma_f32_4x4x4_16b_bf16 v[56:59], v[42:43], v[240:241], v[44:47]
    v_mfma_f32_4x4x4_16b_bf16 v[60:63], v[42:43], v[242:243], v[44:47]
    ds_read_b64_tr_b16 a[128:129], v30 offset:49152
    ds_read_b64_tr_b16 a[130:131], v30 offset:51200
    v_mfma_f32_16x16x32_bf16 v[64:67], a[64:67], v[232:235], v[64:67]
    s_add_u32 s4, s4, 1
    ds_read_b64_tr_b16 a[88:89], v24 offset:4096
    ds_read_b64_tr_b16 a[90:91], v24 offset:4608
    v_mfma_f32_16x16x32_bf16 v[80:83], a[64:67], v[236:239], v[80:83]
    ds_read_b64_tr_b16 a[132:133], v31 offset:49152
    ds_read_b64_tr_b16 a[134:135], v31 offset:51200
    v_mfma_f32_16x16x32_bf16 v[68:71], a[68:71], v[232:235], v[68:71]
    s_and_b32 s4, s4, 7
    ds_read_b64_tr_b16 a[92:93], v25 offset:4096
    ds_read_b64_tr_b16 a[94:95], v25 offset:4608
    v_mfma_f32_16x16x32_bf16 v[84:87], a[68:71], v[236:239], v[84:87]
    s_waitcnt lgkmcnt(10)
    ds_read_b64_tr_b16 a[136:137], v32 offset:49152
    ds_read_b64_tr_b16 a[138:139], v32 offset:51200
    v_mfma_f32_16x16x32_bf16 v[72:75], a[72:75], v[232:235], v[72:75]
    s_mul_i32 s5, s4, 229376
    ds_read_b64_tr_b16 a[64:65], v18 offset:8192
    ds_read_b64_tr_b16 a[66:67], v18 offset:8704
    v_mfma_f32_16x16x32_bf16 v[88:91], a[72:75], v[236:239], v[88:91]
    ds_read_b64_tr_b16 a[140:141], v33 offset:49152
    ds_read_b64_tr_b16 a[142:143], v33 offset:51200
    v_mfma_f32_16x16x32_bf16 v[76:79], a[76:79], v[232:235], v[76:79]
    s_add_u32 m0, s60, 32768
    ds_read_b64_tr_b16 a[68:69], v19 offset:8192
    ds_read_b64_tr_b16 a[70:71], v19 offset:8704
    v_mfma_f32_16x16x32_bf16 v[92:95], a[76:79], v[236:239], v[92:95]
    buffer_load_dwordx4 v2, s[28:31], s5 offen offset:0 lds
    v_cvt_pk_bf16_f32 v240, v56, v57
    v_cvt_pk_bf16_f32 v241, v58, v59
    v_cvt_pk_bf16_f32 v242, v60, v61
    v_cvt_pk_bf16_f32 v243, v62, v63
    v_mfma_f32_4x4x4_16b_bf16 v[56:59], v[42:43], v[244:245], v[48:51]
    v_mfma_f32_4x4x4_16b_bf16 v[60:63], v[42:43], v[246:247], v[48:51]
    buffer_load_dwordx4 v3, s[28:31], s5 offen offset:1024 lds
    v_mfma_f32_16x16x32_bf16 v[96:99], a[80:83], v[232:235], v[96:99]
    s_add_u32 s89, s88, 32768
    ds_read_b64_tr_b16 a[72:73], v22 offset:8192
    ds_read_b64_tr_b16 a[74:75], v22 offset:8704
    v_mfma_f32_16x16x32_bf16 v[112:115], a[80:83], v[236:239], v[112:115]
    s_waitcnt lgkmcnt(10)
    buffer_load_dwordx4 v4, s[28:31], s5 offen offset:2048 lds
    v_mfma_f32_16x16x32_bf16 v[100:103], a[84:87], v[232:235], v[100:103]
    s_mul_i32 s21, s82, 294912
    ds_read_b64_tr_b16 a[76:77], v23 offset:8192
    ds_read_b64_tr_b16 a[78:79], v23 offset:8704
    v_mfma_f32_16x16x32_bf16 v[116:119], a[84:87], v[236:239], v[116:119]
    buffer_load_dwordx4 v5, s[28:31], s5 offen offset:3072 lds
    v_mfma_f32_16x16x32_bf16 v[104:107], a[88:91], v[232:235], v[104:107]
    s_mul_i32 s86, s56, 57344
    ds_read_b64_tr_b16 a[80:81], v20 offset:8192
    ds_read_b64_tr_b16 a[82:83], v20 offset:8704
    v_mfma_f32_16x16x32_bf16 v[120:123], a[88:91], v[236:239], v[120:123]
    s_waitcnt lgkmcnt(8)
    v_cvt_pk_bf16_f32 v244, v56, v57
    v_cvt_pk_bf16_f32 v245, v58, v59
    v_mfma_f32_16x16x32_bf16 v[108:111], a[92:95], v[232:235], v[108:111]
    s_lshl3_add_u32 s62, s9, s84
    ds_read_b64_tr_b16 a[84:85], v21 offset:8192
    ds_read_b64_tr_b16 a[86:87], v21 offset:8704
    v_mfma_f32_16x16x32_bf16 v[124:127], a[92:95], v[236:239], v[124:127]
    s_waitcnt lgkmcnt(6)
    v_cvt_pk_bf16_f32 v246, v60, v61
    v_cvt_pk_bf16_f32 v247, v62, v63
    v_mfma_f32_4x4x4_16b_bf16 v[56:59], v[42:43], v[248:249], v[44:47]
    v_mfma_f32_4x4x4_16b_bf16 v[60:63], v[42:43], v[250:251], v[44:47]
    v_accvgpr_write_b32 a27, v155
    v_accvgpr_write_b32 a28, v156
    v_mfma_f32_16x16x32_bf16 v[64:67], a[64:67], v[240:243], v[64:67]
    s_waitcnt vmcnt(8)
    ds_read_b64_tr_b16 a[88:89], v24 offset:8192
    ds_read_b64_tr_b16 a[90:91], v24 offset:8704
    v_mfma_f32_16x16x32_bf16 v[80:83], a[64:67], v[244:247], v[80:83]
    s_nop 0
    ds_read_b64_tr_b16 a[144:145], v30 offset:57344
    ds_read_b64_tr_b16 a[146:147], v30 offset:59392
    v_mfma_f32_16x16x32_bf16 v[68:71], a[68:71], v[240:243], v[68:71]
    s_add_u32 m0, s60, 49152
    ds_read_b64_tr_b16 a[92:93], v25 offset:8192
    ds_read_b64_tr_b16 a[94:95], v25 offset:8704
    v_mfma_f32_16x16x32_bf16 v[84:87], a[68:71], v[244:247], v[84:87]
    buffer_load_dwordx4 v14, s[44:47], s62 offen offset:0 lds
    v_mfma_f32_16x16x32_bf16 v[72:75], a[72:75], v[240:243], v[72:75]
    s_add_u32 s86, s86, s21
    ds_read_b64_tr_b16 a[64:65], v18 offset:12288
    ds_read_b64_tr_b16 a[66:67], v18 offset:12800
    v_mfma_f32_16x16x32_bf16 v[88:91], a[72:75], v[244:247], v[88:91]
    s_waitcnt lgkmcnt(8)
    buffer_load_dwordx4 v15, s[44:47], s62 offen offset:1024 lds
    v_mfma_f32_16x16x32_bf16 v[76:79], a[76:79], v[240:243], v[76:79]
    s_lshl_b32 s87, s56, 14
    ds_read_b64_tr_b16 a[68:69], v19 offset:12288
    ds_read_b64_tr_b16 a[70:71], v19 offset:12800
    v_mfma_f32_16x16x32_bf16 v[92:95], a[76:79], v[244:247], v[92:95]
    s_nop 0
    ds_read_b64_tr_b16 a[148:149], v31 offset:57344
    ds_read_b64_tr_b16 a[150:151], v31 offset:59392
    v_cvt_pk_bf16_f32 v248, v56, v57
    v_cvt_pk_bf16_f32 v249, v58, v59
    v_cvt_pk_bf16_f32 v250, v60, v61
    v_cvt_pk_bf16_f32 v251, v62, v63
    v_mfma_f32_4x4x4_16b_bf16 v[56:59], v[42:43], v[252:253], v[48:51]
    v_mfma_f32_4x4x4_16b_bf16 v[60:63], v[42:43], v[254:255], v[48:51]
    buffer_load_dwordx4 v16, s[44:47], s62 offen offset:2048 lds
    v_mfma_f32_16x16x32_bf16 v[96:99], a[80:83], v[240:243], v[96:99]
    s_add_u32 s87, s87, s21
    ds_read_b64_tr_b16 a[72:73], v22 offset:12288
    ds_read_b64_tr_b16 a[74:75], v22 offset:12800
    v_mfma_f32_16x16x32_bf16 v[112:115], a[80:83], v[244:247], v[112:115]
    s_nop 0
    ds_read_b64_tr_b16 a[152:153], v32 offset:57344
    ds_read_b64_tr_b16 a[154:155], v32 offset:59392
    v_mfma_f32_16x16x32_bf16 v[100:103], a[84:87], v[240:243], v[100:103]
    s_add_u32 s87, s87, 229376
    ds_read_b64_tr_b16 a[76:77], v23 offset:12288
    ds_read_b64_tr_b16 a[78:79], v23 offset:12800
    v_mfma_f32_16x16x32_bf16 v[116:119], a[84:87], v[244:247], v[116:119]
    s_waitcnt lgkmcnt(10)
    buffer_load_dwordx4 v17, s[44:47], s62 offen offset:3072 lds
    v_mfma_f32_16x16x32_bf16 v[104:107], a[88:91], v[240:243], v[104:107]
    s_nop 0
    ds_read_b64_tr_b16 a[80:81], v20 offset:12288
    ds_read_b64_tr_b16 a[82:83], v20 offset:12800
    v_mfma_f32_16x16x32_bf16 v[120:123], a[88:91], v[244:247], v[120:123]
    ds_read_b64_tr_b16 a[156:157], v33 offset:57344
    ds_read_b64_tr_b16 a[158:159], v33 offset:59392
    v_mfma_f32_16x16x32_bf16 v[108:111], a[92:95], v[240:243], v[108:111]
    ds_read_b64_tr_b16 a[84:85], v21 offset:12288
    ds_read_b64_tr_b16 a[86:87], v21 offset:12800
    v_mfma_f32_16x16x32_bf16 v[124:127], a[92:95], v[244:247], v[124:127]
    v_readfirstlane_b32 s72, v38
    s_nop 0
    s_cmp_ge_u32 s72, 9
    s_cbranch_scc0 L_slow_initA
L_back_initA:
    v_cvt_pk_bf16_f32 v252, v56, v57
    v_cvt_pk_bf16_f32 v253, v58, v59
    v_cvt_pk_bf16_f32 v254, v60, v61
    v_cvt_pk_bf16_f32 v255, v62, v63
    v_mfma_f32_16x16x32_bf16 v[64:67], a[64:67], v[248:251], v[64:67]
    ds_read_b64_tr_b16 a[88:89], v24 offset:12288
    ds_read_b64_tr_b16 a[90:91], v24 offset:12800
    v_mfma_f32_16x16x32_bf16 v[80:83], a[64:67], v[252:255], v[80:83]
    s_waitcnt lgkmcnt(4)
    v_accvgpr_write_b32 a29, v157
    v_accvgpr_write_b32 a30, v158
    v_mfma_f32_16x16x32_bf16 v[68:71], a[68:71], v[248:251], v[68:71]
    s_lshl3_add_u32 s62, s12, s62
    ds_read_b64_tr_b16 a[92:93], v25 offset:12288
    ds_read_b64_tr_b16 a[94:95], v25 offset:12800
    v_mfma_f32_16x16x32_bf16 v[84:87], a[68:71], v[252:255], v[84:87]
    s_waitcnt vmcnt(8)
    v_accvgpr_write_b32 a31, v159
    v_accvgpr_write_b32 a32, v160
    v_mfma_f32_16x16x32_bf16 v[72:75], a[72:75], v[248:251], v[72:75]
    s_barrier
    ds_read_b64_tr_b16 a[64:65], v18 offset:16384
    ds_read_b64_tr_b16 a[66:67], v18 offset:16896
    v_mfma_f32_16x16x32_bf16 v[88:91], a[72:75], v[252:255], v[88:91]
    v_accvgpr_write_b32 a33, v161
    v_accvgpr_write_b32 a34, v162
    v_mfma_f32_16x16x32_bf16 v[76:79], a[76:79], v[248:251], v[76:79]
    s_add_u32 m0, s60, 57344
    ds_read_b64_tr_b16 a[68:69], v19 offset:16384
    ds_read_b64_tr_b16 a[70:71], v19 offset:16896
    v_mfma_f32_16x16x32_bf16 v[92:95], a[76:79], v[252:255], v[92:95]
    s_waitcnt lgkmcnt(6)
    buffer_load_dwordx4 v14, s[44:47], s62 offen offset:0 lds
    v_mfma_f32_16x16x32_bf16 v[96:99], a[80:83], v[248:251], v[96:99]
    s_nop 0
    ds_read_b64_tr_b16 a[72:73], v22 offset:16384
    ds_read_b64_tr_b16 a[74:75], v22 offset:16896
    v_mfma_f32_16x16x32_bf16 v[112:115], a[80:83], v[252:255], v[112:115]
    buffer_load_dwordx4 v15, s[44:47], s62 offen offset:1024 lds
    v_mfma_f32_16x16x32_bf16 v[100:103], a[84:87], v[248:251], v[100:103]
    ds_read_b64_tr_b16 a[76:77], v23 offset:16384
    ds_read_b64_tr_b16 a[78:79], v23 offset:16896
    v_mfma_f32_16x16x32_bf16 v[116:119], a[84:87], v[252:255], v[116:119]
    buffer_load_dwordx4 v16, s[44:47], s62 offen offset:2048 lds
    v_mfma_f32_16x16x32_bf16 v[104:107], a[88:91], v[248:251], v[104:107]
    ds_read_b64_tr_b16 a[80:81], v20 offset:16384
    ds_read_b64_tr_b16 a[82:83], v20 offset:16896
    v_mfma_f32_16x16x32_bf16 v[120:123], a[88:91], v[252:255], v[120:123]
    s_waitcnt lgkmcnt(6)
    buffer_load_dwordx4 v17, s[44:47], s62 offen offset:3072 lds
    v_mfma_f32_16x16x32_bf16 v[108:111], a[92:95], v[248:251], v[108:111]
    s_add_u32 s4, s4, 1
    ds_read_b64_tr_b16 a[84:85], v21 offset:16384
    ds_read_b64_tr_b16 a[86:87], v21 offset:16896
    v_mfma_f32_16x16x32_bf16 v[124:127], a[92:95], v[252:255], v[124:127]
    v_accvgpr_write_b32 a35, v163
    v_accvgpr_write_b32 a36, v164
    v_accvgpr_write_b32 a37, v165
    v_accvgpr_write_b32 a38, v166
    v_accvgpr_write_b32 a39, v167
    v_accvgpr_write_b32 a40, v168
    v_accvgpr_write_b32 a41, v169
    v_accvgpr_write_b32 a42, v170
    v_accvgpr_write_b32 a43, v171
    v_accvgpr_write_b32 a44, v172
    v_accvgpr_write_b32 a45, v173
    v_accvgpr_write_b32 a46, v174
    v_accvgpr_write_b32 a47, v175
    v_accvgpr_write_b32 a48, v176
    v_accvgpr_write_b32 a49, v177
    v_accvgpr_write_b32 a50, v178
    v_accvgpr_write_b32 a51, v179
    v_accvgpr_write_b32 a52, v180
    v_accvgpr_write_b32 a53, v181
    v_accvgpr_write_b32 a54, v182
    v_accvgpr_write_b32 a55, v183
    v_accvgpr_write_b32 a56, v184
    v_accvgpr_write_b32 a57, v185
    v_accvgpr_write_b32 a58, v186
    v_accvgpr_write_b32 a59, v187
    v_accvgpr_write_b32 a60, v188
    v_accvgpr_write_b32 a61, v189
    v_accvgpr_write_b32 a62, v190
    v_accvgpr_write_b32 a63, v191
    v_mfma_f32_16x16x32_bf16 v[128:131], a[64:67], a[0:3], 0
    s_and_b32 s4, s4, 7
    ds_read_b64_tr_b16 a[88:89], v24 offset:16384
    ds_read_b64_tr_b16 a[90:91], v24 offset:16896
    v_mfma_f32_16x16x32_bf16 v[144:147], a[64:67], a[4:7], 0
    s_add_u32 s19, s66, 4096
    v_pk_mul_f32 v[72:73], v[64:65], v[72:73]
    v_pk_mul_f32 v[64:65], v[64:65], v[34:35] op_sel:[0,0] op_sel_hi:[1,0]
    v_mfma_f32_16x16x32_bf16 v[132:135], a[68:71], a[0:3], 0
    s_mul_i32 s5, s4, 229376
    ds_read_b64_tr_b16 a[92:93], v25 offset:16384
    ds_read_b64_tr_b16 a[94:95], v25 offset:16896
    v_mfma_f32_16x16x32_bf16 v[148:151], a[68:71], a[4:7], 0
    s_waitcnt lgkmcnt(6)
    v_exp_f32 v64, v64
    v_exp_f32 v65, v65
    v_pk_mul_f32 v[74:75], v[66:67], v[74:75]
    v_pk_mul_f32 v[66:67], v[66:67], v[34:35] op_sel:[0,0] op_sel_hi:[1,0]
    v_pk_mul_f32 v[76:77], v[68:69], v[76:77]
    v_mfma_f32_16x16x32_bf16 v[136:139], a[72:75], a[0:3], 0
    s_add_u32 m0, s60, 40960
    ds_read_b64_tr_b16 a[64:65], v18 offset:20480
    ds_read_b64_tr_b16 a[66:67], v18 offset:20992
    v_mfma_f32_16x16x32_bf16 v[152:155], a[72:75], a[4:7], 0
    buffer_load_dwordx4 v2, s[28:31], s5 offen offset:0 lds
    v_exp_f32 v66, v66
    v_exp_f32 v67, v67
    v_pk_mul_f32 v[68:69], v[68:69], v[34:35] op_sel:[0,0] op_sel_hi:[1,0]
    v_pk_fma_f32 v[64:65], v[64:65], v[36:37], v[36:37] op_sel:[0,0,0] op_sel_hi:[1,0,0]
    v_mfma_f32_16x16x32_bf16 v[140:143], a[76:79], a[0:3], 0
    ds_read_b64_tr_b16 a[68:69], v19 offset:20480
    ds_read_b64_tr_b16 a[70:71], v19 offset:20992
    v_mfma_f32_16x16x32_bf16 v[156:159], a[76:79], a[4:7], 0
    s_waitcnt vmcnt(5)
    buffer_load_dwordx4 v3, s[28:31], s5 offen offset:1024 lds
    ds_read_b64_tr_b16 a[160:161], v30 offset:49152
    ds_read_b64_tr_b16 a[162:163], v30 offset:51200
    v_exp_f32 v68, v68
    v_pk_mul_f32 v[78:79], v[70:71], v[78:79]
    v_pk_mul_f32 v[70:71], v[70:71], v[34:35] op_sel:[0,0] op_sel_hi:[1,0]
    v_mfma_f32_16x16x32_bf16 v[160:163], a[80:83], a[0:3], 0
    ds_read_b64_tr_b16 a[72:73], v22 offset:20480
    ds_read_b64_tr_b16 a[74:75], v22 offset:20992
    v_mfma_f32_16x16x32_bf16 v[176:179], a[80:83], a[4:7], 0
    s_waitcnt lgkmcnt(8)
    buffer_load_dwordx4 v4, s[28:31], s5 offen offset:2048 lds
    ds_read_b64_tr_b16 a[164:165], v31 offset:49152
    ds_read_b64_tr_b16 a[166:167], v31 offset:51200
    v_exp_f32 v69, v69
    v_pk_fma_f32 v[66:67], v[66:67], v[36:37], v[36:37] op_sel:[0,0,0] op_sel_hi:[1,0,0]
    v_pk_mul_f32 v[88:89], v[80:81], v[88:89]
    v_mfma_f32_16x16x32_bf16 v[164:167], a[84:87], a[0:3], 0
    ds_read_b64_tr_b16 a[76:77], v23 offset:20480
    ds_read_b64_tr_b16 a[78:79], v23 offset:20992
    v_mfma_f32_16x16x32_bf16 v[180:183], a[84:87], a[4:7], 0
    buffer_load_dwordx4 v5, s[28:31], s5 offen offset:3072 lds
    ds_read_b64_tr_b16 a[168:169], v32 offset:49152
    ds_read_b64_tr_b16 a[170:171], v32 offset:51200
    v_rcp_f32_e64 v64, v64
    v_pk_mul_f32 v[80:81], v[80:81], v[34:35] op_sel:[0,1] op_sel_hi:[1,1]
    v_pk_fma_f32 v[68:69], v[68:69], v[36:37], v[36:37] op_sel:[0,0,0] op_sel_hi:[1,0,0]
    v_mfma_f32_16x16x32_bf16 v[168:171], a[88:91], a[0:3], 0
    s_add_u32 s4, s4, 1
    ds_read_b64_tr_b16 a[80:81], v20 offset:20480
    ds_read_b64_tr_b16 a[82:83], v20 offset:20992
    v_mfma_f32_16x16x32_bf16 v[184:187], a[88:91], a[4:7], 0
    s_nop 0
    ds_read_b64_tr_b16 a[172:173], v33 offset:49152
    ds_read_b64_tr_b16 a[174:175], v33 offset:51200
    v_rcp_f32 v65, v65
    v_exp_f32 v70, v70
    v_pk_mul_f32 v[72:73], v[64:65], v[72:73]
    v_pk_mul_f32 v[90:91], v[82:83], v[90:91]
    v_mfma_f32_16x16x32_bf16 v[172:175], a[92:95], a[0:3], 0
    s_and_b32 s4, s4, 7
    ds_read_b64_tr_b16 a[84:85], v21 offset:20480
    ds_read_b64_tr_b16 a[86:87], v21 offset:20992
    v_mfma_f32_16x16x32_bf16 v[188:191], a[92:95], a[4:7], 0
    s_waitcnt lgkmcnt(12)
    v_exp_f32 v71, v71
    v_rcp_f32 v66, v66
    v_rcp_f32_e64 v67, v67
    v_pk_mul_f32 v[82:83], v[82:83], v[34:35] op_sel:[0,1] op_sel_hi:[1,1]
    v_pk_fma_f32 v[70:71], v[70:71], v[36:37], v[36:37] op_sel:[0,0,0] op_sel_hi:[1,0,0]
    v_mfma_f32_16x16x32_bf16 v[128:131], a[64:67], a[8:11], v[128:131]
    s_mul_i32 s5, s4, 229376
    ds_read_b64_tr_b16 a[88:89], v24 offset:20480
    ds_read_b64_tr_b16 a[90:91], v24 offset:20992
    v_mfma_f32_16x16x32_bf16 v[144:147], a[64:67], a[12:15], v[144:147]
    v_exp_f32 v80, v80
    v_exp_f32 v81, v81
    v_rcp_f32_e64 v68, v68
    v_pk_mul_f32 v[74:75], v[66:67], v[74:75]
    v_pk_mul_f32 v[92:93], v[84:85], v[92:93]
    v_mfma_f32_16x16x32_bf16 v[132:135], a[68:71], a[8:11], v[132:135]
    s_mov_b32 m0, s60
    ds_read_b64_tr_b16 a[92:93], v25 offset:20480
    ds_read_b64_tr_b16 a[94:95], v25 offset:20992
    v_mfma_f32_16x16x32_bf16 v[148:151], a[68:71], a[12:15], v[148:151]
    buffer_load_dwordx4 v2, s[28:31], s5 offen offset:0 lds
    v_rcp_f32 v69, v69
    v_cvt_pk_bf16_f32 v64, v72, v73
    v_pk_mul_f32 v[84:85], v[84:85], v[34:35] op_sel:[0,1] op_sel_hi:[1,1]
    v_pk_fma_f32 v[80:81], v[80:81], v[36:37], v[36:37] op_sel:[0,1,1] op_sel_hi:[1,1,1]
    v_pk_mul_f32 v[76:77], v[68:69], v[76:77]
    v_mfma_f32_16x16x32_bf16 v[136:139], a[72:75], a[8:11], v[136:139]
    s_waitcnt vmcnt(5)
    ds_read_b64_tr_b16 a[64:65], v18 offset:24576
    ds_read_b64_tr_b16 a[66:67], v18 offset:25088
    v_mfma_f32_16x16x32_bf16 v[152:155], a[72:75], a[12:15], v[152:155]
    s_waitcnt lgkmcnt(6)
    buffer_load_dwordx4 v3, s[28:31], s5 offen offset:1024 lds
    ds_read_b64_tr_b16 a[176:177], v30 offset:57344
    ds_read_b64_tr_b16 a[178:179], v30 offset:59392
    v_exp_f32_e64 v82, v82
    v_pk_mul_f32 v[94:95], v[86:87], v[94:95]
    v_pk_mul_f32 v[86:87], v[86:87], v[34:35] op_sel:[0,1] op_sel_hi:[1,1]
    v_mfma_f32_16x16x32_bf16 v[140:143], a[76:79], a[8:11], v[140:143]
    ds_read_b64_tr_b16 a[68:69], v19 offset:24576
    ds_read_b64_tr_b16 a[70:71], v19 offset:25088
    v_mfma_f32_16x16x32_bf16 v[156:159], a[76:79], a[12:15], v[156:159]
    buffer_load_dwordx4 v4, s[28:31], s5 offen offset:2048 lds
    ds_read_b64_tr_b16 a[180:181], v31 offset:57344
    ds_read_b64_tr_b16 a[182:183], v31 offset:59392
    v_exp_f32_e64 v83, v83
    v_pk_mul_f32 v[104:105], v[96:97], v[104:105]
    v_pk_fma_f32 v[82:83], v[82:83], v[36:37], v[36:37] op_sel:[0,1,1] op_sel_hi:[1,1,1]
    v_mfma_f32_16x16x32_bf16 v[160:163], a[80:83], a[8:11], v[160:163]
    ds_read_b64_tr_b16 a[72:73], v22 offset:24576
    ds_read_b64_tr_b16 a[74:75], v22 offset:25088
    v_mfma_f32_16x16x32_bf16 v[176:179], a[80:83], a[12:15], v[176:179]
    buffer_load_dwordx4 v5, s[28:31], s5 offen offset:3072 lds
    ds_read_b64_tr_b16 a[184:185], v32 offset:57344
    ds_read_b64_tr_b16 a[186:187], v32 offset:59392
    v_rcp_f32_e64 v70, v70
    v_pk_mul_f32 v[96:97], v[96:97], v[34:35] op_sel:[0,0] op_sel_hi:[1,0]
    v_cvt_pk_bf16_f32 v65, v74, v75
    v_mfma_f32_16x16x32_bf16 v[164:167], a[84:87], a[8:11], v[164:167]
    ds_read_b64_tr_b16 a[76:77], v23 offset:24576
    ds_read_b64_tr_b16 a[78:79], v23 offset:25088
    v_mfma_f32_16x16x32_bf16 v[180:183], a[84:87], a[12:15], v[180:183]
    s_waitcnt lgkmcnt(12)
    ds_read_b64_tr_b16 a[188:189], v33 offset:57344
    ds_read_b64_tr_b16 a[190:191], v33 offset:59392
    v_rcp_f32 v71, v71
    v_exp_f32_e64 v84, v84
    v_pk_mul_f32 v[78:79], v[70:71], v[78:79]
    v_cvt_pk_bf16_f32 v66, v76, v77
    v_mfma_f32_16x16x32_bf16 v[168:171], a[88:91], a[8:11], v[168:171]
    s_lshl3_add_u32 s62, s14, s62
    ds_read_b64_tr_b16 a[80:81], v20 offset:24576
    ds_read_b64_tr_b16 a[82:83], v20 offset:25088
    v_mfma_f32_16x16x32_bf16 v[184:187], a[88:91], a[12:15], v[184:187]
    v_exp_f32 v85, v85
    v_rcp_f32 v80, v80
    v_rcp_f32 v81, v81
    v_pk_fma_f32 v[84:85], v[84:85], v[36:37], v[36:37] op_sel:[0,1,1] op_sel_hi:[1,1,1]
    v_pk_mul_f32 v[88:89], v[80:81], v[88:89]
    v_mfma_f32_16x16x32_bf16 v[172:175], a[92:95], a[8:11], v[172:175]
    s_add_u32 m0, s60, 49152
    ds_read_b64_tr_b16 a[84:85], v21 offset:24576
    ds_read_b64_tr_b16 a[86:87], v21 offset:25088
    v_mfma_f32_16x16x32_bf16 v[188:191], a[92:95], a[12:15], v[188:191]
    buffer_load_dwordx4 v14, s[44:47], s62 offen offset:0 lds
    v_exp_f32 v86, v86
    v_exp_f32 v87, v87
    v_rcp_f32_e64 v82, v82
    v_mfma_f32_16x16x32_bf16 v[128:131], a[64:67], a[16:19], v[128:131]
    ds_read_b64_tr_b16 a[88:89], v24 offset:24576
    ds_read_b64_tr_b16 a[90:91], v24 offset:25088
    v_mfma_f32_16x16x32_bf16 v[144:147], a[64:67], a[20:23], v[144:147]
    s_waitcnt lgkmcnt(8)
    buffer_load_dwordx4 v15, s[44:47], s62 offen offset:1024 lds
    v_rcp_f32 v83, v83
    v_cvt_pk_bf16_f32 v67, v78, v79
    v_mfma_f32_16x16x32_bf16 v[132:135], a[68:71], a[16:19], v[132:135]
    ds_read_b64_tr_b16 a[92:93], v25 offset:24576
    ds_read_b64_tr_b16 a[94:95], v25 offset:25088
    buffer_store_dwordx4 v[64:67], v1, s[36:39], s66 offen offset:0 sc1
    v_mfma_f32_16x16x32_bf16 v[148:151], a[68:71], a[20:23], v[148:151]
    buffer_load_dwordx4 v16, s[44:47], s62 offen offset:2048 lds
    v_exp_f32 v96, v96
    v_exp_f32 v97, v97
    v_pk_mul_f32 v[106:107], v[98:99], v[106:107]
    v_pk_mul_f32 v[98:99], v[98:99], v[34:35] op_sel:[0,0] op_sel_hi:[1,0]
    v_mfma_f32_16x16x32_bf16 v[136:139], a[72:75], a[16:19], v[136:139]
    ds_read_b64_tr_b16 a[64:65], v18 offset:28672
    ds_read_b64_tr_b16 a[66:67], v18 offset:29184
    v_mfma_f32_16x16x32_bf16 v[152:155], a[72:75], a[20:23], v[152:155]
    buffer_load_dwordx4 v17, s[44:47], s62 offen offset:3072 lds
    v_rcp_f32 v84, v84
    v_rcp_f32 v85, v85
    v_pk_fma_f32 v[86:87], v[86:87], v[36:37], v[36:37] op_sel:[0,1,1] op_sel_hi:[1,1,1]
    v_pk_mul_f32 v[90:91], v[82:83], v[90:91]
    v_mfma_f32_16x16x32_bf16 v[140:143], a[76:79], a[16:19], v[140:143]
    ds_read_b64_tr_b16 a[68:69], v19 offset:28672
    ds_read_b64_tr_b16 a[70:71], v19 offset:29184
    v_mfma_f32_16x16x32_bf16 v[156:159], a[76:79], a[20:23], v[156:159]
    s_waitcnt lgkmcnt(6)
    v_cvt_pk_bf16_f32 v80, v88, v89
    v_exp_f32 v98, v98
    v_exp_f32_e64 v99, v99
    v_pk_mul_f32 v[108:109], v[100:101], v[108:109]
    v_pk_mul_f32 v[100:101], v[100:101], v[34:35] op_sel:[0,0] op_sel_hi:[1,0]
    v_pk_fma_f32 v[96:97], v[96:97], v[36:37], v[36:37] op_sel:[0,0,0] op_sel_hi:[1,0,0]
    v_mfma_f32_16x16x32_bf16 v[160:163], a[80:83], a[16:19], v[160:163]
    s_lshl3_add_u32 s62, s13, s62
    ds_read_b64_tr_b16 a[72:73], v22 offset:28672
    ds_read_b64_tr_b16 a[74:75], v22 offset:29184
    v_mfma_f32_16x16x32_bf16 v[176:179], a[80:83], a[20:23], v[176:179]
    v_rcp_f32 v86, v86
    v_rcp_f32_e64 v87, v87
    v_cvt_pk_bf16_f32 v81, v90, v91
    v_pk_mul_f32 v[92:93], v[84:85], v[92:93]
    v_pk_mul_f32 v[110:111], v[102:103], v[110:111]
    v_pk_mul_f32 v[102:103], v[102:103], v[34:35] op_sel:[0,0] op_sel_hi:[1,0]
    v_mfma_f32_16x16x32_bf16 v[164:167], a[84:87], a[16:19], v[164:167]
    s_add_u32 m0, s60, 57344
    ds_read_b64_tr_b16 a[76:77], v23 offset:28672
    ds_read_b64_tr_b16 a[78:79], v23 offset:29184
    v_mfma_f32_16x16x32_bf16 v[180:183], a[84:87], a[20:23], v[180:183]
    buffer_load_dwordx4 v14, s[44:47], s62 offen offset:0 lds
    v_exp_f32 v100, v100
    v_exp_f32 v101, v101
    v_pk_fma_f32 v[98:99], v[98:99], v[36:37], v[36:37] op_sel:[0,0,0] op_sel_hi:[1,0,0]
    v_pk_mul_f32 v[94:95], v[86:87], v[94:95]
    v_mfma_f32_16x16x32_bf16 v[168:171], a[88:91], a[16:19], v[168:171]
    ds_read_b64_tr_b16 a[80:81], v20 offset:28672
    ds_read_b64_tr_b16 a[82:83], v20 offset:29184
    v_mfma_f32_16x16x32_bf16 v[184:187], a[88:91], a[20:23], v[184:187]
    s_waitcnt lgkmcnt(6)
    buffer_load_dwordx4 v15, s[44:47], s62 offen offset:1024 lds
    v_rcp_f32 v96, v96
    v_rcp_f32_e64 v97, v97
    v_pk_mul_f32 v[120:121], v[112:113], v[120:121]
    v_pk_mul_f32 v[112:113], v[112:113], v[34:35] op_sel:[0,1] op_sel_hi:[1,1]
    v_mfma_f32_16x16x32_bf16 v[172:175], a[92:95], a[16:19], v[172:175]
    ds_read_b64_tr_b16 a[84:85], v21 offset:28672
    ds_read_b64_tr_b16 a[86:87], v21 offset:29184
    v_mfma_f32_16x16x32_bf16 v[188:191], a[92:95], a[20:23], v[188:191]
    buffer_load_dwordx4 v16, s[44:47], s62 offen offset:2048 lds
    v_cvt_pk_bf16_f32 v82, v92, v93
    v_exp_f32_e64 v102, v102
    v_pk_fma_f32 v[100:101], v[100:101], v[36:37], v[36:37] op_sel:[0,0,0] op_sel_hi:[1,0,0]
    v_pk_mul_f32 v[104:105], v[96:97], v[104:105]
    v_cvt_pk_bf16_f32 v83, v94, v95
    v_mfma_f32_16x16x32_bf16 v[128:131], a[64:67], a[24:27], v[128:131]
    ds_read_b64_tr_b16 a[88:89], v24 offset:28672
    ds_read_b64_tr_b16 a[90:91], v24 offset:29184
    v_mfma_f32_16x16x32_bf16 v[144:147], a[64:67], a[28:31], v[144:147]
    buffer_load_dwordx4 v17, s[44:47], s62 offen offset:3072 lds
    v_exp_f32 v103, v103
    v_rcp_f32 v98, v98
    v_rcp_f32_e64 v99, v99
    v_mfma_f32_16x16x32_bf16 v[132:135], a[68:71], a[24:27], v[132:135]
    ds_read_b64_tr_b16 a[92:93], v25 offset:28672
    ds_read_b64_tr_b16 a[94:95], v25 offset:29184
    buffer_store_dwordx4 v[80:83], v1, s[36:39], s66 offen offset:1024 sc1
    v_mfma_f32_16x16x32_bf16 v[148:151], a[68:71], a[28:31], v[148:151]
    s_waitcnt lgkmcnt(6) vmcnt(14)
    v_exp_f32 v112, v112
    v_exp_f32 v113, v113
    v_rcp_f32 v100, v100
    v_pk_mul_f32 v[122:123], v[114:115], v[122:123]
    v_pk_mul_f32 v[114:115], v[114:115], v[34:35] op_sel:[0,1] op_sel_hi:[1,1]
    v_mfma_f32_16x16x32_bf16 v[136:139], a[72:75], a[24:27], v[136:139]
    s_barrier
    ds_read_b64_tr_b16 a[64:65], v18 offset:32768
    ds_read_b64_tr_b16 a[66:67], v18 offset:33280
    v_mfma_f32_16x16x32_bf16 v[152:155], a[72:75], a[28:31], v[152:155]
    v_rcp_f32 v101, v101
    v_cvt_pk_bf16_f32 v96, v104, v105
    v_exp_f32_e64 v114, v114
    v_pk_fma_f32 v[102:103], v[102:103], v[36:37], v[36:37] op_sel:[0,0,0] op_sel_hi:[1,0,0]
    v_pk_mul_f32 v[106:107], v[98:99], v[106:107]
    v_pk_mul_f32 v[124:125], v[116:117], v[124:125]
    v_mfma_f32_16x16x32_bf16 v[140:143], a[76:79], a[24:27], v[140:143]
    s_add_u32 s4, s4, 1
    ds_read_b64_tr_b16 a[68:69], v19 offset:32768
    ds_read_b64_tr_b16 a[70:71], v19 offset:33280
    v_mfma_f32_16x16x32_bf16 v[156:159], a[76:79], a[28:31], v[156:159]
    v_exp_f32 v115, v115
    v_rcp_f32 v102, v102
    v_rcp_f32 v103, v103
    v_pk_mul_f32 v[116:117], v[116:117], v[34:35] op_sel:[0,1] op_sel_hi:[1,1]
    v_pk_fma_f32 v[112:113], v[112:113], v[36:37], v[36:37] op_sel:[0,1,1] op_sel_hi:[1,1,1]
    v_mfma_f32_16x16x32_bf16 v[160:163], a[80:83], a[24:27], v[160:163]
    s_and_b32 s4, s4, 7
    ds_read_b64_tr_b16 a[72:73], v22 offset:32768
    ds_read_b64_tr_b16 a[74:75], v22 offset:33280
    v_mfma_f32_16x16x32_bf16 v[176:179], a[80:83], a[28:31], v[176:179]
    s_waitcnt lgkmcnt(6)
    v_cvt_pk_bf16_f32 v97, v106, v107
    v_exp_f32 v116, v116
    v_exp_f32 v117, v117
    v_pk_mul_f32 v[108:109], v[100:101], v[108:109]
    v_pk_mul_f32 v[126:127], v[118:119], v[126:127]
    v_pk_mul_f32 v[118:119], v[118:119], v[34:35] op_sel:[0,1] op_sel_hi:[1,1]
    v_mfma_f32_16x16x32_bf16 v[164:167], a[84:87], a[24:27], v[164:167]
    s_mul_i32 s5, s4, 229376
    ds_read_b64_tr_b16 a[76:77], v23 offset:32768
    ds_read_b64_tr_b16 a[78:79], v23 offset:33280
    v_mfma_f32_16x16x32_bf16 v[180:183], a[84:87], a[28:31], v[180:183]
    v_rcp_f32 v112, v112
    v_rcp_f32 v113, v113
    v_cvt_pk_bf16_f32 v98, v108, v109
    v_pk_fma_f32 v[114:115], v[114:115], v[36:37], v[36:37] op_sel:[0,1,1] op_sel_hi:[1,1,1]
    v_pk_mul_f32 v[110:111], v[102:103], v[110:111]
    v_pk_fma_f32 v[116:117], v[116:117], v[36:37], v[36:37] op_sel:[0,1,1] op_sel_hi:[1,1,1]
    v_mfma_f32_16x16x32_bf16 v[168:171], a[88:91], a[24:27], v[168:171]
    s_add_u32 m0, s60, 8192
    ds_read_b64_tr_b16 a[80:81], v20 offset:32768
    ds_read_b64_tr_b16 a[82:83], v20 offset:33280
    v_mfma_f32_16x16x32_bf16 v[184:187], a[88:91], a[28:31], v[184:187]
L_padA3:
    s_cbranch_execz L_padret
    buffer_load_dwordx4 v2, s[28:31], s5 offen offset:0 lds
    v_exp_f32 v118, v118
    v_exp_f32_e64 v119, v119
    v_pk_mul_f32 v[120:121], v[112:113], v[120:121]
    v_cvt_pk_bf16_f32 v99, v110, v111
    v_mfma_f32_16x16x32_bf16 v[172:175], a[92:95], a[24:27], v[172:175]
    ds_read_b64_tr_b16 a[84:85], v21 offset:32768
    ds_read_b64_tr_b16 a[86:87], v21 offset:33280
    v_mfma_f32_16x16x32_bf16 v[188:191], a[92:95], a[28:31], v[188:191]
    s_waitcnt lgkmcnt(6)
    buffer_load_dwordx4 v3, s[28:31], s5 offen offset:1024 lds
    v_rcp_f32 v114, v114
    v_rcp_f32_e64 v115, v115
    v_mfma_f32_16x16x32_bf16 v[128:131], a[64:67], a[32:35], v[128:131]
    ds_read_b64_tr_b16 a[88:89], v24 offset:32768
    ds_read_b64_tr_b16 a[90:91], v24 offset:33280
    buffer_store_dwordx4 v[96:99], v1, s[36:39], s19 offen offset:0 sc1
    v_mfma_f32_16x16x32_bf16 v[144:147], a[64:67], a[36:39], v[144:147]
    s_waitcnt vmcnt(8)
    buffer_load_dwordx4 v4, s[28:31], s5 offen offset:2048 lds
    ds_read_b64_tr_b16 a[192:193], v30 offset:49152
    ds_read_b64_tr_b16 a[194:195], v30 offset:51200
    v_rcp_f32 v116, v116
    v_pk_fma_f32 v[118:119], v[118:119], v[36:37], v[36:37] op_sel:[0,1,1] op_sel_hi:[1,1,1]
    v_pk_mul_f32 v[122:123], v[114:115], v[122:123]
    v_mfma_f32_16x16x32_bf16 v[132:135], a[68:71], a[32:35], v[132:135]
    ds_read_b64_tr_b16 a[92:93], v25 offset:32768
    ds_read_b64_tr_b16 a[94:95], v25 offset:33280
    v_mfma_f32_16x16x32_bf16 v[148:151], a[68:71], a[36:39], v[148:151]
    ds_read_b64_tr_b16 a[196:197], v31 offset:49152
    ds_read_b64_tr_b16 a[198:199], v31 offset:51200
    v_rcp_f32_e64 v117, v117
    v_cvt_pk_bf16_f32 v112, v120, v121
    v_pk_mul_f32 v[124:125], v[116:117], v[124:125]
    v_rcp_f32_e64 v118, v118
    v_mfma_f32_16x16x32_bf16 v[136:139], a[72:75], a[32:35], v[136:139]
    ds_read_b64_tr_b16 a[64:65], v18 offset:36864
    ds_read_b64_tr_b16 a[66:67], v18 offset:37376
    v_mfma_f32_16x16x32_bf16 v[152:155], a[72:75], a[36:39], v[152:155]
    s_waitcnt lgkmcnt(10)
    buffer_load_dwordx4 v5, s[28:31], s5 offen offset:3072 lds
    ds_read_b64_tr_b16 a[200:201], v32 offset:49152
    ds_read_b64_tr_b16 a[202:203], v32 offset:51200
    v_rcp_f32 v119, v119
    v_cvt_pk_bf16_f32 v113, v122, v123
    v_pk_mul_f32 v[126:127], v[118:119], v[126:127]
    v_mfma_f32_16x16x32_bf16 v[140:143], a[76:79], a[32:35], v[140:143]
    s_add_u32 s4, s4, 1
    ds_read_b64_tr_b16 a[68:69], v19 offset:36864
    ds_read_b64_tr_b16 a[70:71], v19 offset:37376
    v_mfma_f32_16x16x32_bf16 v[156:159], a[76:79], a[36:39], v[156:159]
    s_nop 0
    ds_read_b64_tr_b16 a[204:205], v33 offset:49152
    ds_read_b64_tr_b16 a[206:207], v33 offset:51200
    v_cvt_pk_bf16_f32 v114, v124, v125
    v_cvt_pk_bf16_f32 v115, v126, v127
    s_and_b32 s4, s4, 7
    s_mul_i32 s5, s4, 229376
    s_add_u32 m0, s60, 16384
    v_mfma_f32_16x16x32_bf16 v[160:163], a[80:83], a[32:35], v[160:163]
    s_nop 0
    ds_read_b64_tr_b16 a[72:73], v22 offset:36864
    ds_read_b64_tr_b16 a[74:75], v22 offset:37376
    buffer_store_dwordx4 v[112:115], v1, s[36:39], s19 offen offset:1024 sc1
    v_mfma_f32_16x16x32_bf16 v[176:179], a[80:83], a[36:39], v[176:179]
    buffer_load_dwordx4 v2, s[28:31], s5 offen offset:0 lds
    v_mfma_f32_16x16x32_bf16 v[164:167], a[84:87], a[32:35], v[164:167]
    s_sub_u32 s73, s99, s60
    ds_read_b64_tr_b16 a[76:77], v23 offset:36864
    ds_read_b64_tr_b16 a[78:79], v23 offset:37376
    v_mfma_f32_16x16x32_bf16 v[180:183], a[84:87], a[36:39], v[180:183]
    s_waitcnt lgkmcnt(10)
    v_add_u32 v48, s73, v30
    v_add_u32 v49, s73, v31
    v_mfma_f32_16x16x32_bf16 v[168:171], a[88:91], a[32:35], v[168:171]
    ds_read_b64_tr_b16 a[80:81], v20 offset:36864
    ds_read_b64_tr_b16 a[82:83], v20 offset:37376
    v_mfma_f32_16x16x32_bf16 v[184:187], a[88:91], a[36:39], v[184:187]
    v_add_u32 v50, s73, v32
    v_add_u32 v51, s73, v33
    v_mfma_f32_16x16x32_bf16 v[172:175], a[92:95], a[32:35], v[172:175]
    s_waitcnt vmcnt(8)
    ds_read_b64_tr_b16 a[84:85], v21 offset:36864
    ds_read_b64_tr_b16 a[86:87], v21 offset:37376
    v_mfma_f32_16x16x32_bf16 v[188:191], a[92:95], a[36:39], v[188:191]
    buffer_load_dwordx4 v3, s[28:31], s5 offen offset:1024 lds
    v_mfma_f32_16x16x32_bf16 v[128:131], a[64:67], a[40:43], v[128:131]
    s_nop 0
    ds_read_b64_tr_b16 a[88:89], v24 offset:36864
    ds_read_b64_tr_b16 a[90:91], v24 offset:37376
    v_mfma_f32_16x16x32_bf16 v[144:147], a[64:67], a[44:47], v[144:147]
    s_waitcnt lgkmcnt(6)
    ds_read_b64_tr_b16 a[208:209], v30 offset:57344
    ds_read_b64_tr_b16 a[210:211], v30 offset:59392
    v_mfma_f32_16x16x32_bf16 v[132:135], a[68:71], a[40:43], v[132:135]
    s_nop 0
    ds_read_b64_tr_b16 a[92:93], v25 offset:36864
    ds_read_b64_tr_b16 a[94:95], v25 offset:37376
    v_mfma_f32_16x16x32_bf16 v[148:151], a[68:71], a[44:47], v[148:151]
    buffer_load_dwordx4 v4, s[28:31], s5 offen offset:2048 lds
    v_mfma_f32_16x16x32_bf16 v[136:139], a[72:75], a[40:43], v[136:139]
    ds_read_b64_tr_b16 a[64:65], v18 offset:40960
    ds_read_b64_tr_b16 a[66:67], v18 offset:41472
    v_mfma_f32_16x16x32_bf16 v[152:155], a[72:75], a[44:47], v[152:155]
    ds_read_b64_tr_b16 a[212:213], v31 offset:57344
    ds_read_b64_tr_b16 a[214:215], v31 offset:59392
    v_mfma_f32_16x16x32_bf16 v[140:143], a[76:79], a[40:43], v[140:143]
    ds_read_b64_tr_b16 a[68:69], v19 offset:40960
    ds_read_b64_tr_b16 a[70:71], v19 offset:41472
    v_mfma_f32_16x16x32_bf16 v[156:159], a[76:79], a[44:47], v[156:159]
    s_waitcnt lgkmcnt(10)
    ds_read_b64_tr_b16 a[216:217], v32 offset:57344
    ds_read_b64_tr_b16 a[218:219], v32 offset:59392
    v_mfma_f32_16x16x32_bf16 v[160:163], a[80:83], a[40:43], v[160:163]
    s_nop 0
    ds_read_b64_tr_b16 a[72:73], v22 offset:40960
    ds_read_b64_tr_b16 a[74:75], v22 offset:41472
    v_mfma_f32_16x16x32_bf16 v[176:179], a[80:83], a[44:47], v[176:179]
    buffer_load_dwordx4 v5, s[28:31], s5 offen offset:3072 lds
    v_mfma_f32_16x16x32_bf16 v[164:167], a[84:87], a[40:43], v[164:167]
    ds_read_b64_tr_b16 a[76:77], v23 offset:40960
    ds_read_b64_tr_b16 a[78:79], v23 offset:41472
    v_mfma_f32_16x16x32_bf16 v[180:183], a[84:87], a[44:47], v[180:183]
    ds_read_b64_tr_b16 a[220:221], v33 offset:57344
    ds_read_b64_tr_b16 a[222:223], v33 offset:59392
    v_mfma_f32_16x16x32_bf16 v[168:171], a[88:91], a[40:43], v[168:171]
    s_lshl3_add_u32 s62, s16, s62
    ds_read_b64_tr_b16 a[80:81], v20 offset:40960
    ds_read_b64_tr_b16 a[82:83], v20 offset:41472
    v_mfma_f32_16x16x32_bf16 v[184:187], a[88:91], a[44:47], v[184:187]
    s_waitcnt lgkmcnt(10)
    s_add_u32 m0, s60, 49152
    v_mfma_f32_16x16x32_bf16 v[172:175], a[92:95], a[40:43], v[172:175]
    ds_read_b64_tr_b16 a[84:85], v21 offset:40960
    ds_read_b64_tr_b16 a[86:87], v21 offset:41472
    v_mfma_f32_16x16x32_bf16 v[188:191], a[92:95], a[44:47], v[188:191]
    buffer_load_dwordx4 v14, s[44:47], s62 offen offset:0 lds
    v_mfma_f32_16x16x32_bf16 v[128:131], a[64:67], a[48:51], v[128:131]
    ds_read_b64_tr_b16 a[88:89], v24 offset:40960
    ds_read_b64_tr_b16 a[90:91], v24 offset:41472
    v_mfma_f32_16x16x32_bf16 v[144:147], a[64:67], a[52:55], v[144:147]
    v_mfma_f32_16x16x32_bf16 v[132:135], a[68:71], a[48:51], v[132:135]
    ds_read_b64_tr_b16 a[92:93], v25 offset:40960
    ds_read_b64_tr_b16 a[94:95], v25 offset:41472
    v_mfma_f32_16x16x32_bf16 v[148:151], a[68:71], a[52:55], v[148:151]
    s_waitcnt lgkmcnt(6)
    v_mfma_f32_16x16x32_bf16 v[136:139], a[72:75], a[48:51], v[136:139]
    s_nop 0
    ds_read_b64_tr_b16 a[64:65], v18 offset:45056
    ds_read_b64_tr_b16 a[66:67], v18 offset:45568
    v_mfma_f32_16x16x32_bf16 v[152:155], a[72:75], a[52:55], v[152:155]
    v_mfma_f32_16x16x32_bf16 v[140:143], a[76:79], a[48:51], v[140:143]
    ds_read_b64_tr_b16 a[68:69], v19 offset:45056
    ds_read_b64_tr_b16 a[70:71], v19 offset:45568
    v_mfma_f32_16x16x32_bf16 v[156:159], a[76:79], a[52:55], v[156:159]
    v_mfma_f32_16x16x32_bf16 v[160:163], a[80:83], a[48:51], v[160:163]
    ds_read_b64_tr_b16 a[72:73], v22 offset:45056
    ds_read_b64_tr_b16 a[74:75], v22 offset:45568
    v_mfma_f32_16x16x32_bf16 v[176:179], a[80:83], a[52:55], v[176:179]
    s_waitcnt lgkmcnt(6)
    v_mfma_f32_16x16x32_bf16 v[164:167], a[84:87], a[48:51], v[164:167]
    s_nop 0
    ds_read_b64_tr_b16 a[76:77], v23 offset:45056
    ds_read_b64_tr_b16 a[78:79], v23 offset:45568
    v_mfma_f32_16x16x32_bf16 v[180:183], a[84:87], a[52:55], v[180:183]
    buffer_load_dwordx4 v15, s[44:47], s62 offen offset:1024 lds
    v_mfma_f32_16x16x32_bf16 v[168:171], a[88:91], a[48:51], v[168:171]
    ds_read_b64_tr_b16 a[80:81], v20 offset:45056
    ds_read_b64_tr_b16 a[82:83], v20 offset:45568
    v_mfma_f32_16x16x32_bf16 v[184:187], a[88:91], a[52:55], v[184:187]
    v_mfma_f32_16x16x32_bf16 v[172:175], a[92:95], a[48:51], v[172:175]
    ds_read_b64_tr_b16 a[84:85], v21 offset:45056
    ds_read_b64_tr_b16 a[86:87], v21 offset:45568
    v_mfma_f32_16x16x32_bf16 v[188:191], a[92:95], a[52:55], v[188:191]
    s_waitcnt lgkmcnt(6)
    buffer_load_dwordx4 v16, s[44:47], s62 offen offset:2048 lds
    v_mfma_f32_16x16x32_bf16 v[128:131], a[64:67], a[56:59], v[128:131]
    s_nop 0
    ds_read_b64_tr_b16 a[88:89], v24 offset:45056
    ds_read_b64_tr_b16 a[90:91], v24 offset:45568
    v_mfma_f32_16x16x32_bf16 v[144:147], a[64:67], a[60:63], v[144:147]
    v_mfma_f32_16x16x32_bf16 v[132:135], a[68:71], a[56:59], v[132:135]
    ds_read_b64_tr_b16 a[92:93], v25 offset:45056
    ds_read_b64_tr_b16 a[94:95], v25 offset:45568
    v_mfma_f32_16x16x32_bf16 v[148:151], a[68:71], a[60:63], v[148:151]
    s_waitcnt vmcnt(8)
    buffer_load_dwordx4 v17, s[44:47], s62 offen offset:3072 lds
    v_mfma_f32_16x16x32_bf16 v[136:139], a[72:75], a[56:59], v[136:139]
    s_barrier
    ds_read_b64_tr_b16 a[64:65], v18 offset:0
    ds_read_b64_tr_b16 a[66:67], v18 offset:512
    v_mfma_f32_16x16x32_bf16 v[152:155], a[72:75], a[60:63], v[152:155]
    s_waitcnt lgkmcnt(6) vmcnt(8)
    s_add_u32 s72, s78, 0
    s_atomic_add s3, s[36:37], s72
    v_mfma_f32_16x16x32_bf16 v[140:143], a[76:79], a[56:59], v[140:143]
    s_add_u32 s4, s4, 1
    ds_read_b64_tr_b16 a[68:69], v19 offset:0
    ds_read_b64_tr_b16 a[70:71], v19 offset:512
    v_mfma_f32_16x16x32_bf16 v[156:159], a[76:79], a[60:63], v[156:159]
    s_and_b32 s4, s4, 7
    s_mul_i32 s5, s4, 229376
    v_mfma_f32_16x16x32_bf16 v[160:163], a[80:83], a[56:59], v[160:163]
    s_add_u32 m0, s60, 24576
    ds_read_b64_tr_b16 a[72:73], v22 offset:0
    ds_read_b64_tr_b16 a[74:75], v22 offset:512
    v_mfma_f32_16x16x32_bf16 v[176:179], a[80:83], a[60:63], v[176:179]
    buffer_load_dwordx4 v2, s[28:31], s5 offen offset:0 lds
    v_mfma_f32_16x16x32_bf16 v[164:167], a[84:87], a[56:59], v[164:167]
    ds_read_b64_tr_b16 a[76:77], v23 offset:0
    ds_read_b64_tr_b16 a[78:79], v23 offset:512
    v_mfma_f32_16x16x32_bf16 v[180:183], a[84:87], a[60:63], v[180:183]
    s_waitcnt lgkmcnt(6)
    buffer_load_dwordx4 v3, s[28:31], s5 offen offset:1024 lds
    v_mfma_f32_16x16x32_bf16 v[168:171], a[88:91], a[56:59], v[168:171]
    s_nop 0
    ds_read_b64_tr_b16 a[80:81], v20 offset:0
    ds_read_b64_tr_b16 a[82:83], v20 offset:512
    v_mfma_f32_16x16x32_bf16 v[184:187], a[88:91], a[60:63], v[184:187]
    v_mfma_f32_16x16x32_bf16 v[172:175], a[92:95], a[56:59], v[172:175]
    ds_read_b64_tr_b16 a[84:85], v21 offset:0
    ds_read_b64_tr_b16 a[86:87], v21 offset:512
    v_mfma_f32_16x16x32_bf16 v[188:191], a[92:95], a[60:63], v[188:191]
    buffer_load_dwordx4 v4, s[28:31], s5 offen offset:2048 lds
    v_mfma_f32_16x16x32_bf16 v[128:131], a[64:67], v[192:195], v[128:131]
    ds_read_b64_tr_b16 a[88:89], v24 offset:0
    ds_read_b64_tr_b16 a[90:91], v24 offset:512
    v_mfma_f32_16x16x32_bf16 v[144:147], a[64:67], v[196:199], v[144:147]
    s_waitcnt lgkmcnt(6)
    v_mfma_f32_16x16x32_bf16 v[132:135], a[68:71], v[192:195], v[132:135]
    s_nop 0
    ds_read_b64_tr_b16 a[92:93], v25 offset:0
    ds_read_b64_tr_b16 a[94:95], v25 offset:512
    v_mfma_f32_16x16x32_bf16 v[148:151], a[68:71], v[196:199], v[148:151]
    v_mfma_f32_16x16x32_bf16 v[136:139], a[72:75], v[192:195], v[136:139]
    ds_read_b64_tr_b16 a[64:65], v18 offset:4096
    ds_read_b64_tr_b16 a[66:67], v18 offset:4608
    v_mfma_f32_16x16x32_bf16 v[152:155], a[72:75], v[196:199], v[152:155]
    buffer_load_dwordx4 v5, s[28:31], s5 offen offset:3072 lds
    v_mfma_f32_16x16x32_bf16 v[140:143], a[76:79], v[192:195], v[140:143]
    s_add_u32 s4, s4, 1
    ds_read_b64_tr_b16 a[68:69], v19 offset:4096
    ds_read_b64_tr_b16 a[70:71], v19 offset:4608
    v_mfma_f32_16x16x32_bf16 v[156:159], a[76:79], v[196:199], v[156:159]
    s_waitcnt lgkmcnt(6)
    s_and_b32 s4, s4, 7
    s_mul_i32 s5, s4, 196608
    v_mfma_f32_16x16x32_bf16 v[160:163], a[80:83], v[192:195], v[160:163]
    s_add_u32 m0, s60, 32768
    ds_read_b64_tr_b16 a[72:73], v22 offset:4096
    ds_read_b64_tr_b16 a[74:75], v22 offset:4608
    v_mfma_f32_16x16x32_bf16 v[176:179], a[80:83], v[196:199], v[176:179]
    buffer_load_dwordx4 v6, s[32:35], s5 offen offset:0 lds
    v_mfma_f32_16x16x32_bf16 v[164:167], a[84:87], v[192:195], v[164:167]
    s_nop 0
    ds_read_b64_tr_b16 a[76:77], v23 offset:4096
    ds_read_b64_tr_b16 a[78:79], v23 offset:4608
    v_mfma_f32_16x16x32_bf16 v[180:183], a[84:87], v[196:199], v[180:183]
    v_mfma_f32_16x16x32_bf16 v[168:171], a[88:91], v[192:195], v[168:171]
    ds_read_b64_tr_b16 a[80:81], v20 offset:4096
    ds_read_b64_tr_b16 a[82:83], v20 offset:4608
    v_mfma_f32_16x16x32_bf16 v[184:187], a[88:91], v[196:199], v[184:187]
    s_waitcnt lgkmcnt(6)
    v_mfma_f32_16x16x32_bf16 v[172:175], a[92:95], v[192:195], v[172:175]
    s_nop 0
    ds_read_b64_tr_b16 a[84:85], v21 offset:4096
    ds_read_b64_tr_b16 a[86:87], v21 offset:4608
    v_mfma_f32_16x16x32_bf16 v[188:191], a[92:95], v[196:199], v[188:191]
    buffer_load_dwordx4 v7, s[32:35], s5 offen offset:1024 lds
    v_mfma_f32_16x16x32_bf16 v[128:131], a[64:67], v[200:203], v[128:131]
    ds_read_b64_tr_b16 a[88:89], v24 offset:4096
    ds_read_b64_tr_b16 a[90:91], v24 offset:4608
    v_mfma_f32_16x16x32_bf16 v[144:147], a[64:67], v[204:207], v[144:147]
    v_mfma_f32_16x16x32_bf16 v[132:135], a[68:71], v[200:203], v[132:135]
    ds_read_b64_tr_b16 a[92:93], v25 offset:4096
    ds_read_b64_tr_b16 a[94:95], v25 offset:4608
    v_mfma_f32_16x16x32_bf16 v[148:151], a[68:71], v[204:207], v[148:151]
    s_waitcnt lgkmcnt(6)
    buffer_load_dwordx4 v8, s[32:35], s5 offen offset:2048 lds
    v_mfma_f32_16x16x32_bf16 v[136:139], a[72:75], v[200:203], v[136:139]
    s_nop 0
    ds_read_b64_tr_b16 a[64:65], v18 offset:8192
    ds_read_b64_tr_b16 a[66:67], v18 offset:8704
    v_mfma_f32_16x16x32_bf16 v[152:155], a[72:75], v[204:207], v[152:155]
    v_mfma_f32_16x16x32_bf16 v[140:143], a[76:79], v[200:203], v[140:143]
    ds_read_b64_tr_b16 a[68:69], v19 offset:8192
    ds_read_b64_tr_b16 a[70:71], v19 offset:8704
    v_mfma_f32_16x16x32_bf16 v[156:159], a[76:79], v[204:207], v[156:159]
    v_mfma_f32_16x16x32_bf16 v[160:163], a[80:83], v[200:203], v[160:163]
    ds_read_b64_tr_b16 a[72:73], v22 offset:8192
    ds_read_b64_tr_b16 a[74:75], v22 offset:8704
    v_mfma_f32_16x16x32_bf16 v[176:179], a[80:83], v[204:207], v[176:179]
    s_waitcnt lgkmcnt(6)
    buffer_load_dwordx4 v9, s[32:35], s5 offen offset:3072 lds
    v_mfma_f32_16x16x32_bf16 v[164:167], a[84:87], v[200:203], v[164:167]
    s_nop 0
    ds_read_b64_tr_b16 a[76:77], v23 offset:8192
    ds_read_b64_tr_b16 a[78:79], v23 offset:8704
    v_mfma_f32_16x16x32_bf16 v[180:183], a[84:87], v[204:207], v[180:183]
    s_lshl3_add_u32 s62, s12, s62
    s_add_u32 m0, s60, 57344
    v_mfma_f32_16x16x32_bf16 v[168:171], a[88:91], v[200:203], v[168:171]
    s_nop 0
    ds_read_b64_tr_b16 a[80:81], v20 offset:8192
    ds_read_b64_tr_b16 a[82:83], v20 offset:8704
    v_mfma_f32_16x16x32_bf16 v[184:187], a[88:91], v[204:207], v[184:187]
    s_waitcnt vmcnt(8)
    buffer_load_dwordx4 v14, s[44:47], s62 offen offset:0 lds
    v_mfma_f32_16x16x32_bf16 v[172:175], a[92:95], v[200:203], v[172:175]
    s_nop 0
    ds_read_b64_tr_b16 a[84:85], v21 offset:8192
    ds_read_b64_tr_b16 a[86:87], v21 offset:8704
    v_mfma_f32_16x16x32_bf16 v[188:191], a[92:95], v[204:207], v[188:191]
    s_waitcnt lgkmcnt(6)
    ds_read_b64_tr_b16 a[224:225], v30 offset:49152
    ds_read_b64_tr_b16 a[226:227], v30 offset:51200
    v_mfma_f32_16x16x32_bf16 v[128:131], a[64:67], v[208:211], v[128:131]
    s_nop 0
    ds_read_b64_tr_b16 a[88:89], v24 offset:8192
    ds_read_b64_tr_b16 a[90:91], v24 offset:8704
    v_mfma_f32_16x16x32_bf16 v[144:147], a[64:67], v[212:215], v[144:147]
    ds_read_b64_tr_b16 a[228:229], v31 offset:49152
    ds_read_b64_tr_b16 a[230:231], v31 offset:51200
    v_mfma_f32_16x16x32_bf16 v[132:135], a[68:71], v[208:211], v[132:135]
    ds_read_b64_tr_b16 a[92:93], v25 offset:8192
    ds_read_b64_tr_b16 a[94:95], v25 offset:8704
    v_mfma_f32_16x16x32_bf16 v[148:151], a[68:71], v[212:215], v[148:151]
    buffer_load_dwordx4 v15, s[44:47], s62 offen offset:1024 lds
    v_mfma_f32_16x16x32_bf16 v[136:139], a[72:75], v[208:211], v[136:139]
    ds_read_b64_tr_b16 a[64:65], v18 offset:12288
    ds_read_b64_tr_b16 a[66:67], v18 offset:12800
    v_mfma_f32_16x16x32_bf16 v[152:155], a[72:75], v[212:215], v[152:155]
    s_waitcnt lgkmcnt(10)
    ds_read_b64_tr_b16 a[232:233], v32 offset:49152
    ds_read_b64_tr_b16 a[234:235], v32 offset:51200
    v_mfma_f32_16x16x32_bf16 v[140:143], a[76:79], v[208:211], v[140:143]
    s_nop 0
    ds_read_b64_tr_b16 a[68:69], v19 offset:12288
    ds_read_b64_tr_b16 a[70:71], v19 offset:12800
    v_mfma_f32_16x16x32_bf16 v[156:159], a[76:79], v[212:215], v[156:159]
    buffer_load_dwordx4 v16, s[44:47], s62 offen offset:2048 lds
    v_mfma_f32_16x16x32_bf16 v[160:163], a[80:83], v[208:211], v[160:163]
    ds_read_b64_tr_b16 a[72:73], v22 offset:12288
    ds_read_b64_tr_b16 a[74:75], v22 offset:12800
    v_mfma_f32_16x16x32_bf16 v[176:179], a[80:83], v[212:215], v[176:179]
    ds_read_b64_tr_b16 a[236:237], v33 offset:49152
    ds_read_b64_tr_b16 a[238:239], v33 offset:51200
    v_mfma_f32_16x16x32_bf16 v[164:167], a[84:87], v[208:211], v[164:167]
    ds_read_b64_tr_b16 a[76:77], v23 offset:12288
    ds_read_b64_tr_b16 a[78:79], v23 offset:12800
    v_mfma_f32_16x16x32_bf16 v[180:183], a[84:87], v[212:215], v[180:183]
    s_waitcnt lgkmcnt(10)
    v_mfma_f32_16x16x32_bf16 v[168:171], a[88:91], v[208:211], v[168:171]
    s_nop 0
    ds_read_b64_tr_b16 a[80:81], v20 offset:12288
    ds_read_b64_tr_b16 a[82:83], v20 offset:12800
    v_mfma_f32_16x16x32_bf16 v[184:187], a[88:91], v[212:215], v[184:187]
    buffer_load_dwordx4 v17, s[44:47], s62 offen offset:3072 lds
    v_mfma_f32_16x16x32_bf16 v[172:175], a[92:95], v[208:211], v[172:175]
    ds_read_b64_tr_b16 a[84:85], v21 offset:12288
    ds_read_b64_tr_b16 a[86:87], v21 offset:12800
    v_mfma_f32_16x16x32_bf16 v[188:191], a[92:95], v[212:215], v[188:191]
    s_waitcnt lgkmcnt(6)
    s_lshl3_add_u32 s62, s15, s62
    s_add_u32 m0, s60, 49152
    v_mfma_f32_16x16x32_bf16 v[128:131], a[64:67], v[216:219], v[128:131]
    ds_read_b64_tr_b16 a[88:89], v24 offset:12288
    ds_read_b64_tr_b16 a[90:91], v24 offset:12800
    v_mfma_f32_16x16x32_bf16 v[144:147], a[64:67], v[220:223], v[144:147]
    s_waitcnt lgkmcnt(6)
    buffer_load_dwordx4 v14, s[44:47], s62 offen offset:0 lds
    v_mfma_f32_16x16x32_bf16 v[132:135], a[68:71], v[216:219], v[132:135]
    s_nop 0
    ds_read_b64_tr_b16 a[92:93], v25 offset:12288
    ds_read_b64_tr_b16 a[94:95], v25 offset:12800
    v_mfma_f32_16x16x32_bf16 v[148:151], a[68:71], v[220:223], v[148:151]
    s_waitcnt vmcnt(9)
    v_mfma_f32_16x16x32_bf16 v[136:139], a[72:75], v[216:219], v[136:139]
    s_barrier
    ds_read_b64_tr_b16 a[64:65], v18 offset:16384
    ds_read_b64_tr_b16 a[66:67], v18 offset:16896
    v_mfma_f32_16x16x32_bf16 v[152:155], a[72:75], v[220:223], v[152:155]
    buffer_load_dwordx4 v15, s[44:47], s62 offen offset:1024 lds
    v_mfma_f32_16x16x32_bf16 v[140:143], a[76:79], v[216:219], v[140:143]
    ds_read_b64_tr_b16 a[68:69], v19 offset:16384
    ds_read_b64_tr_b16 a[70:71], v19 offset:16896
    v_mfma_f32_16x16x32_bf16 v[156:159], a[76:79], v[220:223], v[156:159]
    s_waitcnt lgkmcnt(6)
    buffer_load_dwordx4 v16, s[44:47], s62 offen offset:2048 lds
    v_mfma_f32_16x16x32_bf16 v[160:163], a[80:83], v[216:219], v[160:163]
    s_nop 0
    ds_read_b64_tr_b16 a[72:73], v22 offset:16384
    ds_read_b64_tr_b16 a[74:75], v22 offset:16896
    v_mfma_f32_16x16x32_bf16 v[176:179], a[80:83], v[220:223], v[176:179]
    v_mfma_f32_16x16x32_bf16 v[164:167], a[84:87], v[216:219], v[164:167]
    ds_read_b64_tr_b16 a[76:77], v23 offset:16384
    ds_read_b64_tr_b16 a[78:79], v23 offset:16896
    v_mfma_f32_16x16x32_bf16 v[180:183], a[84:87], v[220:223], v[180:183]
    v_mfma_f32_16x16x32_bf16 v[168:171], a[88:91], v[216:219], v[168:171]
    ds_read_b64_tr_b16 a[80:81], v18 offset:20480
    ds_read_b64_tr_b16 a[82:83], v18 offset:20992
    v_mfma_f32_16x16x32_bf16 v[184:187], a[88:91], v[220:223], v[184:187]
    s_waitcnt lgkmcnt(6)
    buffer_load_dwordx4 v17, s[44:47], s62 offen offset:3072 lds
    v_mfma_f32_16x16x32_bf16 v[172:175], a[92:95], v[216:219], v[172:175]
    s_add_u32 s4, s4, 2
    ds_read_b64_tr_b16 a[84:85], v19 offset:20480
    ds_read_b64_tr_b16 a[86:87], v19 offset:20992
    v_mfma_f32_16x16x32_bf16 v[188:191], a[92:95], v[220:223], v[188:191]
    s_and_b32 s4, s4, 7
    s_mul_i32 s5, s4, 196608
    v_mfma_f32_16x16x32_bf16 v[128:131], a[64:67], v[224:227], v[128:131]
    s_add_u32 m0, s60, 40960
    ds_read_b64_tr_b16 a[88:89], v22 offset:20480
    ds_read_b64_tr_b16 a[90:91], v22 offset:20992
    v_mfma_f32_16x16x32_bf16 v[144:147], a[64:67], v[228:231], v[144:147]
    buffer_load_dwordx4 v6, s[32:35], s5 offen offset:0 lds
    v_mfma_f32_16x16x32_bf16 v[132:135], a[68:71], v[224:227], v[132:135]
    s_nop 0
    ds_read_b64_tr_b16 a[92:93], v23 offset:20480
    ds_read_b64_tr_b16 a[94:95], v23 offset:20992
    v_mfma_f32_16x16x32_bf16 v[148:151], a[68:71], v[228:231], v[148:151]
    s_waitcnt lgkmcnt(6)
    v_mfma_f32_16x16x32_bf16 v[136:139], a[72:75], v[224:227], v[136:139]
    s_nop 0
    ds_read_b64_tr_b16 a[64:65], v18 offset:24576
    ds_read_b64_tr_b16 a[66:67], v18 offset:25088
    v_mfma_f32_16x16x32_bf16 v[152:155], a[72:75], v[228:231], v[152:155]
    v_mfma_f32_16x16x32_bf16 v[140:143], a[76:79], v[224:227], v[140:143]
    ds_read_b64_tr_b16 a[68:69], v19 offset:24576
    ds_read_b64_tr_b16 a[70:71], v19 offset:25088
    v_mfma_f32_16x16x32_bf16 v[156:159], a[76:79], v[228:231], v[156:159]
    buffer_load_dwordx4 v7, s[32:35], s5 offen offset:1024 lds
    v_mfma_f32_16x16x32_bf16 v[128:131], a[80:83], v[232:235], v[128:131]
    ds_read_b64_tr_b16 a[72:73], v22 offset:24576
    ds_read_b64_tr_b16 a[74:75], v22 offset:25088
    v_mfma_f32_16x16x32_bf16 v[144:147], a[80:83], v[236:239], v[144:147]
    s_waitcnt lgkmcnt(6)
    v_mfma_f32_16x16x32_bf16 v[132:135], a[84:87], v[232:235], v[132:135]
    s_nop 0
    ds_read_b64_tr_b16 a[76:77], v23 offset:24576
    ds_read_b64_tr_b16 a[78:79], v23 offset:25088
    v_mfma_f32_16x16x32_bf16 v[148:151], a[84:87], v[236:239], v[148:151]
    buffer_load_dwordx4 v8, s[32:35], s5 offen offset:2048 lds
    v_mfma_f32_16x16x32_bf16 v[136:139], a[88:91], v[232:235], v[136:139]
    ds_read_b64_tr_b16 a[80:81], v18 offset:28672
    ds_read_b64_tr_b16 a[82:83], v18 offset:29184
    v_mfma_f32_16x16x32_bf16 v[152:155], a[88:91], v[236:239], v[152:155]
    v_mfma_f32_16x16x32_bf16 v[140:143], a[92:95], v[232:235], v[140:143]
    ds_read_b64_tr_b16 a[84:85], v19 offset:28672
    ds_read_b64_tr_b16 a[86:87], v19 offset:29184
    v_mfma_f32_16x16x32_bf16 v[156:159], a[92:95], v[236:239], v[156:159]
    s_waitcnt lgkmcnt(6)
    v_mfma_f32_16x16x32_bf16 v[128:131], a[64:67], v[240:243], v[128:131]
    s_nop 0
    ds_read_b64_tr_b16 a[88:89], v22 offset:28672
    ds_read_b64_tr_b16 a[90:91], v22 offset:29184
    v_mfma_f32_16x16x32_bf16 v[144:147], a[64:67], v[244:247], v[144:147]
    buffer_load_dwordx4 v9, s[32:35], s5 offen offset:3072 lds
    v_mfma_f32_16x16x32_bf16 v[132:135], a[68:71], v[240:243], v[132:135]
    s_add_u32 s4, s4, 2
    ds_read_b64_tr_b16 a[92:93], v23 offset:28672
    ds_read_b64_tr_b16 a[94:95], v23 offset:29184
    v_mfma_f32_16x16x32_bf16 v[148:151], a[68:71], v[244:247], v[148:151]
    s_and_b32 s4, s4, 7
    s_mul_i32 s5, s4, 196608
    v_mfma_f32_16x16x32_bf16 v[136:139], a[72:75], v[240:243], v[136:139]
    s_mov_b32 m0, s60
    ds_read_b64_tr_b16 a[64:65], v20 offset:16384
    ds_read_b64_tr_b16 a[66:67], v20 offset:16896
    v_mfma_f32_16x16x32_bf16 v[152:155], a[72:75], v[244:247], v[152:155]
    s_waitcnt lgkmcnt(6) vmcnt(8)
    buffer_load_dwordx4 v6, s[32:35], s5 offen offset:0 lds
    v_mfma_f32_16x16x32_bf16 v[140:143], a[76:79], v[240:243], v[140:143]
    ds_read_b64_tr_b16 a[68:69], v21 offset:16384
    ds_read_b64_tr_b16 a[70:71], v21 offset:16896
    v_mfma_f32_16x16x32_bf16 v[156:159], a[76:79], v[244:247], v[156:159]
    ds_read_b64_tr_b16 a[240:241], v30 offset:57344
    ds_read_b64_tr_b16 a[242:243], v30 offset:59392
    v_mfma_f32_16x16x32_bf16 v[128:131], a[80:83], v[248:251], v[128:131]
    ds_read_b64_tr_b16 a[72:73], v24 offset:16384
    ds_read_b64_tr_b16 a[74:75], v24 offset:16896
    v_mfma_f32_16x16x32_bf16 v[144:147], a[80:83], v[252:255], v[144:147]
    ds_read_b64_tr_b16 a[244:245], v31 offset:57344
    ds_read_b64_tr_b16 a[246:247], v31 offset:59392
    v_mfma_f32_16x16x32_bf16 v[132:135], a[84:87], v[248:251], v[132:135]
    ds_read_b64_tr_b16 a[76:77], v25 offset:16384
    ds_read_b64_tr_b16 a[78:79], v25 offset:16896
    v_mfma_f32_16x16x32_bf16 v[148:151], a[84:87], v[252:255], v[148:151]
    s_waitcnt lgkmcnt(10)
    buffer_load_dwordx4 v7, s[32:35], s5 offen offset:1024 lds
    v_mfma_f32_16x16x32_bf16 v[136:139], a[88:91], v[248:251], v[136:139]
    s_nop 0
    ds_read_b64_tr_b16 a[80:81], v20 offset:20480
    ds_read_b64_tr_b16 a[82:83], v20 offset:20992
    v_mfma_f32_16x16x32_bf16 v[152:155], a[88:91], v[252:255], v[152:155]
    ds_read_b64_tr_b16 a[248:249], v32 offset:57344
    ds_read_b64_tr_b16 a[250:251], v32 offset:59392
    v_mfma_f32_16x16x32_bf16 v[140:143], a[92:95], v[248:251], v[140:143]
    ds_read_b64_tr_b16 a[84:85], v21 offset:20480
    ds_read_b64_tr_b16 a[86:87], v21 offset:20992
    v_mfma_f32_16x16x32_bf16 v[156:159], a[92:95], v[252:255], v[156:159]
    buffer_load_dwordx4 v8, s[32:35], s5 offen offset:2048 lds
    v_mfma_f32_16x16x32_bf16 v[160:163], a[64:67], v[224:227], v[160:163]
    s_add_u32 s19, s68, 4096
    ds_read_b64_tr_b16 a[88:89], v24 offset:20480
    ds_read_b64_tr_b16 a[90:91], v24 offset:20992
    v_mfma_f32_16x16x32_bf16 v[176:179], a[64:67], v[228:231], v[176:179]
    s_waitcnt lgkmcnt(8)
    ds_read_b64_tr_b16 a[252:253], v33 offset:57344
    ds_read_b64_tr_b16 a[254:255], v33 offset:59392
    v_pk_mul_f32 v[136:137], v[128:129], v[136:137]
    v_pk_mul_f32 v[128:129], v[128:129], v[34:35] op_sel:[0,0] op_sel_hi:[1,0]
    v_pk_mul_f32 v[138:139], v[130:131], v[138:139]
    v_mfma_f32_16x16x32_bf16 v[164:167], a[68:71], v[224:227], v[164:167]
    s_nop 0
    ds_read_b64_tr_b16 a[92:93], v25 offset:20480
    ds_read_b64_tr_b16 a[94:95], v25 offset:20992
    v_mfma_f32_16x16x32_bf16 v[180:183], a[68:71], v[228:231], v[180:183]
    buffer_load_dwordx4 v9, s[32:35], s5 offen offset:3072 lds
    v_exp_f32 v128, v128
    v_exp_f32 v129, v129
    v_pk_mul_f32 v[130:131], v[130:131], v[34:35] op_sel:[0,0] op_sel_hi:[1,0]
    v_pk_mul_f32 v[140:141], v[132:133], v[140:141]
    v_mfma_f32_16x16x32_bf16 v[168:171], a[72:75], v[224:227], v[168:171]
    ds_read_b64_tr_b16 a[64:65], v20 offset:24576
    ds_read_b64_tr_b16 a[66:67], v20 offset:25088
    v_mfma_f32_16x16x32_bf16 v[184:187], a[72:75], v[228:231], v[184:187]
    s_waitcnt lgkmcnt(4)
    v_exp_f32 v130, v130
    v_exp_f32_e64 v131, v131
    v_pk_mul_f32 v[132:133], v[132:133], v[34:35] op_sel:[0,0] op_sel_hi:[1,0]
    v_pk_fma_f32 v[128:129], v[128:129], v[36:37], v[36:37] op_sel:[0,0,0] op_sel_hi:[1,0,0]
    v_pk_mul_f32 v[142:143], v[134:135], v[142:143]
    v_mfma_f32_16x16x32_bf16 v[172:175], a[76:79], v[224:227], v[172:175]
    s_lshl3_add_u32 s62, s13, s62
    ds_read_b64_tr_b16 a[68:69], v21 offset:24576
    ds_read_b64_tr_b16 a[70:71], v21 offset:25088
    v_mfma_f32_16x16x32_bf16 v[188:191], a[76:79], v[228:231], v[188:191]
    v_exp_f32 v132, v132
    v_exp_f32 v133, v133
    v_rcp_f32 v128, v128
    v_pk_mul_f32 v[134:135], v[134:135], v[34:35] op_sel:[0,0] op_sel_hi:[1,0]
    v_pk_fma_f32 v[130:131], v[130:131], v[36:37], v[36:37] op_sel:[0,0,0] op_sel_hi:[1,0,0]
    v_mfma_f32_16x16x32_bf16 v[160:163], a[80:83], v[232:235], v[160:163]
    s_add_u32 m0, s60, 57344
    ds_read_b64_tr_b16 a[72:73], v24 offset:24576
    ds_read_b64_tr_b16 a[74:75], v24 offset:25088
    v_mfma_f32_16x16x32_bf16 v[176:179], a[80:83], v[236:239], v[176:179]
    buffer_load_dwordx4 v14, s[44:47], s62 offen offset:0 lds
    v_rcp_f32 v129, v129
    v_exp_f32 v134, v134
    v_pk_mul_f32 v[152:153], v[144:145], v[152:153]
    v_pk_mul_f32 v[144:145], v[144:145], v[34:35] op_sel:[0,1] op_sel_hi:[1,1]
    v_mfma_f32_16x16x32_bf16 v[164:167], a[84:87], v[232:235], v[164:167]
    ds_read_b64_tr_b16 a[76:77], v25 offset:24576
    ds_read_b64_tr_b16 a[78:79], v25 offset:25088
    v_mfma_f32_16x16x32_bf16 v[180:183], a[84:87], v[236:239], v[180:183]
    buffer_load_dwordx4 v15, s[44:47], s62 offen offset:1024 lds
    v_exp_f32 v135, v135
    v_rcp_f32 v130, v130
    v_pk_fma_f32 v[132:133], v[132:133], v[36:37], v[36:37] op_sel:[0,0,0] op_sel_hi:[1,0,0]
    v_pk_mul_f32 v[136:137], v[128:129], v[136:137]
    v_mfma_f32_16x16x32_bf16 v[168:171], a[88:91], v[232:235], v[168:171]
L_padA4:
    s_cbranch_execz L_padret
    ds_read_b64_tr_b16 a[80:81], v20 offset:28672
    ds_read_b64_tr_b16 a[82:83], v20 offset:29184
    v_mfma_f32_16x16x32_bf16 v[184:187], a[88:91], v[236:239], v[184:187]
    s_waitcnt lgkmcnt(6)
    buffer_load_dwordx4 v16, s[44:47], s62 offen offset:2048 lds
    v_rcp_f32 v131, v131
    v_exp_f32 v144, v144
    v_pk_mul_f32 v[154:155], v[146:147], v[154:155]
    v_pk_mul_f32 v[146:147], v[146:147], v[34:35] op_sel:[0,1] op_sel_hi:[1,1]
    v_mfma_f32_16x16x32_bf16 v[172:175], a[92:95], v[232:235], v[172:175]
    ds_read_b64_tr_b16 a[84:85], v21 offset:28672
    ds_read_b64_tr_b16 a[86:87], v21 offset:29184
    v_mfma_f32_16x16x32_bf16 v[188:191], a[92:95], v[236:239], v[188:191]
    buffer_load_dwordx4 v17, s[44:47], s62 offen offset:3072 lds
    v_exp_f32 v145, v145
    v_rcp_f32 v132, v132
    v_pk_fma_f32 v[134:135], v[134:135], v[36:37], v[36:37] op_sel:[0,0,0] op_sel_hi:[1,0,0]
    v_pk_mul_f32 v[138:139], v[130:131], v[138:139]
    v_mfma_f32_16x16x32_bf16 v[160:163], a[64:67], v[240:243], v[160:163]
    ds_read_b64_tr_b16 a[88:89], v24 offset:28672
    ds_read_b64_tr_b16 a[90:91], v24 offset:29184
    v_mfma_f32_16x16x32_bf16 v[176:179], a[64:67], v[244:247], v[176:179]
    buffer_load_dword v38, off, s[36:39], s79 offset:0 sc1
    v_rcp_f32_e64 v133, v133
    v_cvt_pk_bf16_f32 v128, v136, v137
    v_pk_mul_f32 v[156:157], v[148:149], v[156:157]
    v_pk_mul_f32 v[148:149], v[148:149], v[34:35] op_sel:[0,1] op_sel_hi:[1,1]
    v_pk_fma_f32 v[144:145], v[144:145], v[36:37], v[36:37] op_sel:[0,1,1] op_sel_hi:[1,1,1]
    v_mfma_f32_16x16x32_bf16 v[164:167], a[68:71], v[240:243], v[164:167]
    s_lshl3_add_u32 s62, s10, s84
    ds_read_b64_tr_b16 a[92:93], v25 offset:28672
    ds_read_b64_tr_b16 a[94:95], v25 offset:29184
    v_mfma_f32_16x16x32_bf16 v[180:183], a[68:71], v[244:247], v[180:183]
    s_waitcnt lgkmcnt(6) vmcnt(9)
    v_exp_f32 v146, v146
    v_exp_f32 v147, v147
    v_rcp_f32_e64 v134, v134
    v_pk_mul_f32 v[140:141], v[132:133], v[140:141]
    v_pk_mul_f32 v[158:159], v[150:151], v[158:159]
    v_mfma_f32_16x16x32_bf16 v[168:171], a[72:75], v[240:243], v[168:171]
    s_barrier
    ds_read_b64_tr_b16 a[64:65], v18 offset:32768
    ds_read_b64_tr_b16 a[66:67], v18 offset:33280
    v_mfma_f32_16x16x32_bf16 v[184:187], a[72:75], v[244:247], v[184:187]
    v_rcp_f32 v135, v135
    v_cvt_pk_bf16_f32 v129, v138, v139
    v_exp_f32_e64 v148, v148
    v_pk_mul_f32 v[150:151], v[150:151], v[34:35] op_sel:[0,1] op_sel_hi:[1,1]
    v_pk_fma_f32 v[146:147], v[146:147], v[36:37], v[36:37] op_sel:[0,1,1] op_sel_hi:[1,1,1]
    v_pk_mul_f32 v[142:143], v[134:135], v[142:143]
    v_mfma_f32_16x16x32_bf16 v[172:175], a[76:79], v[240:243], v[172:175]
    s_add_u32 m0, s99, 0
    ds_read_b64_tr_b16 a[68:69], v19 offset:32768
    ds_read_b64_tr_b16 a[70:71], v19 offset:33280
    v_mfma_f32_16x16x32_bf16 v[188:191], a[76:79], v[244:247], v[188:191]
    buffer_load_dwordx4 v14, s[44:47], s62 offen offset:0 lds
    v_exp_f32 v149, v149
    v_rcp_f32_e64 v144, v144
    v_pk_fma_f32 v[148:149], v[148:149], v[36:37], v[36:37] op_sel:[0,1,1] op_sel_hi:[1,1,1]
    v_cvt_pk_bf16_f32 v130, v140, v141
    v_mfma_f32_16x16x32_bf16 v[160:163], a[80:83], v[248:251], v[160:163]
    ds_read_b64_tr_b16 a[72:73], v20 offset:32768
    ds_read_b64_tr_b16 a[74:75], v20 offset:33280
    v_mfma_f32_16x16x32_bf16 v[176:179], a[80:83], v[252:255], v[176:179]
    s_waitcnt lgkmcnt(6)
    buffer_load_dwordx4 v15, s[44:47], s62 offen offset:1024 lds
    v_rcp_f32 v145, v145
    v_exp_f32_e64 v150, v150
    v_pk_mul_f32 v[152:153], v[144:145], v[152:153]
    v_cvt_pk_bf16_f32 v131, v142, v143
    v_mfma_f32_16x16x32_bf16 v[164:167], a[84:87], v[248:251], v[164:167]
    ds_read_b64_tr_b16 a[76:77], v21 offset:32768
    ds_read_b64_tr_b16 a[78:79], v21 offset:33280
    v_mfma_f32_16x16x32_bf16 v[180:183], a[84:87], v[252:255], v[180:183]
    buffer_load_dwordx4 v16, s[44:47], s62 offen offset:2048 lds
    v_exp_f32 v151, v151
    v_rcp_f32 v146, v146
    v_rcp_f32_e64 v147, v147
    v_mfma_f32_16x16x32_bf16 v[168:171], a[88:91], v[248:251], v[168:171]
    ds_read_b64_tr_b16 a[80:81], v18 offset:36864
    ds_read_b64_tr_b16 a[82:83], v18 offset:37376
    buffer_store_dwordx4 v[128:131], v1, s[36:39], s68 offen offset:0 sc1
    v_mfma_f32_16x16x32_bf16 v[184:187], a[88:91], v[252:255], v[184:187]
    buffer_load_dword v40, off, s[36:39], s77 offset:0 sc1
    v_rcp_f32 v148, v148
    v_rcp_f32 v149, v149
    v_pk_fma_f32 v[150:151], v[150:151], v[36:37], v[36:37] op_sel:[0,1,1] op_sel_hi:[1,1,1]
    v_pk_mul_f32 v[154:155], v[146:147], v[154:155]
    v_mfma_f32_16x16x32_bf16 v[172:175], a[92:95], v[248:251], v[172:175]
    ds_read_b64_tr_b16 a[84:85], v19 offset:36864
    ds_read_b64_tr_b16 a[86:87], v19 offset:37376
    v_mfma_f32_16x16x32_bf16 v[188:191], a[92:95], v[252:255], v[188:191]
    s_waitcnt lgkmcnt(6)
    buffer_load_dwordx4 v17, s[44:47], s62 offen offset:3072 lds
    v_cvt_pk_bf16_f32 v144, v152, v153
    v_rcp_f32 v150, v150
    v_pk_mul_f32 v[156:157], v[148:149], v[156:157]
    v_rcp_f32_e64 v151, v151
    v_mfma_f32_16x16x32_bf16 v[64:67], a[64:67], a[0:3], 0
    s_add_u32 s4, s4, 2
    ds_read_b64_tr_b16 a[88:89], v20 offset:36864
    ds_read_b64_tr_b16 a[90:91], v20 offset:37376
    v_mfma_f32_16x16x32_bf16 v[72:75], a[64:67], a[4:7], 0
    s_nop 0
    v_cvt_pk_bf16_f32 v145, v154, v155
    v_cvt_pk_bf16_f32 v146, v156, v157
    v_pk_mul_f32 v[158:159], v[150:151], v[158:159]
    v_cvt_pk_bf16_f32 v147, v158, v159
    v_pk_mul_f32 v[168:169], v[160:161], v[168:169]
    v_mfma_f32_16x16x32_bf16 v[68:71], a[68:71], a[0:3], 0
    s_and_b32 s4, s4, 7
    ds_read_b64_tr_b16 a[92:93], v21 offset:36864
    ds_read_b64_tr_b16 a[94:95], v21 offset:37376
    buffer_store_dwordx4 v[144:147], v1, s[36:39], s68 offen offset:1024 sc1
    v_mfma_f32_16x16x32_bf16 v[76:79], a[68:71], a[4:7], 0
    s_nop 0
    v_pk_mul_f32 v[160:161], v[160:161], v[34:35] op_sel:[0,0] op_sel_hi:[1,0]
    v_pk_mul_f32 v[170:171], v[162:163], v[170:171]
    v_pk_mul_f32 v[162:163], v[162:163], v[34:35] op_sel:[0,0] op_sel_hi:[1,0]
    v_mfma_f32_16x16x32_bf16 v[80:83], a[72:75], a[0:3], 0
    s_mul_i32 s5, s4, 196608
    ds_read_b64_tr_b16 a[64:65], v22 offset:32768
    ds_read_b64_tr_b16 a[66:67], v22 offset:33280
    v_mfma_f32_16x16x32_bf16 v[88:91], a[72:75], a[4:7], 0
    s_waitcnt lgkmcnt(6)
    v_exp_f32 v160, v160
    v_exp_f32 v161, v161
    v_exp_f32 v162, v162
    v_pk_mul_f32 v[172:173], v[164:165], v[172:173]
    v_pk_mul_f32 v[164:165], v[164:165], v[34:35] op_sel:[0,0] op_sel_hi:[1,0]
    v_mfma_f32_16x16x32_bf16 v[84:87], a[76:79], a[0:3], 0
    s_add_u32 m0, s60, 8192
    ds_read_b64_tr_b16 a[68:69], v23 offset:32768
    ds_read_b64_tr_b16 a[70:71], v23 offset:33280
    v_mfma_f32_16x16x32_bf16 v[92:95], a[76:79], a[4:7], 0
    buffer_load_dwordx4 v6, s[32:35], s5 offen offset:0 lds
    s_waitcnt vmcnt(8)
    v_readfirstlane_b32 s72, v38
    s_nop 0
    s_cmp_ge_u32 s72, 4
    s_cbranch_scc0 L_slow_EA
L_back_EA:
    v_pk_fma_f32 v[160:161], v[160:161], v[36:37], v[36:37] op_sel:[0,0,0] op_sel_hi:[1,0,0]
    v_pk_mul_f32 v[174:175], v[166:167], v[174:175]
    v_pk_mul_f32 v[166:167], v[166:167], v[34:35] op_sel:[0,0] op_sel_hi:[1,0]
    v_pk_mul_f32 v[184:185], v[176:177], v[184:185]
    v_mfma_f32_16x16x32_bf16 v[64:67], a[80:83], a[8:11], v[64:67]
    s_nop 0
    ds_read_b64_tr_b16 a[72:73], v24 offset:32768
    ds_read_b64_tr_b16 a[74:75], v24 offset:33280
    v_mfma_f32_16x16x32_bf16 v[72:75], a[80:83], a[12:15], v[72:75]
    buffer_load_dwordx4 v7, s[32:35], s5 offen offset:1024 lds
    v_exp_f32 v163, v163
    v_exp_f32 v164, v164
    v_pk_fma_f32 v[162:163], v[162:163], v[36:37], v[36:37] op_sel:[0,0,0] op_sel_hi:[1,0,0]
    v_pk_mul_f32 v[176:177], v[176:177], v[34:35] op_sel:[0,1] op_sel_hi:[1,1]
    v_mfma_f32_16x16x32_bf16 v[68:71], a[84:87], a[8:11], v[68:71]
    ds_read_b64_tr_b16 a[76:77], v25 offset:32768
    ds_read_b64_tr_b16 a[78:79], v25 offset:33280
    v_mfma_f32_16x16x32_bf16 v[76:79], a[84:87], a[12:15], v[76:79]
    s_waitcnt lgkmcnt(6)
    buffer_load_dwordx4 v8, s[32:35], s5 offen offset:2048 lds
    v_exp_f32 v165, v165
    v_rcp_f32_e64 v160, v160
    v_pk_fma_f32 v[164:165], v[164:165], v[36:37], v[36:37] op_sel:[0,0,0] op_sel_hi:[1,0,0]
    v_pk_mul_f32 v[186:187], v[178:179], v[186:187]
    v_mfma_f32_16x16x32_bf16 v[80:83], a[88:91], a[8:11], v[80:83]
    ds_read_b64_tr_b16 a[80:81], v22 offset:36864
    ds_read_b64_tr_b16 a[82:83], v22 offset:37376
    v_mfma_f32_16x16x32_bf16 v[88:91], a[88:91], a[12:15], v[88:91]
    buffer_load_dwordx4 v9, s[32:35], s5 offen offset:3072 lds
    v_rcp_f32 v161, v161
    v_exp_f32 v166, v166
    v_pk_mul_f32 v[168:169], v[160:161], v[168:169]
    v_pk_mul_f32 v[178:179], v[178:179], v[34:35] op_sel:[0,1] op_sel_hi:[1,1]
    v_mfma_f32_16x16x32_bf16 v[84:87], a[92:95], a[8:11], v[84:87]
    ds_read_b64_tr_b16 a[84:85], v23 offset:36864
    ds_read_b64_tr_b16 a[86:87], v23 offset:37376
    v_mfma_f32_16x16x32_bf16 v[92:95], a[92:95], a[12:15], v[92:95]
    s_add_u32 s65, s8, s86
    v_exp_f32 v167, v167
    v_rcp_f32 v162, v162
    v_rcp_f32 v163, v163
    v_pk_fma_f32 v[166:167], v[166:167], v[36:37], v[36:37] op_sel:[0,0,0] op_sel_hi:[1,0,0]
    v_mfma_f32_16x16x32_bf16 v[64:67], a[64:67], a[16:19], v[64:67]
    s_lshl3_add_u32 s62, s12, s62
    ds_read_b64_tr_b16 a[88:89], v24 offset:36864
    ds_read_b64_tr_b16 a[90:91], v24 offset:37376
    v_mfma_f32_16x16x32_bf16 v[72:75], a[64:67], a[20:23], v[72:75]
    s_waitcnt lgkmcnt(6)
    buffer_load_dwordx4 a[0:3], v1, s[36:39], s65 offen offset:0 sc1
    v_exp_f32 v176, v176
    v_exp_f32 v177, v177
    v_pk_mul_f32 v[170:171], v[162:163], v[170:171]
    v_pk_mul_f32 v[188:189], v[180:181], v[188:189]
    v_mfma_f32_16x16x32_bf16 v[68:71], a[68:71], a[16:19], v[68:71]
    s_add_u32 m0, s60, 16384
    ds_read_b64_tr_b16 a[92:93], v25 offset:36864
    ds_read_b64_tr_b16 a[94:95], v25 offset:37376
    v_mfma_f32_16x16x32_bf16 v[76:79], a[68:71], a[20:23], v[76:79]
    v_rcp_f32 v164, v164
    v_rcp_f32 v165, v165
    v_cvt_pk_bf16_f32 v160, v168, v169
    v_pk_mul_f32 v[180:181], v[180:181], v[34:35] op_sel:[0,1] op_sel_hi:[1,1]
    v_pk_fma_f32 v[176:177], v[176:177], v[36:37], v[36:37] op_sel:[0,1,1] op_sel_hi:[1,1,1]
    v_pk_mul_f32 v[172:173], v[164:165], v[172:173]
    v_mfma_f32_16x16x32_bf16 v[80:83], a[72:75], a[16:19], v[80:83]
    ds_read_b64_tr_b16 a[64:65], v18 offset:40960
    ds_read_b64_tr_b16 a[66:67], v18 offset:41472
    v_mfma_f32_16x16x32_bf16 v[88:91], a[72:75], a[20:23], v[88:91]
    v_exp_f32 v178, v178
    v_exp_f32 v179, v179
    v_rcp_f32_e64 v166, v166
    v_pk_mul_f32 v[190:191], v[182:183], v[190:191]
    v_pk_mul_f32 v[182:183], v[182:183], v[34:35] op_sel:[0,1] op_sel_hi:[1,1]
    v_mfma_f32_16x16x32_bf16 v[84:87], a[76:79], a[16:19], v[84:87]
    ds_read_b64_tr_b16 a[68:69], v19 offset:40960
    ds_read_b64_tr_b16 a[70:71], v19 offset:41472
    v_mfma_f32_16x16x32_bf16 v[92:95], a[76:79], a[20:23], v[92:95]
    s_waitcnt lgkmcnt(6)
    buffer_load_dwordx4 a[4:7], v1, s[36:39], s65 offen offset:1024 sc1
    s_waitcnt vmcnt(8)
    v_readfirstlane_b32 s72, v40
    s_nop 0
    s_cmp_ge_u32 s72, 16
    s_cbranch_scc0 L_slow_kv
L_back_kv:
    v_pk_fma_f32 v[178:179], v[178:179], v[36:37], v[36:37] op_sel:[0,1,1] op_sel_hi:[1,1,1]
    v_rcp_f32_e64 v167, v167
    v_cvt_pk_bf16_f32 v161, v170, v171
    v_mfma_f32_16x16x32_bf16 v[64:67], a[80:83], a[24:27], v[64:67]
    ds_read_b64_tr_b16 a[72:73], v20 offset:40960
    ds_read_b64_tr_b16 a[74:75], v20 offset:41472
    v_mfma_f32_16x16x32_bf16 v[72:75], a[80:83], a[28:31], v[72:75]
    v_exp_f32 v180, v180
    v_exp_f32 v181, v181
    v_rcp_f32_e64 v176, v176
    v_pk_mul_f32 v[174:175], v[166:167], v[174:175]
    v_pk_fma_f32 v[180:181], v[180:181], v[36:37], v[36:37] op_sel:[0,1,1] op_sel_hi:[1,1,1]
    v_mfma_f32_16x16x32_bf16 v[68:71], a[84:87], a[24:27], v[68:71]
    ds_read_b64_tr_b16 a[76:77], v21 offset:40960
    ds_read_b64_tr_b16 a[78:79], v21 offset:41472
    v_mfma_f32_16x16x32_bf16 v[76:79], a[84:87], a[28:31], v[76:79]
    buffer_load_dwordx2 v[26:27], v54, s[36:39], s76 offen offset:0 sc1
    v_rcp_f32_e64 v177, v177
    v_cvt_pk_bf16_f32 v162, v172, v173
    v_pk_mul_f32 v[184:185], v[176:177], v[184:185]
    v_exp_f32_e64 v182, v182
    v_mfma_f32_16x16x32_bf16 v[80:83], a[88:91], a[24:27], v[80:83]
    ds_read_b64_tr_b16 a[80:81], v18 offset:45056
    ds_read_b64_tr_b16 a[82:83], v18 offset:45568
    v_mfma_f32_16x16x32_bf16 v[88:91], a[88:91], a[28:31], v[88:91]
    s_waitcnt lgkmcnt(6)
    buffer_load_dwordx2 v[96:97], v39, s[36:39], s76 offen offset:512 sc1
    v_exp_f32 v183, v183
    v_rcp_f32 v178, v178
    v_rcp_f32 v179, v179
    v_mfma_f32_16x16x32_bf16 v[84:87], a[92:95], a[24:27], v[84:87]
    ds_read_b64_tr_b16 a[84:85], v19 offset:45056
    ds_read_b64_tr_b16 a[86:87], v19 offset:45568
    v_mfma_f32_16x16x32_bf16 v[92:95], a[92:95], a[28:31], v[92:95]
    buffer_load_dwordx2 v[98:99], v39, s[36:39], s76 offen offset:1536 sc1
    v_cvt_pk_bf16_f32 v163, v174, v175
    v_mfma_f32_16x16x32_bf16 v[64:67], a[64:67], a[32:35], v[64:67]
    ds_read_b64_tr_b16 a[88:89], v20 offset:45056
    ds_read_b64_tr_b16 a[90:91], v20 offset:45568
    buffer_store_dwordx4 v[160:163], v1, s[36:39], s19 offen offset:0 sc1
    v_mfma_f32_16x16x32_bf16 v[72:75], a[64:67], a[36:39], v[72:75]
    v_rcp_f32 v180, v180
    v_rcp_f32 v181, v181
    v_cvt_pk_bf16_f32 v176, v184, v185
    v_pk_fma_f32 v[182:183], v[182:183], v[36:37], v[36:37] op_sel:[0,1,1] op_sel_hi:[1,1,1]
    v_pk_mul_f32 v[186:187], v[178:179], v[186:187]
    v_pk_mul_f32 v[188:189], v[180:181], v[188:189]
    v_mfma_f32_16x16x32_bf16 v[68:71], a[68:71], a[32:35], v[68:71]
    ds_read_b64_tr_b16 a[92:93], v21 offset:45056
    ds_read_b64_tr_b16 a[94:95], v21 offset:45568
    v_mfma_f32_16x16x32_bf16 v[76:79], a[68:71], a[36:39], v[76:79]
    s_waitcnt lgkmcnt(6)
    buffer_load_dwordx2 v[100:101], v39, s[36:39], s76 offen offset:2560 sc1
    v_rcp_f32 v182, v182
    v_rcp_f32_e64 v183, v183
    v_cvt_pk_bf16_f32 v177, v186, v187
    v_pk_mul_f32 v[190:191], v[182:183], v[190:191]
    v_mfma_f32_16x16x32_bf16 v[80:83], a[72:75], a[32:35], v[80:83]
    ds_read_b64_tr_b16 a[64:65], v22 offset:40960
    ds_read_b64_tr_b16 a[66:67], v22 offset:41472
    v_mfma_f32_16x16x32_bf16 v[88:91], a[72:75], a[36:39], v[88:91]
    buffer_load_dwordx2 v[102:103], v39, s[36:39], s76 offen offset:3584 sc1
    s_add_u32 s76, s76, 4096
    v_cvt_pk_bf16_f32 v178, v188, v189
    v_cvt_pk_bf16_f32 v179, v190, v191
    v_mfma_f32_16x16x32_bf16 v[84:87], a[76:79], a[32:35], v[84:87]
    ds_read_b64_tr_b16 a[68:69], v23 offset:40960
    ds_read_b64_tr_b16 a[70:71], v23 offset:41472
    buffer_store_dwordx4 v[176:179], v1, s[36:39], s19 offen offset:1024 sc1
    v_mfma_f32_16x16x32_bf16 v[92:95], a[76:79], a[36:39], v[92:95]
    v_mfma_f32_16x16x32_bf16 v[64:67], a[80:83], a[40:43], v[64:67]
    ds_read_b64_tr_b16 a[72:73], v24 offset:40960
    ds_read_b64_tr_b16 a[74:75], v24 offset:41472
    v_mfma_f32_16x16x32_bf16 v[72:75], a[80:83], a[44:47], v[72:75]
    s_waitcnt lgkmcnt(6)
    v_mfma_f32_16x16x32_bf16 v[68:71], a[84:87], a[40:43], v[68:71]
    s_nop 0
    ds_read_b64_tr_b16 a[76:77], v25 offset:40960
    ds_read_b64_tr_b16 a[78:79], v25 offset:41472
    v_mfma_f32_16x16x32_bf16 v[76:79], a[84:87], a[44:47], v[76:79]
    buffer_load_dwordx2 v[104:105], v39, s[36:39], s76 offen offset:512 sc1
    v_mfma_f32_16x16x32_bf16 v[80:83], a[88:91], a[40:43], v[80:83]
    ds_read_b64_tr_b16 a[80:81], v22 offset:45056
    ds_read_b64_tr_b16 a[82:83], v22 offset:45568
    v_mfma_f32_16x16x32_bf16 v[88:91], a[88:91], a[44:47], v[88:91]
    buffer_load_dwordx2 v[106:107], v39, s[36:39], s76 offen offset:1536 sc1
    v_mfma_f32_16x16x32_bf16 v[84:87], a[92:95], a[40:43], v[84:87]
    ds_read_b64_tr_b16 a[84:85], v23 offset:45056
    ds_read_b64_tr_b16 a[86:87], v23 offset:45568
    v_mfma_f32_16x16x32_bf16 v[92:95], a[92:95], a[44:47], v[92:95]
    s_waitcnt lgkmcnt(6)
    buffer_load_dwordx2 v[108:109], v39, s[36:39], s76 offen offset:2560 sc1
    v_mfma_f32_16x16x32_bf16 v[64:67], a[64:67], a[48:51], v[64:67]
    s_nop 0
    ds_read_b64_tr_b16 a[88:89], v24 offset:45056
    ds_read_b64_tr_b16 a[90:91], v24 offset:45568
    v_mfma_f32_16x16x32_bf16 v[72:75], a[64:67], a[52:55], v[72:75]
    buffer_load_dwordx2 v[110:111], v39, s[36:39], s76 offen offset:3584 sc1
    v_mfma_f32_16x16x32_bf16 v[68:71], a[68:71], a[48:51], v[68:71]
    s_add_u32 s76, s76, 4096
    ds_read_b64_tr_b16 a[92:93], v25 offset:45056
    ds_read_b64_tr_b16 a[94:95], v25 offset:45568
    v_mfma_f32_16x16x32_bf16 v[76:79], a[68:71], a[52:55], v[76:79]
    s_waitcnt vmcnt(13)
    v_mfma_f32_16x16x32_bf16 v[80:83], a[72:75], a[48:51], v[80:83]
    s_barrier
    ds_read_b64_tr_b16 a[64:65], v18 offset:0
    ds_read_b64_tr_b16 a[66:67], v18 offset:512
    v_mfma_f32_16x16x32_bf16 v[88:91], a[72:75], a[52:55], v[88:91]
    s_waitcnt lgkmcnt(6)
    buffer_load_dwordx2 v[112:113], v39, s[36:39], s76 offen offset:512 sc1
    v_mfma_f32_16x16x32_bf16 v[84:87], a[76:79], a[48:51], v[84:87]
    s_nop 0
    ds_read_b64_tr_b16 a[68:69], v19 offset:0
    ds_read_b64_tr_b16 a[70:71], v19 offset:512
    v_mfma_f32_16x16x32_bf16 v[92:95], a[76:79], a[52:55], v[92:95]
    buffer_load_dwordx2 v[114:115], v39, s[36:39], s76 offen offset:1536 sc1
    v_mfma_f32_16x16x32_bf16 v[64:67], a[80:83], a[56:59], v[64:67]
    ds_read_b64_tr_b16 a[72:73], v20 offset:0
    ds_read_b64_tr_b16 a[74:75], v20 offset:512
    v_mfma_f32_16x16x32_bf16 v[72:75], a[80:83], a[60:63], v[72:75]
    v_mfma_f32_16x16x32_bf16 v[68:71], a[84:87], a[56:59], v[68:71]
    ds_read_b64_tr_b16 a[76:77], v21 offset:0
    ds_read_b64_tr_b16 a[78:79], v21 offset:512
    v_mfma_f32_16x16x32_bf16 v[76:79], a[84:87], a[60:63], v[76:79]
    s_waitcnt lgkmcnt(6)
    buffer_load_dwordx2 v[116:117], v39, s[36:39], s76 offen offset:2560 sc1
    v_mfma_f32_16x16x32_bf16 v[80:83], a[88:91], a[56:59], v[80:83]
    s_nop 0
    ds_read_b64_tr_b16 a[80:81], v18 offset:4096
    ds_read_b64_tr_b16 a[82:83], v18 offset:4608
    v_mfma_f32_16x16x32_bf16 v[88:91], a[88:91], a[60:63], v[88:91]
    buffer_load_dwordx2 v[118:119], v39, s[36:39], s76 offen offset:3584 sc1
    v_mfma_f32_16x16x32_bf16 v[84:87], a[92:95], a[56:59], v[84:87]
    s_add_u32 s76, s76, 4096
    ds_read_b64_tr_b16 a[84:85], v19 offset:4096
    ds_read_b64_tr_b16 a[86:87], v19 offset:4608
    v_mfma_f32_16x16x32_bf16 v[92:95], a[92:95], a[60:63], v[92:95]
    buffer_load_dwordx2 v[120:121], v39, s[36:39], s76 offen offset:512 sc1
    v_mfma_f32_16x16x32_bf16 v[64:67], a[64:67], v[192:195], v[64:67]
    ds_read_b64_tr_b16 a[88:89], v20 offset:4096
    ds_read_b64_tr_b16 a[90:91], v20 offset:4608
    v_mfma_f32_16x16x32_bf16 v[72:75], a[64:67], v[196:199], v[72:75]
    s_waitcnt lgkmcnt(6)
    buffer_load_dwordx2 v[122:123], v39, s[36:39], s76 offen offset:1536 sc1
    v_mfma_f32_16x16x32_bf16 v[68:71], a[68:71], v[192:195], v[68:71]
    s_nop 0
    ds_read_b64_tr_b16 a[92:93], v21 offset:4096
    ds_read_b64_tr_b16 a[94:95], v21 offset:4608
    v_mfma_f32_16x16x32_bf16 v[76:79], a[68:71], v[196:199], v[76:79]
    buffer_load_dwordx2 v[124:125], v39, s[36:39], s76 offen offset:2560 sc1
    v_mfma_f32_16x16x32_bf16 v[80:83], a[72:75], v[192:195], v[80:83]
    ds_read_b64_tr_b16 a[64:65], v22 offset:0
    ds_read_b64_tr_b16 a[66:67], v22 offset:512
    v_mfma_f32_16x16x32_bf16 v[88:91], a[72:75], v[196:199], v[88:91]
    buffer_load_dwordx2 v[126:127], v39, s[36:39], s76 offen offset:3584 sc1
    v_mfma_f32_16x16x32_bf16 v[84:87], a[76:79], v[192:195], v[84:87]
    ds_read_b64_tr_b16 a[68:69], v23 offset:0
    ds_read_b64_tr_b16 a[70:71], v23 offset:512
    v_mfma_f32_16x16x32_bf16 v[92:95], a[76:79], v[196:199], v[92:95]
    s_waitcnt lgkmcnt(6) vmcnt(18)
    v_mfma_f32_4x4x4_16b_bf16 v[60:63], v[42:43], v[26:27], 0
    v_mfma_f32_16x16x32_bf16 v[64:67], a[80:83], v[200:203], v[64:67]
    s_nop 0
    ds_read_b64_tr_b16 a[72:73], v24 offset:0
    ds_read_b64_tr_b16 a[74:75], v24 offset:512
    v_mfma_f32_16x16x32_bf16 v[72:75], a[80:83], v[204:207], v[72:75]
    buffer_load_dwordx4 a[8:11], v1, s[36:39], s65 offen offset:2048 sc1
    v_mfma_f32_16x16x32_bf16 v[68:71], a[84:87], v[200:203], v[68:71]
    ds_read_b64_tr_b16 a[76:77], v25 offset:0
    ds_read_b64_tr_b16 a[78:79], v25 offset:512
    v_mfma_f32_16x16x32_bf16 v[76:79], a[84:87], v[204:207], v[76:79]
    v_add_f32 v60, v60, v60 row_ror:8
    v_add_f32 v61, v61, v61 row_ror:8
    v_mfma_f32_16x16x32_bf16 v[80:83], a[88:91], v[200:203], v[80:83]
    ds_read_b64_tr_b16 a[80:81], v22 offset:4096
    ds_read_b64_tr_b16 a[82:83], v22 offset:4608
    v_mfma_f32_16x16x32_bf16 v[88:91], a[88:91], v[204:207], v[88:91]
    s_waitcnt lgkmcnt(6)
    buffer_load_dwordx4 a[12:15], v1, s[36:39], s65 offen offset:3072 sc1
    v_mfma_f32_16x16x32_bf16 v[84:87], a[92:95], v[200:203], v[84:87]
    s_add_u32 s65, s12, s65
    ds_read_b64_tr_b16 a[84:85], v23 offset:4096
    ds_read_b64_tr_b16 a[86:87], v23 offset:4608
    v_mfma_f32_16x16x32_bf16 v[92:95], a[92:95], v[204:207], v[92:95]
    v_add_f32 v62, v62, v62 row_ror:8
    v_add_f32 v63, v63, v63 row_ror:8
    v_mfma_f32_16x16x32_bf16 v[64:67], a[64:67], v[208:211], v[64:67]
    ds_read_b64_tr_b16 a[88:89], v24 offset:4096
    ds_read_b64_tr_b16 a[90:91], v24 offset:4608
    v_mfma_f32_16x16x32_bf16 v[72:75], a[64:67], v[212:215], v[72:75]
    buffer_load_dwordx4 a[16:19], v1, s[36:39], s65 offen offset:0 sc1
    v_mfma_f32_16x16x32_bf16 v[68:71], a[68:71], v[208:211], v[68:71]
    ds_read_b64_tr_b16 a[92:93], v25 offset:4096
    ds_read_b64_tr_b16 a[94:95], v25 offset:4608
    v_mfma_f32_16x16x32_bf16 v[76:79], a[68:71], v[212:215], v[76:79]
    s_waitcnt lgkmcnt(6) vmcnt(15)
    s_add_u32 s72, s78, 128
    s_atomic_add s3, s[36:37], s72
    v_mfma_f32_16x16x32_bf16 v[80:83], a[72:75], v[208:211], v[80:83]
    s_nop 0
    ds_read_b64_tr_b16 a[64:65], v18 offset:8192
    ds_read_b64_tr_b16 a[66:67], v18 offset:8704
    v_mfma_f32_16x16x32_bf16 v[88:91], a[72:75], v[212:215], v[88:91]
    v_add_f32 v60, v60, v60 row_ror:4
    v_add_f32 v61, v61, v61 row_ror:4
    v_mfma_f32_16x16x32_bf16 v[84:87], a[76:79], v[208:211], v[84:87]
    ds_read_b64_tr_b16 a[68:69], v19 offset:8192
    ds_read_b64_tr_b16 a[70:71], v19 offset:8704
    v_mfma_f32_16x16x32_bf16 v[92:95], a[76:79], v[212:215], v[92:95]
    buffer_load_dwordx4 a[20:23], v1, s[36:39], s65 offen offset:1024 sc1
    v_mfma_f32_16x16x32_bf16 v[64:67], a[80:83], v[216:219], v[64:67]
    ds_read_b64_tr_b16 a[72:73], v20 offset:8192
    ds_read_b64_tr_b16 a[74:75], v20 offset:8704
    v_mfma_f32_16x16x32_bf16 v[72:75], a[80:83], v[220:223], v[72:75]
    s_waitcnt lgkmcnt(6)
    v_add_f32 v62, v62, v62 row_ror:4
    v_add_f32 v63, v63, v63 row_ror:4
    v_mfma_f32_16x16x32_bf16 v[68:71], a[84:87], v[216:219], v[68:71]
    s_nop 0
    ds_read_b64_tr_b16 a[76:77], v21 offset:8192
    ds_read_b64_tr_b16 a[78:79], v21 offset:8704
    v_mfma_f32_16x16x32_bf16 v[76:79], a[84:87], v[220:223], v[76:79]
    buffer_load_dwordx4 a[24:27], v1, s[36:39], s65 offen offset:2048 sc1
    v_mfma_f32_16x16x32_bf16 v[80:83], a[88:91], v[216:219], v[80:83]
    ds_read_b64_tr_b16 a[80:81], v18 offset:12288
    ds_read_b64_tr_b16 a[82:83], v18 offset:12800
    v_mfma_f32_16x16x32_bf16 v[88:91], a[88:91], v[220:223], v[88:91]
    v_add_f32 v60, v60, v60 row_ror:2
    v_add_f32 v61, v61, v61 row_ror:2
    v_mfma_f32_16x16x32_bf16 v[84:87], a[92:95], v[216:219], v[84:87]
    ds_read_b64_tr_b16 a[84:85], v19 offset:12288
    ds_read_b64_tr_b16 a[86:87], v19 offset:12800
    v_mfma_f32_16x16x32_bf16 v[92:95], a[92:95], v[220:223], v[92:95]
    s_waitcnt lgkmcnt(6)
    v_add_f32 v62, v62, v62 row_ror:2
    v_add_f32 v63, v63, v63 row_ror:2
    v_mfma_f32_16x16x32_bf16 v[64:67], a[64:67], v[224:227], v[64:67]
    s_nop 0
    ds_read_b64_tr_b16 a[88:89], v20 offset:12288
    ds_read_b64_tr_b16 a[90:91], v20 offset:12800
    v_mfma_f32_16x16x32_bf16 v[72:75], a[64:67], v[228:231], v[72:75]
    buffer_load_dwordx4 a[28:31], v1, s[36:39], s65 offen offset:3072 sc1
    v_mfma_f32_16x16x32_bf16 v[68:71], a[68:71], v[224:227], v[68:71]
    s_add_u32 s65, s17, s65
    ds_read_b64_tr_b16 a[92:93], v21 offset:12288
    ds_read_b64_tr_b16 a[94:95], v21 offset:12800
    v_mfma_f32_16x16x32_bf16 v[76:79], a[68:71], v[228:231], v[76:79]
    s_nop 0
    v_add_f32 v60, v60, v60 row_ror:1
    v_add_f32 v61, v61, v61 row_ror:1
    v_mfma_f32_16x16x32_bf16 v[80:83], a[72:75], v[224:227], v[80:83]
    ds_read_b64_tr_b16 a[64:65], v22 offset:8192
    ds_read_b64_tr_b16 a[66:67], v22 offset:8704
    v_mfma_f32_16x16x32_bf16 v[88:91], a[72:75], v[228:231], v[88:91]
    s_waitcnt lgkmcnt(6)
    v_add_f32 v62, v62, v62 row_ror:1
    v_add_f32 v63, v63, v63 row_ror:1
    v_mfma_f32_16x16x32_bf16 v[84:87], a[76:79], v[224:227], v[84:87]
    s_nop 0
    ds_read_b64_tr_b16 a[68:69], v23 offset:8192
    ds_read_b64_tr_b16 a[70:71], v23 offset:8704
    v_mfma_f32_16x16x32_bf16 v[92:95], a[76:79], v[228:231], v[92:95]
    buffer_load_dwordx4 a[32:35], v1, s[36:39], s65 offen offset:0 sc1
    v_mfma_f32_16x16x32_bf16 v[64:67], a[80:83], v[232:235], v[64:67]
    ds_read_b64_tr_b16 a[72:73], v24 offset:8192
    ds_read_b64_tr_b16 a[74:75], v24 offset:8704
    v_mfma_f32_16x16x32_bf16 v[72:75], a[80:83], v[236:239], v[72:75]
    s_waitcnt vmcnt(15)
    v_mfma_f32_4x4x4_16b_bf16 v[56:59], v[42:43], v[96:97], 0
    v_mfma_f32_4x4x4_16b_bf16 v[10:13], v[42:43], v[98:99], 0
    v_mfma_f32_4x4x4_16b_bf16 v[26:29], v[42:43], v[100:101], 0
    v_mfma_f32_4x4x4_16b_bf16 v[56:59], v[42:43], v[102:103], v[56:59]
    v_mfma_f32_4x4x4_16b_bf16 v[10:13], v[42:43], v[104:105], v[10:13]
    v_mfma_f32_4x4x4_16b_bf16 v[26:29], v[42:43], v[106:107], v[26:29]
    v_mfma_f32_4x4x4_16b_bf16 v[56:59], v[42:43], v[108:109], v[56:59]
    v_mfma_f32_4x4x4_16b_bf16 v[10:13], v[42:43], v[110:111], v[10:13]
    v_mfma_f32_16x16x32_bf16 v[68:71], a[84:87], v[232:235], v[68:71]
    s_nop 0
    ds_read_b64_tr_b16 a[76:77], v25 offset:8192
    ds_read_b64_tr_b16 a[78:79], v25 offset:8704
    v_mfma_f32_16x16x32_bf16 v[76:79], a[84:87], v[236:239], v[76:79]
    s_waitcnt lgkmcnt(6)
    buffer_load_dwordx4 a[36:39], v1, s[36:39], s65 offen offset:1024 sc1
    v_mfma_f32_16x16x32_bf16 v[80:83], a[88:91], v[232:235], v[80:83]
    s_nop 0
    ds_read_b64_tr_b16 a[80:81], v22 offset:12288
    ds_read_b64_tr_b16 a[82:83], v22 offset:12800
    v_mfma_f32_16x16x32_bf16 v[88:91], a[88:91], v[236:239], v[88:91]
    buffer_load_dwordx4 a[40:43], v1, s[36:39], s65 offen offset:2048 sc1
    v_mfma_f32_16x16x32_bf16 v[84:87], a[92:95], v[232:235], v[84:87]
    ds_read_b64_tr_b16 a[84:85], v23 offset:12288
    ds_read_b64_tr_b16 a[86:87], v23 offset:12800
    v_mfma_f32_16x16x32_bf16 v[92:95], a[92:95], v[236:239], v[92:95]
    s_waitcnt vmcnt(9)
    v_mfma_f32_4x4x4_16b_bf16 v[26:29], v[42:43], v[112:113], v[26:29]
    v_mfma_f32_4x4x4_16b_bf16 v[56:59], v[42:43], v[114:115], v[56:59]
    v_mfma_f32_4x4x4_16b_bf16 v[10:13], v[42:43], v[116:117], v[10:13]
    v_mfma_f32_4x4x4_16b_bf16 v[26:29], v[42:43], v[118:119], v[26:29]
    v_mfma_f32_4x4x4_16b_bf16 v[56:59], v[42:43], v[120:121], v[56:59]
    v_mfma_f32_4x4x4_16b_bf16 v[10:13], v[42:43], v[122:123], v[10:13]
    v_mfma_f32_4x4x4_16b_bf16 v[26:29], v[42:43], v[124:125], v[26:29]
    v_mfma_f32_4x4x4_16b_bf16 v[56:59], v[42:43], v[126:127], v[56:59]
    v_mfma_f32_16x16x32_bf16 v[64:67], a[64:67], v[240:243], v[64:67]
    s_nop 0
    ds_read_b64_tr_b16 a[88:89], v24 offset:12288
    ds_read_b64_tr_b16 a[90:91], v24 offset:12800
    v_mfma_f32_16x16x32_bf16 v[72:75], a[64:67], v[244:247], v[72:75]
    s_waitcnt lgkmcnt(6)
    buffer_load_dwordx4 a[44:47], v1, s[36:39], s65 offen offset:3072 sc1
    v_mfma_f32_16x16x32_bf16 v[68:71], a[68:71], v[240:243], v[68:71]
    s_add_u32 s65, s13, s65
    ds_read_b64_tr_b16 a[92:93], v25 offset:12288
    ds_read_b64_tr_b16 a[94:95], v25 offset:12800
    v_mfma_f32_16x16x32_bf16 v[76:79], a[68:71], v[244:247], v[76:79]
    buffer_load_dwordx4 a[48:51], v1, s[36:39], s65 offen offset:0 sc1
    v_mfma_f32_16x16x32_bf16 v[80:83], a[72:75], v[240:243], v[80:83]
    v_add_f32 v10, v10, v26
    v_add_f32 v11, v11, v27
    v_mfma_f32_16x16x32_bf16 v[88:91], a[72:75], v[244:247], v[88:91]
    v_add_f32 v12, v12, v28
    v_add_f32 v13, v13, v29
    v_mfma_f32_16x16x32_bf16 v[84:87], a[76:79], v[240:243], v[84:87]
    v_add_f32 v56, v56, v10
    v_add_f32 v57, v57, v11
    v_mfma_f32_16x16x32_bf16 v[92:95], a[76:79], v[244:247], v[92:95]
    s_waitcnt lgkmcnt(2)
    buffer_load_dwordx4 a[52:55], v1, s[36:39], s65 offen offset:1024 sc1
    v_mfma_f32_16x16x32_bf16 v[64:67], a[80:83], v[248:251], v[64:67]
    v_add_f32 v58, v58, v12
    v_add_f32_e64 v59, v59, v13
    v_mfma_f32_16x16x32_bf16 v[72:75], a[80:83], v[252:255], v[72:75]
    v_cvt_pk_bf16_f32 v56, v56, v57
    v_cvt_pk_bf16_f32 v57, v58, v59
    v_mfma_f32_16x16x32_bf16 v[68:71], a[84:87], v[248:251], v[68:71]
    v_cvt_pk_bf16_f32 v58, v60, v61
    v_cvt_pk_bf16_f32 v59, v62, v63
    v_mfma_f32_16x16x32_bf16 v[76:79], a[84:87], v[252:255], v[76:79]
L_padA5:
    s_cbranch_execz L_padret
    buffer_load_dwordx4 a[56:59], v1, s[36:39], s65 offen offset:2048 sc1
    v_mfma_f32_16x16x32_bf16 v[80:83], a[88:91], v[248:251], v[80:83]
    v_mfma_f32_16x16x32_bf16 v[88:91], a[88:91], v[252:255], v[88:91]
    s_nop 0
    ds_read_b32 v55, v30
    s_waitcnt lgkmcnt(1)
    ds_write_b128 v52, v[56:59] offset:4096
    v_pk_fma_f32 v[64:65], v[64:65], v[34:35], s[70:71] op_sel:[0,0,0] op_sel_hi:[1,0,0] neg_lo:[0,1,0] neg_hi:[0,1,0]
    v_mfma_f32_16x16x32_bf16 v[84:87], a[92:95], v[248:251], v[84:87]
    s_nop 0
    v_exp_f32 v44, v64 clamp
    v_mfma_f32_16x16x32_bf16 v[92:95], a[92:95], v[252:255], v[92:95]
    buffer_load_dwordx4 a[60:63], v1, s[36:39], s65 offen offset:3072 sc1
    s_barrier
    v_mfma_f32_16x16x32_bf16 v[192:195], a[96:99], a[0:3], 0
    s_nop 0
    ds_read_b32 v55, v30
    s_waitcnt lgkmcnt(1)
    buffer_load_dwordx4 v14, s[44:47], s62 offen offset:0 lds
    s_barrier
    v_pk_fma_f32 v[66:67], v[66:67], v[34:35], s[70:71] op_sel:[0,0,0] op_sel_hi:[1,0,0] neg_lo:[0,1,0] neg_hi:[0,1,0]
    v_pk_fma_f32 v[68:69], v[68:69], v[34:35], s[70:71] op_sel:[0,0,0] op_sel_hi:[1,0,0] neg_lo:[0,1,0] neg_hi:[0,1,0]
    v_pk_fma_f32 v[70:71], v[70:71], v[34:35], s[70:71] op_sel:[0,0,0] op_sel_hi:[1,0,0] neg_lo:[0,1,0] neg_hi:[0,1,0]
    v_exp_f32 v45, v65 clamp
    v_pk_fma_f32 v[72:73], v[72:73], v[34:35], s[70:71] op_sel:[0,1,0] op_sel_hi:[1,1,0] neg_lo:[0,1,0] neg_hi:[0,1,0]
    v_max_f32 v64, s70, v64
    v_max_f32 v65, s70, v65
    v_mfma_f32_16x16x32_bf16 v[196:199], a[100:103], a[0:3], 0
    buffer_load_dwordx4 v15, s[44:47], s62 offen offset:1024 lds
    ds_read_b128 v[56:59], v53 offset:4096
    ds_read_b128 v[60:63], v53 offset:12288
    v_exp_f32 v46, v66 clamp
    v_pk_fma_f32 v[64:65], v[64:65], s[70:71], v[44:45] op_sel:[0,1,0] op_sel_hi:[1,1,1]
    v_exp_f32 v47, v67 clamp
    v_max_f32_e64 v66, s70, v66
    v_pk_fma_f32 v[74:75], v[74:75], v[34:35], s[70:71] op_sel:[0,1,0] op_sel_hi:[1,1,0] neg_lo:[0,1,0] neg_hi:[0,1,0]
    v_max_f32_e64 v67, s70, v67
    v_mfma_f32_16x16x32_bf16 v[200:203], a[104:107], a[0:3], 0
    buffer_load_dwordx4 v16, s[44:47], s62 offen offset:2048 lds
    ds_read_b128 v[10:13], v53 offset:20480
    ds_read_b128 v[26:29], v53 offset:28672
    v_exp_f32 v44, v68 clamp
    v_pk_fma_f32 v[66:67], v[66:67], s[70:71], v[46:47] op_sel:[0,1,0] op_sel_hi:[1,1,1]
    v_exp_f32 v45, v69 clamp
    v_max_f32 v68, s70, v68
    v_max_f32 v69, s70, v69
    v_pk_fma_f32 v[68:69], v[68:69], s[70:71], v[44:45] op_sel:[0,1,0] op_sel_hi:[1,1,1]
    v_mfma_f32_16x16x32_bf16 v[204:207], a[108:111], a[0:3], 0
    buffer_load_dwordx4 v17, s[44:47], s62 offen offset:3072 lds
    v_cvt_pk_bf16_f32 v64, v64, v65
    v_exp_f32 v46, v70 clamp
    v_pk_fma_f32 v[76:77], v[76:77], v[34:35], s[70:71] op_sel:[0,1,0] op_sel_hi:[1,1,0] neg_lo:[0,1,0] neg_hi:[0,1,0]
    v_exp_f32 v47, v71 clamp
    v_max_f32 v70, s70, v70
    v_max_f32 v71, s70, v71
    v_pk_fma_f32 v[70:71], v[70:71], s[70:71], v[46:47] op_sel:[0,1,0] op_sel_hi:[1,1,1]
    v_pk_fma_f32 v[78:79], v[78:79], v[34:35], s[70:71] op_sel:[0,1,0] op_sel_hi:[1,1,0] neg_lo:[0,1,0] neg_hi:[0,1,0]
    v_mfma_f32_16x16x32_bf16 v[208:211], a[96:99], a[4:7], 0
    s_lshl3_add_u32 s62, s11, s85
    v_cvt_pk_bf16_f32 v65, v66, v67
    v_exp_f32 v44, v72 clamp
    v_exp_f32 v45, v73 clamp
    v_max_f32 v72, s70, v72
    v_max_f32_e64 v73, s70, v73
    v_pk_fma_f32 v[72:73], v[72:73], s[70:71], v[44:45] op_sel:[0,1,0] op_sel_hi:[1,1,1]
    v_pk_fma_f32 v[80:81], v[80:81], v[34:35], s[70:71] op_sel:[0,0,0] op_sel_hi:[1,0,0] neg_lo:[0,1,0] neg_hi:[0,1,0]
    v_cvt_pk_bf16_f32 v66, v68, v69
    v_exp_f32 v46, v74 clamp
    v_mfma_f32_16x16x32_bf16 v[212:215], a[100:103], a[4:7], 0
    s_add_u32 m0, s60, 24576
    v_exp_f32 v47, v75 clamp
    v_max_f32 v74, s70, v74
    v_max_f32 v75, s70, v75
    v_cvt_pk_bf16_f32 v67, v70, v71
    v_pk_fma_f32 v[74:75], v[74:75], s[70:71], v[46:47] op_sel:[0,1,0] op_sel_hi:[1,1,1]
    v_pk_fma_f32 v[82:83], v[82:83], v[34:35], s[70:71] op_sel:[0,0,0] op_sel_hi:[1,0,0] neg_lo:[0,1,0] neg_hi:[0,1,0]
    v_exp_f32 v44, v76 clamp
    v_exp_f32 v45, v77 clamp
    v_max_f32_e64 v76, s70, v76
    v_mfma_f32_16x16x32_bf16 v[216:219], a[104:107], a[4:7], 0
    buffer_load_dwordx4 v14, s[48:51], s62 offen offset:0 lds
    v_max_f32_e64 v77, s70, v77
    v_cvt_pk_bf16_f32 v68, v72, v73
    v_exp_f32 v46, v78 clamp
    v_pk_fma_f32 v[76:77], v[76:77], s[70:71], v[44:45] op_sel:[0,1,0] op_sel_hi:[1,1,1]
    v_pk_fma_f32 v[84:85], v[84:85], v[34:35], s[70:71] op_sel:[0,0,0] op_sel_hi:[1,0,0] neg_lo:[0,1,0] neg_hi:[0,1,0]
    v_exp_f32 v47, v79 clamp
    v_max_f32 v78, s70, v78
    v_max_f32 v79, s70, v79
    v_mfma_f32_16x16x32_bf16 v[220:223], a[108:111], a[4:7], 0
    buffer_load_dwordx4 v15, s[48:51], s62 offen offset:1024 lds
    v_cvt_pk_bf16_f32 v69, v74, v75
    v_exp_f32 v44, v80 clamp
    v_pk_fma_f32 v[78:79], v[78:79], s[70:71], v[46:47] op_sel:[0,1,0] op_sel_hi:[1,1,1]
    v_pk_fma_f32 v[86:87], v[86:87], v[34:35], s[70:71] op_sel:[0,0,0] op_sel_hi:[1,0,0] neg_lo:[0,1,0] neg_hi:[0,1,0]
    v_exp_f32 v45, v81 clamp
    v_max_f32 v80, s70, v80
    v_max_f32 v81, s70, v81
    v_pk_fma_f32 v[80:81], v[80:81], s[70:71], v[44:45] op_sel:[0,1,0] op_sel_hi:[1,1,1]
    s_waitcnt vmcnt(18)
    v_mfma_f32_16x16x32_bf16 v[224:227], a[96:99], a[8:11], 0
    buffer_load_dwordx4 v16, s[48:51], s62 offen offset:2048 lds
    v_cvt_pk_bf16_f32 v70, v76, v77
    v_exp_f32 v46, v82 clamp
    v_pk_fma_f32 v[88:89], v[88:89], v[34:35], s[70:71] op_sel:[0,1,0] op_sel_hi:[1,1,0] neg_lo:[0,1,0] neg_hi:[0,1,0]
    v_exp_f32 v47, v83 clamp
    v_max_f32 v82, s70, v82
    v_max_f32_e64 v83, s70, v83
    v_pk_fma_f32 v[82:83], v[82:83], s[70:71], v[46:47] op_sel:[0,1,0] op_sel_hi:[1,1,1]
    v_pk_fma_f32 v[90:91], v[90:91], v[34:35], s[70:71] op_sel:[0,1,0] op_sel_hi:[1,1,0] neg_lo:[0,1,0] neg_hi:[0,1,0]
    v_mfma_f32_16x16x32_bf16 v[228:231], a[100:103], a[8:11], 0
    buffer_load_dwordx4 v17, s[48:51], s62 offen offset:3072 lds
    v_cvt_pk_bf16_f32 v71, v78, v79
    v_exp_f32 v44, v84 clamp
    v_exp_f32 v45, v85 clamp
    v_max_f32 v84, s70, v84
    v_max_f32 v85, s70, v85
    v_pk_fma_f32 v[84:85], v[84:85], s[70:71], v[44:45] op_sel:[0,1,0] op_sel_hi:[1,1,1]
    v_pk_fma_f32 v[92:93], v[92:93], v[34:35], s[70:71] op_sel:[0,1,0] op_sel_hi:[1,1,0] neg_lo:[0,1,0] neg_hi:[0,1,0]
    v_cvt_pk_bf16_f32 v80, v80, v81
    v_mfma_f32_16x16x32_bf16 v[232:235], a[104:107], a[8:11], 0
    s_lshl3_add_u32 s62, s12, s62
    v_exp_f32 v46, v86 clamp
    v_exp_f32 v47, v87 clamp
    v_max_f32 v86, s70, v86
    v_max_f32_e64 v87, s70, v87
    v_pk_fma_f32 v[86:87], v[86:87], s[70:71], v[46:47] op_sel:[0,1,0] op_sel_hi:[1,1,1]
    v_pk_fma_f32 v[94:95], v[94:95], v[34:35], s[70:71] op_sel:[0,1,0] op_sel_hi:[1,1,0] neg_lo:[0,1,0] neg_hi:[0,1,0]
    v_cvt_pk_bf16_f32 v81, v82, v83
    v_exp_f32 v44, v88 clamp
    v_max_f32_e64 v88, s70, v88
    v_mfma_f32_16x16x32_bf16 v[236:239], a[108:111], a[8:11], 0
    s_add_u32 m0, s60, 32768
    v_exp_f32 v45, v89 clamp
    v_max_f32_e64 v89, s70, v89
    v_cvt_pk_bf16_f32 v82, v84, v85
    v_exp_f32 v46, v90 clamp
    v_pk_fma_f32 v[88:89], v[88:89], s[70:71], v[44:45] op_sel:[0,1,0] op_sel_hi:[1,1,1]
    v_exp_f32 v47, v91 clamp
    v_max_f32 v90, s70, v90
    v_max_f32 v91, s70, v91
    v_pk_fma_f32 v[90:91], v[90:91], s[70:71], v[46:47] op_sel:[0,1,0] op_sel_hi:[1,1,1]
    v_mfma_f32_16x16x32_bf16 v[240:243], a[96:99], a[12:15], 0
    buffer_load_dwordx4 v14, s[48:51], s62 offen offset:0 lds
    v_cvt_pk_bf16_f32 v83, v86, v87
    v_exp_f32 v44, v92 clamp
    v_exp_f32 v45, v93 clamp
    v_max_f32 v92, s70, v92
    v_max_f32 v93, s70, v93
    v_pk_fma_f32 v[92:93], v[92:93], s[70:71], v[44:45] op_sel:[0,1,0] op_sel_hi:[1,1,1]
    v_cvt_pk_bf16_f32 v84, v88, v89
    v_cvt_pk_bf16_f32 v85, v90, v91
    v_mfma_f32_16x16x32_bf16 v[244:247], a[100:103], a[12:15], 0
    buffer_load_dwordx4 v15, s[48:51], s62 offen offset:1024 lds
    v_exp_f32 v46, v94 clamp
    v_exp_f32 v47, v95 clamp
    v_max_f32 v94, s70, v94
    v_max_f32 v95, s70, v95
    v_pk_fma_f32 v[94:95], v[94:95], s[70:71], v[46:47] op_sel:[0,1,0] op_sel_hi:[1,1,1]
    v_cvt_pk_bf16_f32 v86, v92, v93
    v_cvt_pk_bf16_f32 v87, v94, v95
    s_add_u32 s19, s67, 4096
    v_mfma_f32_16x16x32_bf16 v[248:251], a[104:107], a[12:15], 0
    buffer_load_dword v38, off, s[36:39], s79 offset:128 sc1
    s_waitcnt lgkmcnt(0)
    v_mfma_f32_16x16x16_bf16 v[104:107], v[58:59], v[64:65], 0
    v_mfma_f32_16x16x16_bf16 v[108:111], v[62:63], v[66:67], 0
    v_mfma_f32_16x16x16_bf16 v[96:99], v[56:57], v[64:65], 0
    v_mfma_f32_16x16x16_bf16 v[100:103], v[60:61], v[66:67], 0
    v_mfma_f32_16x16x16_bf16 v[120:123], v[58:59], v[68:69], 0
    v_mfma_f32_16x16x16_bf16 v[124:127], v[62:63], v[70:71], 0
    v_mfma_f32_16x16x16_bf16 v[112:115], v[56:57], v[68:69], 0
    v_mfma_f32_16x16x16_bf16 v[116:119], v[60:61], v[70:71], 0
    s_nop 0
    v_add_f32 v104, s69, v104
    v_add_f32 v108, s69, v108
    v_rcp_f32 v104, v104
    v_rcp_f32 v108, v108
    v_mul_f32 v104, 0xbf317218, v104
    v_pk_mul_f32 v[96:97], v[96:97], v[104:105] op_sel_hi:[1,0]
    v_pk_mul_f32 v[98:99], v[98:99], v[104:105] op_sel_hi:[1,0]
    v_mfma_f32_16x16x32_bf16 v[252:255], a[108:111], a[12:15], 0
    buffer_load_dwordx4 v16, s[48:51], s62 offen offset:2048 lds
    v_mul_f32 v108, 0xbf317218, v108
    v_cvt_pk_bf16_f32 v72, v96, v97
    v_cvt_pk_bf16_f32 v73, v98, v99
    v_pk_mul_f32 v[100:101], v[100:101], v[108:109] op_sel_hi:[1,0]
    v_pk_mul_f32 v[102:103], v[102:103], v[108:109] op_sel_hi:[1,0]
    v_cvt_pk_bf16_f32 v74, v100, v101
    v_cvt_pk_bf16_f32 v75, v102, v103
    v_mbcnt_lo_u32_b32 v5, -1, 0
    v_mbcnt_hi_u32_b32 v5, -1, v5
    v_lshlrev_b32 v5, 4, v5
    s_waitcnt vmcnt(22)
    v_mfma_f32_16x16x32_bf16 v[192:195], a[112:115], a[16:19], v[192:195]
    buffer_store_dwordx4 v[72:75], v1, s[36:39], s67 offen offset:0 sc1
    v_add_f32 v120, s69, v120
    v_add_f32 v124, s69, v124
    v_rcp_f32 v120, v120
    v_rcp_f32 v124, v124
    v_mul_f32 v120, 0xbf317218, v120
    v_pk_mul_f32 v[112:113], v[112:113], v[120:121] op_sel_hi:[1,0]
    v_pk_mul_f32 v[114:115], v[114:115], v[120:121] op_sel_hi:[1,0]
    v_mul_f32 v124, 0xbf317218, v124
    v_mfma_f32_16x16x32_bf16 v[196:199], a[116:119], a[16:19], v[196:199]
    buffer_load_dwordx4 v17, s[48:51], s62 offen offset:3072 lds
    v_cvt_pk_bf16_f32 v76, v112, v113
    v_cvt_pk_bf16_f32 v77, v114, v115
    v_pk_mul_f32 v[116:117], v[116:117], v[124:125] op_sel_hi:[1,0]
    v_pk_mul_f32 v[118:119], v[118:119], v[124:125] op_sel_hi:[1,0]
    v_cvt_pk_bf16_f32 v78, v116, v117
    v_cvt_pk_bf16_f32 v79, v118, v119
    v_and_b32 v41, 0x70, v5
    v_lshrrev_b32 v7, 7, v5
    v_lshlrev_b32 v8, 1, v41
    v_mfma_f32_16x16x32_bf16 v[200:203], a[120:123], a[16:19], v[200:203]
    s_lshl3_add_u32 s62, s14, s62
    buffer_store_dwordx4 v[76:79], v1, s[36:39], s67 offen offset:1024 sc1
    v_mfma_f32_16x16x16_bf16 v[104:107], v[12:13], v[80:81], 0
    v_mfma_f32_16x16x16_bf16 v[108:111], v[28:29], v[82:83], 0
    v_mfma_f32_16x16x16_bf16 v[96:99], v[10:11], v[80:81], 0
    v_mfma_f32_16x16x16_bf16 v[100:103], v[26:27], v[82:83], 0
    v_mfma_f32_16x16x16_bf16 v[120:123], v[12:13], v[84:85], 0
    v_mfma_f32_16x16x16_bf16 v[124:127], v[28:29], v[86:87], 0
    v_mfma_f32_16x16x16_bf16 v[112:115], v[10:11], v[84:85], 0
    v_mfma_f32_16x16x16_bf16 v[116:119], v[26:27], v[86:87], 0
    s_nop 0
    v_add_f32 v104, s69, v104
    v_add_f32 v108, s69, v108
    v_rcp_f32 v104, v104
    v_rcp_f32 v108, v108
    v_mul_f32 v104, 0xbf317218, v104
    v_pk_mul_f32 v[96:97], v[96:97], v[104:105] op_sel_hi:[1,0]
    v_pk_mul_f32 v[98:99], v[98:99], v[104:105] op_sel_hi:[1,0]
    v_mfma_f32_16x16x32_bf16 v[204:207], a[124:127], a[16:19], v[204:207]
    s_add_u32 m0, s60, 40960
    v_mul_f32 v108, 0xbf317218, v108
    v_cvt_pk_bf16_f32 v88, v96, v97
    v_cvt_pk_bf16_f32 v89, v98, v99
    v_pk_mul_f32 v[100:101], v[100:101], v[108:109] op_sel_hi:[1,0]
    v_pk_mul_f32 v[102:103], v[102:103], v[108:109] op_sel_hi:[1,0]
    v_cvt_pk_bf16_f32 v90, v100, v101
    v_cvt_pk_bf16_f32 v91, v102, v103
    v_lshlrev_b32 v6, 4, v7
    v_xor_b32 v8, v8, v6
    v_lshl_add_u32 v41, v7, 10, v41
    v_mfma_f32_16x16x32_bf16 v[208:211], a[112:115], a[20:23], v[208:211]
    buffer_store_dwordx4 v[88:91], v1, s[36:39], s19 offen offset:0 sc1
    v_add_f32 v120, s69, v120
    v_add_f32 v124, s69, v124
    v_rcp_f32 v120, v120
    v_rcp_f32 v124, v124
    v_mul_f32 v120, 0xbf317218, v120
    v_pk_mul_f32 v[112:113], v[112:113], v[120:121] op_sel_hi:[1,0]
    v_pk_mul_f32 v[114:115], v[114:115], v[120:121] op_sel_hi:[1,0]
    v_mul_f32 v124, 0xbf317218, v124
    v_mfma_f32_16x16x32_bf16 v[212:215], a[116:119], a[20:23], v[212:215]
    buffer_load_dwordx4 v14, s[48:51], s62 offen offset:0 lds
    v_cvt_pk_bf16_f32 v92, v112, v113
    v_cvt_pk_bf16_f32 v93, v114, v115
    v_pk_mul_f32 v[116:117], v[116:117], v[124:125] op_sel_hi:[1,0]
    v_pk_mul_f32 v[118:119], v[118:119], v[124:125] op_sel_hi:[1,0]
    v_cvt_pk_bf16_f32 v94, v116, v117
    v_cvt_pk_bf16_f32 v95, v118, v119
    v_lshl_add_u32 v8, v7, 8, v8
    s_mul_i32 s73, s75, 2176
    v_xor_b32_e64 v8, s73, v8
    v_mfma_f32_16x16x32_bf16 v[216:219], a[120:123], a[20:23], v[216:219]
    s_lshl_b32 s73, s61, 13
    buffer_store_dwordx4 v[92:95], v1, s[36:39], s19 offen offset:1024 sc1
    s_waitcnt vmcnt(7)
    v_readfirstlane_b32 s72, v38
    s_nop 0
    s_cmp_ge_u32 s72, 8
    s_cbranch_scc0 L_slow_M2A
L_back_M2A:
    v_add_u32 v6, s73, v8
    v_xor_b32 v7, 16, v6
    v_add_u32 v8, 65536, v6
    v_add_u32 v9, 65536, v7
    v_and_b32 v3, 0xf0, v5
    v_lshrrev_b32 v4, 4, v5
    v_and_b32 v4, 0x30, v4
    v_xor_b32_e64 v4, v3, v4
    v_mfma_f32_16x16x32_bf16 v[220:223], a[124:127], a[20:23], v[220:223]
    buffer_load_dwordx4 v15, s[48:51], s62 offen offset:1024 lds
    v_mfma_f32_16x16x32_bf16 v[224:227], a[112:115], a[24:27], v[224:227]
    buffer_load_dwordx4 v16, s[48:51], s62 offen offset:2048 lds
    v_mfma_f32_16x16x32_bf16 v[228:231], a[116:119], a[24:27], v[228:231]
    ds_read_b64_tr_b16 a[64:65], v30 offset:49152
    ds_read_b64_tr_b16 a[66:67], v30 offset:51200
    v_mfma_f32_16x16x32_bf16 v[232:235], a[120:123], a[24:27], v[232:235]
    buffer_load_dwordx4 v17, s[48:51], s62 offen offset:3072 lds
    v_mfma_f32_16x16x32_bf16 v[236:239], a[124:127], a[24:27], v[236:239]
    s_add_u32 s65, s9, s86
    ds_read_b64_tr_b16 a[68:69], v31 offset:49152
    ds_read_b64_tr_b16 a[70:71], v31 offset:51200
    v_mfma_f32_16x16x32_bf16 v[240:243], a[112:115], a[28:31], v[240:243]
    s_nop 0
    ds_read_b64_tr_b16 a[72:73], v32 offset:49152
    ds_read_b64_tr_b16 a[74:75], v32 offset:51200
    v_mfma_f32_16x16x32_bf16 v[244:247], a[116:119], a[28:31], v[244:247]
    ds_read_b64_tr_b16 a[76:77], v33 offset:49152
    ds_read_b64_tr_b16 a[78:79], v33 offset:51200
    v_mfma_f32_16x16x32_bf16 v[248:251], a[120:123], a[28:31], v[248:251]
    buffer_load_dwordx4 v[128:131], v1, s[36:39], s65 offen offset:0 sc1
    v_mfma_f32_16x16x32_bf16 v[252:255], a[124:127], a[28:31], v[252:255]
    ds_read_b64_tr_b16 a[80:81], v30 offset:57344
    ds_read_b64_tr_b16 a[82:83], v30 offset:59392
    v_mfma_f32_16x16x32_bf16 v[192:195], a[128:131], a[32:35], v[192:195]
    ds_read_b64_tr_b16 a[84:85], v31 offset:57344
    ds_read_b64_tr_b16 a[86:87], v31 offset:59392
    v_mfma_f32_16x16x32_bf16 v[196:199], a[132:135], a[32:35], v[196:199]
    ds_read_b64_tr_b16 a[88:89], v32 offset:57344
    ds_read_b64_tr_b16 a[90:91], v32 offset:59392
    v_mfma_f32_16x16x32_bf16 v[200:203], a[136:139], a[32:35], v[200:203]
    ds_read_b64_tr_b16 a[92:93], v33 offset:57344
    ds_read_b64_tr_b16 a[94:95], v33 offset:59392
    v_mfma_f32_16x16x32_bf16 v[204:207], a[140:143], a[32:35], v[204:207]
    ds_read_b64_tr_b16 a[96:97], v48 offset:0
    ds_read_b64_tr_b16 a[98:99], v48 offset:2048
    v_mfma_f32_16x16x32_bf16 v[208:211], a[128:131], a[36:39], v[208:211]
    ds_read_b64_tr_b16 a[100:101], v49 offset:0
    ds_read_b64_tr_b16 a[102:103], v49 offset:2048
    v_mfma_f32_16x16x32_bf16 v[212:215], a[132:135], a[36:39], v[212:215]
    ds_read_b64_tr_b16 a[104:105], v50 offset:0
    ds_read_b64_tr_b16 a[106:107], v50 offset:2048
    v_mfma_f32_16x16x32_bf16 v[216:219], a[136:139], a[36:39], v[216:219]
    buffer_load_dwordx4 v[132:135], v1, s[36:39], s65 offen offset:1024 sc1
    v_mfma_f32_16x16x32_bf16 v[220:223], a[140:143], a[36:39], v[220:223]
    ds_read_b64_tr_b16 a[108:109], v51 offset:0
    ds_read_b64_tr_b16 a[110:111], v51 offset:2048
    v_mfma_f32_16x16x32_bf16 v[224:227], a[128:131], a[40:43], v[224:227]
    ds_read_b64_tr_b16 a[112:113], v30 offset:16384
    ds_read_b64_tr_b16 a[114:115], v30 offset:18432
    v_mfma_f32_16x16x32_bf16 v[228:231], a[132:135], a[40:43], v[228:231]
    ds_read_b64_tr_b16 a[116:117], v31 offset:16384
    ds_read_b64_tr_b16 a[118:119], v31 offset:18432
    v_mfma_f32_16x16x32_bf16 v[232:235], a[136:139], a[40:43], v[232:235]
    ds_read_b64_tr_b16 a[120:121], v32 offset:16384
    ds_read_b64_tr_b16 a[122:123], v32 offset:18432
    v_mfma_f32_16x16x32_bf16 v[236:239], a[140:143], a[40:43], v[236:239]
    buffer_load_dwordx4 v[136:139], v1, s[36:39], s65 offen offset:2048 sc1
    v_mfma_f32_16x16x32_bf16 v[240:243], a[128:131], a[44:47], v[240:243]
    ds_read_b64_tr_b16 a[124:125], v33 offset:16384
    ds_read_b64_tr_b16 a[126:127], v33 offset:18432
    v_mfma_f32_16x16x32_bf16 v[244:247], a[132:135], a[44:47], v[244:247]
    v_lshl_add_u32 v4, v3, 4, v4
    v_add_u32_e64 v2, s60, v4
    v_mfma_f32_16x16x32_bf16 v[248:251], a[136:139], a[44:47], v[248:251]
    v_xor_b32_e64 v3, 64, v2
    v_xor_b32 v4, 128, v2
    v_mfma_f32_16x16x32_bf16 v[252:255], a[140:143], a[44:47], v[252:255]
    buffer_load_dwordx4 v[140:143], v1, s[36:39], s65 offen offset:3072 sc1
    v_mfma_f32_16x16x32_bf16 v[192:195], a[144:147], a[48:51], v[192:195]
    ds_read_b64_tr_b16 a[128:129], v30 offset:24576
    ds_read_b64_tr_b16 a[130:131], v30 offset:26624
    v_mfma_f32_16x16x32_bf16 v[196:199], a[148:151], a[48:51], v[196:199]
    s_lshl3_add_u32 s62, s13, s62
    ds_read_b64_tr_b16 a[132:133], v31 offset:24576
    ds_read_b64_tr_b16 a[134:135], v31 offset:26624
    v_mfma_f32_16x16x32_bf16 v[200:203], a[152:155], a[48:51], v[200:203]
    s_add_u32 m0, s60, 0
    ds_read_b64_tr_b16 a[136:137], v32 offset:24576
    ds_read_b64_tr_b16 a[138:139], v32 offset:26624
    v_mfma_f32_16x16x32_bf16 v[204:207], a[156:159], a[48:51], v[204:207]
    ds_read_b64_tr_b16 a[140:141], v33 offset:24576
    ds_read_b64_tr_b16 a[142:143], v33 offset:26624
    v_mfma_f32_16x16x32_bf16 v[208:211], a[144:147], a[52:55], v[208:211]
    v_xor_b32 v5, 192, v2
    v_mfma_f32_16x16x32_bf16 v[212:215], a[148:151], a[52:55], v[212:215]
    v_mfma_f32_16x16x32_bf16 v[216:219], a[152:155], a[52:55], v[216:219]
    v_mfma_f32_16x16x32_bf16 v[220:223], a[156:159], a[52:55], v[220:223]
    v_mfma_f32_16x16x32_bf16 v[224:227], a[144:147], a[56:59], v[224:227]
    v_mfma_f32_16x16x32_bf16 v[228:231], a[148:151], a[56:59], v[228:231]
    v_mfma_f32_16x16x32_bf16 v[232:235], a[152:155], a[56:59], v[232:235]
    v_mfma_f32_16x16x32_bf16 v[236:239], a[156:159], a[56:59], v[236:239]
    buffer_load_dwordx4 v14, s[48:51], s62 offen offset:0 lds
    v_mfma_f32_16x16x32_bf16 v[240:243], a[144:147], a[60:63], v[240:243]
    v_mfma_f32_16x16x32_bf16 v[244:247], a[148:151], a[60:63], v[244:247]
    v_mfma_f32_16x16x32_bf16 v[248:251], a[152:155], a[60:63], v[248:251]
    v_mfma_f32_16x16x32_bf16 v[252:255], a[156:159], a[60:63], v[252:255]
    s_waitcnt vmcnt(12)
    ds_read_b64_tr_b16 a[144:145], v30 offset:32768
    ds_read_b64_tr_b16 a[146:147], v30 offset:34816
    ds_read_b64_tr_b16 a[148:149], v31 offset:32768
    buffer_load_dwordx4 v15, s[48:51], s62 offen offset:1024 lds
    ds_read_b64_tr_b16 a[150:151], v31 offset:34816
    ds_read_b64_tr_b16 a[152:153], v32 offset:32768
    ds_read_b64_tr_b16 a[154:155], v32 offset:34816
    ds_read_b64_tr_b16 a[156:157], v33 offset:32768
    ds_read_b64_tr_b16 a[158:159], v33 offset:34816
    buffer_load_dwordx4 v16, s[48:51], s62 offen offset:2048 lds
    s_waitcnt vmcnt(10)
    s_add_u32 s72, s78, 256
    s_atomic_add s3, s[36:37], s72
    buffer_load_dwordx4 v17, s[48:51], s62 offen offset:3072 lds
    s_add_u32 s65, s12, s65
    buffer_load_dwordx4 v[144:147], v1, s[36:39], s65 offen offset:0 sc1
    buffer_load_dwordx4 v[148:151], v1, s[36:39], s65 offen offset:1024 sc1
    buffer_load_dwordx4 v[152:155], v1, s[36:39], s65 offen offset:2048 sc1
    s_waitcnt vmcnt(9)
    v_mfma_f32_16x16x32_bf16 v[192:195], a[160:163], v[128:131], v[192:195]
    buffer_load_dwordx4 v[156:159], v1, s[36:39], s65 offen offset:3072 sc1
    v_mfma_f32_16x16x32_bf16 v[196:199], a[164:167], v[128:131], v[196:199]
    s_add_u32 s65, s14, s65
    v_mfma_f32_16x16x32_bf16 v[200:203], a[168:171], v[128:131], v[200:203]
    v_mfma_f32_16x16x32_bf16 v[204:207], a[172:175], v[128:131], v[204:207]
    v_mfma_f32_16x16x32_bf16 v[208:211], a[160:163], v[132:135], v[208:211]
    buffer_load_dwordx4 v[160:163], v1, s[36:39], s65 offen offset:0 sc1
    v_mfma_f32_16x16x32_bf16 v[212:215], a[164:167], v[132:135], v[212:215]
    v_mfma_f32_16x16x32_bf16 v[216:219], a[168:171], v[132:135], v[216:219]
    v_mfma_f32_16x16x32_bf16 v[220:223], a[172:175], v[132:135], v[220:223]
    s_waitcnt vmcnt(9)
    v_mfma_f32_16x16x32_bf16 v[224:227], a[160:163], v[136:139], v[224:227]
    buffer_load_dwordx4 v[164:167], v1, s[36:39], s65 offen offset:1024 sc1
    v_mfma_f32_16x16x32_bf16 v[228:231], a[164:167], v[136:139], v[228:231]
    v_mfma_f32_16x16x32_bf16 v[232:235], a[168:171], v[136:139], v[232:235]
    v_mfma_f32_16x16x32_bf16 v[236:239], a[172:175], v[136:139], v[236:239]
    v_mfma_f32_16x16x32_bf16 v[240:243], a[160:163], v[140:143], v[240:243]
    buffer_load_dwordx4 v[168:171], v1, s[36:39], s65 offen offset:2048 sc1
    v_mfma_f32_16x16x32_bf16 v[244:247], a[164:167], v[140:143], v[244:247]
    v_mfma_f32_16x16x32_bf16 v[248:251], a[168:171], v[140:143], v[248:251]
    v_mfma_f32_16x16x32_bf16 v[252:255], a[172:175], v[140:143], v[252:255]
    ds_read_b64_tr_b16 a[160:161], v30 offset:40960
    ds_read_b64_tr_b16 a[162:163], v30 offset:43008
    ds_read_b64_tr_b16 a[164:165], v31 offset:40960
    buffer_load_dwordx4 v[172:175], v1, s[36:39], s65 offen offset:3072 sc1
    ds_read_b64_tr_b16 a[166:167], v31 offset:43008
    ds_read_b64_tr_b16 a[168:169], v32 offset:40960
    ds_read_b64_tr_b16 a[170:171], v32 offset:43008
    s_add_u32 s65, s13, s65
    ds_read_b64_tr_b16 a[172:173], v33 offset:40960
    ds_read_b64_tr_b16 a[174:175], v33 offset:43008
    buffer_load_dwordx4 v[176:179], v1, s[36:39], s65 offen offset:0 sc1
    buffer_load_dwordx4 v[180:183], v1, s[36:39], s65 offen offset:1024 sc1
    buffer_load_dwordx4 v[184:187], v1, s[36:39], s65 offen offset:2048 sc1
    s_waitcnt vmcnt(9)
    v_mfma_f32_16x16x32_bf16 v[192:195], a[176:179], v[144:147], v[192:195]
    buffer_load_dwordx4 v[188:191], v1, s[36:39], s65 offen offset:3072 sc1
    v_mfma_f32_16x16x32_bf16 v[196:199], a[180:183], v[144:147], v[196:199]
    s_add_u32 s65, s16, s65
    v_mfma_f32_16x16x32_bf16 v[200:203], a[184:187], v[144:147], v[200:203]
    v_mfma_f32_16x16x32_bf16 v[204:207], a[188:191], v[144:147], v[204:207]
    v_mfma_f32_16x16x32_bf16 v[208:211], a[176:179], v[148:151], v[208:211]
    buffer_load_dwordx4 a[0:3], v1, s[36:39], s65 offen offset:0 sc1
    v_mfma_f32_16x16x32_bf16 v[212:215], a[180:183], v[148:151], v[212:215]
    v_mfma_f32_16x16x32_bf16 v[216:219], a[184:187], v[148:151], v[216:219]
    v_mfma_f32_16x16x32_bf16 v[220:223], a[188:191], v[148:151], v[220:223]
    s_waitcnt vmcnt(9)
    v_mfma_f32_16x16x32_bf16 v[224:227], a[176:179], v[152:155], v[224:227]
    buffer_load_dwordx4 a[4:7], v1, s[36:39], s65 offen offset:1024 sc1
    v_mfma_f32_16x16x32_bf16 v[228:231], a[180:183], v[152:155], v[228:231]
    v_mfma_f32_16x16x32_bf16 v[232:235], a[184:187], v[152:155], v[232:235]
    v_mfma_f32_16x16x32_bf16 v[236:239], a[188:191], v[152:155], v[236:239]
    v_mfma_f32_16x16x32_bf16 v[240:243], a[176:179], v[156:159], v[240:243]
    buffer_load_dwordx4 a[8:11], v1, s[36:39], s65 offen offset:2048 sc1
    v_mfma_f32_16x16x32_bf16 v[244:247], a[180:183], v[156:159], v[244:247]
    v_mfma_f32_16x16x32_bf16 v[248:251], a[184:187], v[156:159], v[248:251]
    v_mfma_f32_16x16x32_bf16 v[252:255], a[188:191], v[156:159], v[252:255]
    ds_read_b64_tr_b16 a[176:177], v30 offset:0
    ds_read_b64_tr_b16 a[178:179], v30 offset:2048
    ds_read_b64_tr_b16 a[180:181], v31 offset:0
    ds_read_b64_tr_b16 a[182:183], v31 offset:2048
    ds_read_b64_tr_b16 a[184:185], v32 offset:0
    ds_read_b64_tr_b16 a[186:187], v32 offset:2048
    s_waitcnt vmcnt(9)
    v_mfma_f32_16x16x32_bf16 v[192:195], a[192:195], v[160:163], v[192:195]
    buffer_load_dwordx4 a[12:15], v1, s[36:39], s65 offen offset:3072 sc1
    v_mfma_f32_16x16x32_bf16 v[196:199], a[196:199], v[160:163], v[196:199]
    s_add_u32 s65, s12, s65
    ds_read_b64_tr_b16 a[188:189], v33 offset:0
    ds_read_b64_tr_b16 a[190:191], v33 offset:2048
    v_mfma_f32_16x16x32_bf16 v[200:203], a[200:203], v[160:163], v[200:203]
    v_mfma_f32_16x16x32_bf16 v[204:207], a[204:207], v[160:163], v[204:207]
    v_mfma_f32_16x16x32_bf16 v[208:211], a[192:195], v[164:167], v[208:211]
    buffer_load_dwordx4 a[16:19], v1, s[36:39], s65 offen offset:0 sc1
    v_mfma_f32_16x16x32_bf16 v[212:215], a[196:199], v[164:167], v[212:215]
    v_mfma_f32_16x16x32_bf16 v[216:219], a[200:203], v[164:167], v[216:219]
    v_mfma_f32_16x16x32_bf16 v[220:223], a[204:207], v[164:167], v[220:223]
    s_waitcnt vmcnt(9)
    v_mfma_f32_16x16x32_bf16 v[224:227], a[192:195], v[168:171], v[224:227]
    buffer_load_dwordx4 a[20:23], v1, s[36:39], s65 offen offset:1024 sc1
    v_mfma_f32_16x16x32_bf16 v[228:231], a[196:199], v[168:171], v[228:231]
    v_mfma_f32_16x16x32_bf16 v[232:235], a[200:203], v[168:171], v[232:235]
    v_mfma_f32_16x16x32_bf16 v[236:239], a[204:207], v[168:171], v[236:239]
    v_mfma_f32_16x16x32_bf16 v[240:243], a[192:195], v[172:175], v[240:243]
    buffer_load_dwordx4 a[24:27], v1, s[36:39], s65 offen offset:2048 sc1
    v_mfma_f32_16x16x32_bf16 v[244:247], a[196:199], v[172:175], v[244:247]
    v_mfma_f32_16x16x32_bf16 v[248:251], a[200:203], v[172:175], v[248:251]
    v_mfma_f32_16x16x32_bf16 v[252:255], a[204:207], v[172:175], v[252:255]
    s_waitcnt vmcnt(9)
    v_mfma_f32_16x16x32_bf16 v[192:195], a[208:211], v[176:179], v[192:195]
    buffer_load_dwordx4 v[80:83], v41, s[24:27], s88 offen
    v_mfma_f32_16x16x32_bf16 v[196:199], a[212:215], v[176:179], v[196:199]
    v_mfma_f32_16x16x32_bf16 v[200:203], a[216:219], v[176:179], v[200:203]
    v_mfma_f32_16x16x32_bf16 v[204:207], a[220:223], v[176:179], v[204:207]
    v_mfma_f32_16x16x32_bf16 v[208:211], a[208:211], v[180:183], v[208:211]
    buffer_load_dwordx4 v[84:87], v41, s[24:27], s89 offen
    v_mfma_f32_16x16x32_bf16 v[212:215], a[212:215], v[180:183], v[212:215]
    v_mfma_f32_16x16x32_bf16 v[216:219], a[216:219], v[180:183], v[216:219]
    v_mfma_f32_16x16x32_bf16 v[220:223], a[220:223], v[180:183], v[220:223]
    s_waitcnt vmcnt(9)
    v_mfma_f32_16x16x32_bf16 v[224:227], a[208:211], v[184:187], v[224:227]
    buffer_load_dwordx4 a[28:31], v1, s[36:39], s65 offen offset:3072 sc1
    v_mfma_f32_16x16x32_bf16 v[228:231], a[212:215], v[184:187], v[228:231]
    s_add_u32 s65, s15, s65
    buffer_load_dword v40, off, s[36:39], s79 offset:256 sc1
    v_mfma_f32_16x16x32_bf16 v[232:235], a[216:219], v[184:187], v[232:235]
    v_mfma_f32_16x16x32_bf16 v[236:239], a[220:223], v[184:187], v[236:239]
    v_mfma_f32_16x16x32_bf16 v[240:243], a[208:211], v[188:191], v[240:243]
    v_mfma_f32_16x16x32_bf16 v[244:247], a[212:215], v[188:191], v[244:247]
    v_mfma_f32_16x16x32_bf16 v[248:251], a[216:219], v[188:191], v[248:251]
    buffer_load_dwordx4 a[32:35], v1, s[36:39], s65 offen offset:0 sc1
    v_mfma_f32_16x16x32_bf16 v[252:255], a[220:223], v[188:191], v[252:255]
    s_waitcnt vmcnt(10)
    v_mfma_f32_16x16x32_bf16 v[192:195], a[224:227], a[0:3], v[192:195]
    v_mfma_f32_16x16x32_bf16 v[196:199], a[228:231], a[0:3], v[196:199]
    v_mfma_f32_16x16x32_bf16 v[200:203], a[232:235], a[0:3], v[200:203]
    buffer_load_dwordx4 a[36:39], v1, s[36:39], s65 offen offset:1024 sc1
    v_mfma_f32_16x16x32_bf16 v[204:207], a[236:239], a[0:3], v[204:207]
    v_mfma_f32_16x16x32_bf16 v[208:211], a[224:227], a[4:7], v[208:211]
    v_mfma_f32_16x16x32_bf16 v[212:215], a[228:231], a[4:7], v[212:215]
    v_mfma_f32_16x16x32_bf16 v[216:219], a[232:235], a[4:7], v[216:219]
    v_mfma_f32_16x16x32_bf16 v[220:223], a[236:239], a[4:7], v[220:223]
    buffer_load_dwordx4 a[40:43], v1, s[36:39], s65 offen offset:2048 sc1
    s_waitcnt vmcnt(10)
    v_mfma_f32_16x16x32_bf16 v[224:227], a[224:227], a[8:11], v[224:227]
    v_mfma_f32_16x16x32_bf16 v[228:231], a[228:231], a[8:11], v[228:231]
    v_mfma_f32_16x16x32_bf16 v[232:235], a[232:235], a[8:11], v[232:235]
    v_mfma_f32_16x16x32_bf16 v[236:239], a[236:239], a[8:11], v[236:239]
    buffer_load_dwordx4 a[44:47], v1, s[36:39], s65 offen offset:3072 sc1
    v_mfma_f32_16x16x32_bf16 v[240:243], a[224:227], a[12:15], v[240:243]
    s_add_u32 s65, s13, s65
    v_mfma_f32_16x16x32_bf16 v[244:247], a[228:231], a[12:15], v[244:247]
    v_mfma_f32_16x16x32_bf16 v[248:251], a[232:235], a[12:15], v[248:251]
    v_mfma_f32_16x16x32_bf16 v[252:255], a[236:239], a[12:15], v[252:255]
    s_waitcnt vmcnt(9)
    v_mfma_f32_16x16x32_bf16 v[192:195], a[240:243], a[16:19], v[192:195]
    buffer_load_dwordx4 a[48:51], v1, s[36:39], s65 offen offset:0 sc1
    v_mfma_f32_16x16x32_bf16 v[196:199], a[244:247], a[16:19], v[196:199]
    v_mfma_f32_16x16x32_bf16 v[200:203], a[248:251], a[16:19], v[200:203]
    v_mfma_f32_16x16x32_bf16 v[204:207], a[252:255], a[16:19], v[204:207]
    v_mfma_f32_16x16x32_bf16 v[208:211], a[240:243], a[20:23], v[208:211]
    buffer_load_dwordx4 a[52:55], v1, s[36:39], s65 offen offset:1024 sc1
    v_mfma_f32_16x16x32_bf16 v[212:215], a[244:247], a[20:23], v[212:215]
    v_mfma_f32_16x16x32_bf16 v[216:219], a[248:251], a[20:23], v[216:219]
    v_mfma_f32_16x16x32_bf16 v[220:223], a[252:255], a[20:23], v[220:223]
    buffer_load_dwordx4 a[56:59], v1, s[36:39], s65 offen offset:2048 sc1
    s_waitcnt vmcnt(9)
    buffer_load_dwordx4 a[60:63], v1, s[36:39], s65 offen offset:3072 sc1
    v_lshlrev_b32 v64, 16, v80
    v_and_b32 v65, 0xffff0000, v80
    v_lshlrev_b32_e64 v66, 16, v81
    v_and_b32 v67, 0xffff0000, v81
    v_lshlrev_b32_e64 v68, 16, v82
    v_and_b32 v69, 0xffff0000, v82
    v_lshlrev_b32_e64 v70, 16, v83
    v_and_b32 v71, 0xffff0000, v83
    v_lshlrev_b32_e64 v72, 16, v84
    v_and_b32 v73, 0xffff0000, v84
    v_lshlrev_b32_e64 v74, 16, v85
    v_and_b32 v75, 0xffff0000, v85
    v_lshlrev_b32_e64 v76, 16, v86
    v_and_b32 v77, 0xffff0000, v86
    v_lshlrev_b32 v78, 16, v87
L_padA6:
    s_cbranch_execz L_padret
    v_and_b32 v79, 0xffff0000, v87
    s_waitcnt vmcnt(9)
    v_mfma_f32_16x16x32_bf16 v[224:227], a[240:243], a[24:27], v[224:227]
    s_waitcnt vmcnt(8)
    v_readfirstlane_b32 s72, v40
    s_nop 0
    s_cmp_ge_u32 s72, 8
    s_cbranch_scc0 L_slow_ZA
L_back_ZA:
    v_mfma_f32_16x16x32_bf16 v[228:231], a[244:247], a[24:27], v[228:231]
    s_add_u32 s65, s10, s86
    v_mfma_f32_16x16x32_bf16 v[232:235], a[248:251], a[24:27], v[232:235]
    buffer_load_dwordx4 v[128:131], v1, s[36:39], s65 offen offset:0 sc1
    v_mfma_f32_16x16x32_bf16 v[236:239], a[252:255], a[24:27], v[236:239]
    buffer_load_dwordx4 v[132:135], v1, s[36:39], s65 offen offset:1024 sc1
    v_mfma_f32_16x16x32_bf16 v[240:243], a[240:243], a[28:31], v[240:243]
    buffer_load_dwordx4 v[136:139], v1, s[36:39], s65 offen offset:2048 sc1
    v_mfma_f32_16x16x32_bf16 v[244:247], a[244:247], a[28:31], v[244:247]
    v_mfma_f32_16x16x32_bf16 v[248:251], a[248:251], a[28:31], v[248:251]
    v_mfma_f32_16x16x32_bf16 v[252:255], a[252:255], a[28:31], v[252:255]
    s_waitcnt vmcnt(9) lgkmcnt(15)
    v_mfma_f32_16x16x32_bf16 v[192:195], a[64:67], a[32:35], v[192:195]
    buffer_load_dwordx4 v[140:143], v1, s[36:39], s65 offen offset:3072 sc1
    v_mfma_f32_16x16x32_bf16 v[196:199], a[68:71], a[32:35], v[196:199]
    s_add_u32 s65, s12, s65
    v_mfma_f32_16x16x32_bf16 v[200:203], a[72:75], a[32:35], v[200:203]
    v_mfma_f32_16x16x32_bf16 v[204:207], a[76:79], a[32:35], v[204:207]
    v_mfma_f32_16x16x32_bf16 v[208:211], a[64:67], a[36:39], v[208:211]
    buffer_load_dwordx4 v[144:147], v1, s[36:39], s65 offen offset:0 sc1
    v_mfma_f32_16x16x32_bf16 v[212:215], a[68:71], a[36:39], v[212:215]
    v_mfma_f32_16x16x32_bf16 v[216:219], a[72:75], a[36:39], v[216:219]
    v_mfma_f32_16x16x32_bf16 v[220:223], a[76:79], a[36:39], v[220:223]
    s_waitcnt vmcnt(9)
    v_mfma_f32_16x16x32_bf16 v[224:227], a[64:67], a[40:43], v[224:227]
    buffer_load_dwordx4 v[148:151], v1, s[36:39], s65 offen offset:1024 sc1
    v_mfma_f32_16x16x32_bf16 v[228:231], a[68:71], a[40:43], v[228:231]
    v_mfma_f32_16x16x32_bf16 v[232:235], a[72:75], a[40:43], v[232:235]
    v_mfma_f32_16x16x32_bf16 v[236:239], a[76:79], a[40:43], v[236:239]
    v_mfma_f32_16x16x32_bf16 v[240:243], a[64:67], a[44:47], v[240:243]
    buffer_load_dwordx4 v[152:155], v1, s[36:39], s65 offen offset:2048 sc1
    v_mfma_f32_16x16x32_bf16 v[244:247], a[68:71], a[44:47], v[244:247]
    v_mfma_f32_16x16x32_bf16 v[248:251], a[72:75], a[44:47], v[248:251]
    v_mfma_f32_16x16x32_bf16 v[252:255], a[76:79], a[44:47], v[252:255]
    s_waitcnt vmcnt(9)
    v_mfma_f32_16x16x32_bf16 v[192:195], a[80:83], a[48:51], v[192:195]
    buffer_load_dwordx4 v[156:159], v1, s[36:39], s65 offen offset:3072 sc1
    v_mfma_f32_16x16x32_bf16 v[196:199], a[84:87], a[48:51], v[196:199]
    s_add_u32 s65, s11, s87
    s_add_u32 s20, s12, s65
    s_add_u32 s21, s14, s20
    v_mfma_f32_16x16x32_bf16 v[200:203], a[88:91], a[48:51], v[200:203]
    s_add_u32 s22, s13, s21
    v_mfma_f32_16x16x32_bf16 v[204:207], a[92:95], a[48:51], v[204:207]
    v_mfma_f32_16x16x32_bf16 v[208:211], a[80:83], a[52:55], v[208:211]
    buffer_load_dwordx4 v[160:163], v1, s[36:39], s65 offen offset:0 sc1
    v_mfma_f32_16x16x32_bf16 v[212:215], a[84:87], a[52:55], v[212:215]
    v_mfma_f32_16x16x32_bf16 v[216:219], a[88:91], a[52:55], v[216:219]
    v_mfma_f32_16x16x32_bf16 v[220:223], a[92:95], a[52:55], v[220:223]
    s_waitcnt vmcnt(9)
    v_mfma_f32_16x16x32_bf16 v[224:227], a[80:83], a[56:59], v[224:227]
    buffer_load_dwordx4 v[176:179], v1, s[36:39], s20 offen offset:0 sc1
    v_mfma_f32_16x16x32_bf16 v[228:231], a[84:87], a[56:59], v[228:231]
    v_mfma_f32_16x16x32_bf16 v[232:235], a[88:91], a[56:59], v[232:235]
    v_mfma_f32_16x16x32_bf16 v[236:239], a[92:95], a[56:59], v[236:239]
    v_mfma_f32_16x16x32_bf16 v[240:243], a[80:83], a[60:63], v[240:243]
    v_mfma_f32_16x16x32_bf16 v[244:247], a[84:87], a[60:63], v[244:247]
    v_mfma_f32_16x16x32_bf16 v[248:251], a[88:91], a[60:63], v[248:251]
    v_mfma_f32_16x16x32_bf16 v[252:255], a[92:95], a[60:63], v[252:255]
    buffer_load_dwordx4 a[0:3], v1, s[36:39], s21 offen offset:0 sc1
    s_waitcnt vmcnt(9)
    v_mfma_f32_16x16x32_bf16 v[192:195], a[96:99], v[128:131], v[192:195]
    buffer_load_dwordx4 a[16:19], v1, s[36:39], s22 offen offset:0 sc1
    v_mfma_f32_16x16x32_bf16 v[196:199], a[100:103], v[128:131], v[196:199]
    v_mfma_f32_16x16x32_bf16 v[200:203], a[104:107], v[128:131], v[200:203]
    v_mfma_f32_16x16x32_bf16 v[204:207], a[108:111], v[128:131], v[204:207]
    v_mfma_f32_16x16x32_bf16 v[208:211], a[96:99], v[132:135], v[208:211]
    buffer_load_dwordx4 v[164:167], v1, s[36:39], s65 offen offset:1024 sc1
    v_mfma_f32_16x16x32_bf16 v[212:215], a[100:103], v[132:135], v[212:215]
    v_mfma_f32_16x16x32_bf16 v[216:219], a[104:107], v[132:135], v[216:219]
    v_mfma_f32_16x16x32_bf16 v[220:223], a[108:111], v[132:135], v[220:223]
    s_waitcnt vmcnt(9)
    v_mfma_f32_16x16x32_bf16 v[224:227], a[96:99], v[136:139], v[224:227]
    buffer_load_dwordx4 v[180:183], v1, s[36:39], s20 offen offset:1024 sc1
    v_mfma_f32_16x16x32_bf16 v[228:231], a[100:103], v[136:139], v[228:231]
    v_mfma_f32_16x16x32_bf16 v[232:235], a[104:107], v[136:139], v[232:235]
    v_mfma_f32_16x16x32_bf16 v[236:239], a[108:111], v[136:139], v[236:239]
    v_mfma_f32_16x16x32_bf16 v[240:243], a[96:99], v[140:143], v[240:243]
    buffer_load_dwordx4 a[4:7], v1, s[36:39], s21 offen offset:1024 sc1
    v_mfma_f32_16x16x32_bf16 v[244:247], a[100:103], v[140:143], v[244:247]
    v_mfma_f32_16x16x32_bf16 v[248:251], a[104:107], v[140:143], v[248:251]
    v_mfma_f32_16x16x32_bf16 v[252:255], a[108:111], v[140:143], v[252:255]
    s_waitcnt vmcnt(9)
    v_mfma_f32_16x16x32_bf16 v[192:195], a[112:115], v[144:147], v[192:195]
    buffer_load_dwordx4 a[20:23], v1, s[36:39], s22 offen offset:1024 sc1
    v_mfma_f32_16x16x32_bf16 v[196:199], a[116:119], v[144:147], v[196:199]
    v_mfma_f32_16x16x32_bf16 v[200:203], a[120:123], v[144:147], v[200:203]
    v_mfma_f32_16x16x32_bf16 v[204:207], a[124:127], v[144:147], v[204:207]
    v_mfma_f32_16x16x32_bf16 v[208:211], a[112:115], v[148:151], v[208:211]
    buffer_load_dwordx4 v[168:171], v1, s[36:39], s65 offen offset:2048 sc1
    v_mfma_f32_16x16x32_bf16 v[212:215], a[116:119], v[148:151], v[212:215]
    v_mfma_f32_16x16x32_bf16 v[216:219], a[120:123], v[148:151], v[216:219]
    v_mfma_f32_16x16x32_bf16 v[220:223], a[124:127], v[148:151], v[220:223]
    s_waitcnt vmcnt(9)
    v_mfma_f32_16x16x32_bf16 v[224:227], a[112:115], v[152:155], v[224:227]
    buffer_load_dwordx4 v[184:187], v1, s[36:39], s20 offen offset:2048 sc1
    v_mfma_f32_16x16x32_bf16 v[228:231], a[116:119], v[152:155], v[228:231]
    v_mfma_f32_16x16x32_bf16 v[232:235], a[120:123], v[152:155], v[232:235]
    v_mfma_f32_16x16x32_bf16 v[236:239], a[124:127], v[152:155], v[236:239]
    v_mfma_f32_16x16x32_bf16 v[240:243], a[112:115], v[156:159], v[240:243]
    buffer_load_dwordx4 a[8:11], v1, s[36:39], s21 offen offset:2048 sc1
    v_mfma_f32_16x16x32_bf16 v[244:247], a[116:119], v[156:159], v[244:247]
    v_mfma_f32_16x16x32_bf16 v[248:251], a[120:123], v[156:159], v[248:251]
    v_mfma_f32_16x16x32_bf16 v[252:255], a[124:127], v[156:159], v[252:255]
    s_waitcnt vmcnt(10)
    v_mfma_f32_16x16x32_bf16 v[192:195], a[128:131], v[160:163], v[192:195]
    buffer_load_dwordx4 a[24:27], v1, s[36:39], s22 offen offset:2048 sc1
    v_mfma_f32_16x16x32_bf16 v[196:199], a[132:135], v[160:163], v[196:199]
    v_mfma_f32_16x16x32_bf16 v[200:203], a[136:139], v[160:163], v[200:203]
    v_mfma_f32_16x16x32_bf16 v[204:207], a[140:143], v[160:163], v[204:207]
    s_waitcnt vmcnt(10)
    v_mfma_f32_16x16x32_bf16 v[192:195], a[144:147], v[176:179], v[192:195]
    v_mfma_f32_16x16x32_bf16 v[196:199], a[148:151], v[176:179], v[196:199]
    buffer_load_dwordx4 v[172:175], v1, s[36:39], s65 offen offset:3072 sc1
    v_mfma_f32_16x16x32_bf16 v[200:203], a[152:155], v[176:179], v[200:203]
    v_mfma_f32_16x16x32_bf16 v[204:207], a[156:159], v[176:179], v[204:207]
    s_waitcnt vmcnt(10) lgkmcnt(8)
    v_mfma_f32_16x16x32_bf16 v[192:195], a[160:163], a[0:3], v[192:195]
    v_mfma_f32_16x16x32_bf16 v[196:199], a[164:167], a[0:3], v[196:199]
    buffer_load_dwordx4 v[188:191], v1, s[36:39], s20 offen offset:3072 sc1
    v_mfma_f32_16x16x32_bf16 v[200:203], a[168:171], a[0:3], v[200:203]
    v_mfma_f32_16x16x32_bf16 v[204:207], a[172:175], a[0:3], v[204:207]
    s_waitcnt vmcnt(10) lgkmcnt(0)
    v_mfma_f32_16x16x32_bf16 v[192:195], a[176:179], a[16:19], v[192:195]
    v_mfma_f32_16x16x32_bf16 v[196:199], a[180:183], a[16:19], v[196:199]
    v_mfma_f32_16x16x32_bf16 v[200:203], a[184:187], a[16:19], v[200:203]
    buffer_load_dwordx4 a[12:15], v1, s[36:39], s21 offen offset:3072 sc1
    v_mfma_f32_16x16x32_bf16 v[204:207], a[188:191], a[16:19], v[204:207]
    s_nop 3
    ds_write_b128 v2, v[192:195] offset:16384
    s_waitcnt vmcnt(10)
    v_mfma_f32_16x16x32_bf16 v[208:211], a[128:131], v[164:167], v[208:211]
    ds_write_b128 v3, v[196:199] offset:16384
    v_mfma_f32_16x16x32_bf16 v[212:215], a[132:135], v[164:167], v[212:215]
    ds_write_b128 v4, v[200:203] offset:16384
    v_mfma_f32_16x16x32_bf16 v[216:219], a[136:139], v[164:167], v[216:219]
    ds_write_b128 v5, v[204:207] offset:16384
    v_mfma_f32_16x16x32_bf16 v[220:223], a[140:143], v[164:167], v[220:223]
    buffer_load_dwordx4 a[28:31], v1, s[36:39], s22 offen offset:3072 sc1
    s_waitcnt vmcnt(10)
    v_mfma_f32_16x16x32_bf16 v[208:211], a[144:147], v[180:183], v[208:211]
    v_mfma_f32_16x16x32_bf16 v[212:215], a[148:151], v[180:183], v[212:215]
    v_mfma_f32_16x16x32_bf16 v[216:219], a[152:155], v[180:183], v[216:219]
    v_mfma_f32_16x16x32_bf16 v[220:223], a[156:159], v[180:183], v[220:223]
    s_waitcnt vmcnt(9)
    v_mfma_f32_16x16x32_bf16 v[208:211], a[160:163], a[4:7], v[208:211]
    v_mfma_f32_16x16x32_bf16 v[212:215], a[164:167], a[4:7], v[212:215]
    v_mfma_f32_16x16x32_bf16 v[216:219], a[168:171], a[4:7], v[216:219]
    v_mfma_f32_16x16x32_bf16 v[220:223], a[172:175], a[4:7], v[220:223]
    s_waitcnt vmcnt(8)
    v_mfma_f32_16x16x32_bf16 v[208:211], a[176:179], a[20:23], v[208:211]
    v_mfma_f32_16x16x32_bf16 v[212:215], a[180:183], a[20:23], v[212:215]
    v_mfma_f32_16x16x32_bf16 v[216:219], a[184:187], a[20:23], v[216:219]
    v_mfma_f32_16x16x32_bf16 v[220:223], a[188:191], a[20:23], v[220:223]
    s_nop 4
    ds_write_b128 v2, v[208:211] offset:24576
    s_waitcnt vmcnt(7)
    v_mfma_f32_16x16x32_bf16 v[224:227], a[128:131], v[168:171], v[224:227]
    s_nop 0
    ds_write_b128 v3, v[212:215] offset:24576
    v_mfma_f32_16x16x32_bf16 v[228:231], a[132:135], v[168:171], v[228:231]
    ds_write_b128 v4, v[216:219] offset:24576
    v_mfma_f32_16x16x32_bf16 v[232:235], a[136:139], v[168:171], v[232:235]
    ds_write_b128 v5, v[220:223] offset:24576
    v_mfma_f32_16x16x32_bf16 v[236:239], a[140:143], v[168:171], v[236:239]
    s_waitcnt vmcnt(6)
    v_mfma_f32_16x16x32_bf16 v[224:227], a[144:147], v[184:187], v[224:227]
    v_mfma_f32_16x16x32_bf16 v[228:231], a[148:151], v[184:187], v[228:231]
    v_mfma_f32_16x16x32_bf16 v[232:235], a[152:155], v[184:187], v[232:235]
    v_mfma_f32_16x16x32_bf16 v[236:239], a[156:159], v[184:187], v[236:239]
    s_waitcnt vmcnt(5)
    v_mfma_f32_16x16x32_bf16 v[224:227], a[160:163], a[8:11], v[224:227]
    s_waitcnt lgkmcnt(0)
    s_barrier
    v_mfma_f32_16x16x32_bf16 v[228:231], a[164:167], a[8:11], v[228:231]
    ds_read_b128 v[96:99], v6 offset:16384
    ds_read_b128 v[100:103], v7 offset:16384
    v_mfma_f32_16x16x32_bf16 v[232:235], a[168:171], a[8:11], v[232:235]
    ds_read_b128 v[104:107], v6 offset:20480
    ds_read_b128 v[108:111], v7 offset:20480
    v_mfma_f32_16x16x32_bf16 v[236:239], a[172:175], a[8:11], v[236:239]
    ds_read_b128 v[112:115], v8 offset:16384
    ds_read_b128 v[116:119], v9 offset:16384
    s_waitcnt vmcnt(4)
    v_mfma_f32_16x16x32_bf16 v[224:227], a[176:179], a[24:27], v[224:227]
    s_nop 0
    ds_read_b128 v[120:123], v8 offset:20480
    ds_read_b128 v[124:127], v9 offset:20480
    v_mfma_f32_16x16x32_bf16 v[228:231], a[180:183], a[24:27], v[228:231]
    v_mfma_f32_16x16x32_bf16 v[232:235], a[184:187], a[24:27], v[232:235]
    v_mfma_f32_16x16x32_bf16 v[236:239], a[188:191], a[24:27], v[236:239]
    s_nop 2
    ds_write_b128 v2, v[224:227] offset:32768
    s_waitcnt vmcnt(3)
    v_mfma_f32_16x16x32_bf16 v[240:243], a[128:131], v[172:175], v[240:243]
    s_waitcnt lgkmcnt(7)
    ds_write_b128 v3, v[228:231] offset:32768
    v_add_f32_e64 v64, v64, v96
    s_waitcnt vmcnt(2)
    v_mfma_f32_16x16x32_bf16 v[240:243], a[144:147], v[188:191], v[240:243]
    ds_write_b128 v4, v[232:235] offset:32768
    v_add_f32 v65, v65, v97
    s_waitcnt vmcnt(1)
    v_mfma_f32_16x16x32_bf16 v[240:243], a[160:163], a[12:15], v[240:243]
    ds_write_b128 v5, v[236:239] offset:32768
    v_add_f32 v66, v66, v98
    s_waitcnt vmcnt(0)
    v_mfma_f32_16x16x32_bf16 v[240:243], a[176:179], a[28:31], v[240:243]
    v_add_f32 v67, v67, v99
    v_add_f32 v68, v68, v100
    v_add_f32_e64 v69, v69, v101
    v_mfma_f32_16x16x32_bf16 v[244:247], a[132:135], v[172:175], v[244:247]
    v_add_f32 v70, v70, v102
    v_add_f32 v71, v71, v103
    v_mfma_f32_16x16x32_bf16 v[244:247], a[148:151], v[188:191], v[244:247]
    s_waitcnt lgkmcnt(8)
    v_add_f32 v64, v64, v104
    v_add_f32 v65, v65, v105
    v_add_f32 v66, v66, v106
    v_mfma_f32_16x16x32_bf16 v[244:247], a[164:167], a[12:15], v[244:247]
    ds_write_b128 v2, v[240:243] offset:40960
    v_add_f32_e64 v67, v67, v107
    v_mfma_f32_16x16x32_bf16 v[244:247], a[180:183], a[28:31], v[244:247]
    v_add_f32 v68, v68, v108
    v_add_f32 v69, v69, v109
    v_add_f32_e64 v70, v70, v110
    v_mfma_f32_16x16x32_bf16 v[248:251], a[136:139], v[172:175], v[248:251]
    v_add_f32_e64 v71, v71, v111
    v_mfma_f32_16x16x32_bf16 v[248:251], a[152:155], v[188:191], v[248:251]
    s_waitcnt lgkmcnt(7)
    v_add_f32 v64, v64, v112
    v_add_f32 v65, v65, v113
    v_add_f32 v66, v66, v114
    v_mfma_f32_16x16x32_bf16 v[248:251], a[168:171], a[12:15], v[248:251]
    ds_write_b128 v3, v[244:247] offset:40960
    v_add_f32_e64 v67, v67, v115
    v_mfma_f32_16x16x32_bf16 v[248:251], a[184:187], a[28:31], v[248:251]
    v_add_f32 v68, v68, v116
    v_add_f32 v69, v69, v117
    v_add_f32_e64 v70, v70, v118
    v_mfma_f32_16x16x32_bf16 v[252:255], a[140:143], v[172:175], v[252:255]
    v_add_f32_e64 v71, v71, v119
    v_mfma_f32_16x16x32_bf16 v[252:255], a[156:159], v[188:191], v[252:255]
    s_waitcnt lgkmcnt(6)
    v_add_f32 v64, v64, v120
    v_add_f32 v65, v65, v121
    v_add_f32 v66, v66, v122
    v_mfma_f32_16x16x32_bf16 v[252:255], a[172:175], a[12:15], v[252:255]
    ds_write_b128 v4, v[248:251] offset:40960
    v_add_f32_e64 v67, v67, v123
    v_mfma_f32_16x16x32_bf16 v[252:255], a[188:191], a[28:31], v[252:255]
    v_add_f32 v68, v68, v124
    v_add_f32 v69, v69, v125
    v_add_f32 v70, v70, v126
    s_nop 4
    ds_write_b128 v5, v[252:255] offset:40960
    v_add_f32_e64 v71, v71, v127
    v_cvt_pk_bf16_f32 v80, v64, v65
    v_cvt_pk_bf16_f32 v81, v66, v67
    v_cvt_pk_bf16_f32 v82, v68, v69
    v_cvt_pk_bf16_f32 v83, v70, v71
    buffer_store_dwordx4 v[80:83], v41, s[52:55], s88 offen sc1
    s_waitcnt lgkmcnt(0)
    s_barrier
    ds_read_b128 v[96:99], v6 offset:32768
    ds_read_b128 v[100:103], v7 offset:32768
    ds_read_b128 v[104:107], v6 offset:36864
    ds_read_b128 v[108:111], v7 offset:36864
    ds_read_b128 v[112:115], v8 offset:32768
    ds_read_b128 v[116:119], v9 offset:32768
    ds_read_b128 v[120:123], v8 offset:36864
    ds_read_b128 v[124:127], v9 offset:36864
    s_waitcnt lgkmcnt(6)
    v_pk_add_f32 v[72:73], v[72:73], v[96:97]
    v_pk_add_f32 v[74:75], v[74:75], v[98:99]
    v_pk_add_f32 v[76:77], v[76:77], v[100:101]
    v_pk_add_f32 v[78:79], v[78:79], v[102:103]
    s_waitcnt lgkmcnt(4)
    v_pk_add_f32 v[72:73], v[72:73], v[104:105]
    v_pk_add_f32 v[74:75], v[74:75], v[106:107]
    v_pk_add_f32 v[76:77], v[76:77], v[108:109]
    v_pk_add_f32 v[78:79], v[78:79], v[110:111]
    s_waitcnt lgkmcnt(2)
    v_pk_add_f32 v[72:73], v[72:73], v[112:113]
    v_pk_add_f32 v[74:75], v[74:75], v[114:115]
    v_pk_add_f32 v[76:77], v[76:77], v[116:117]
    v_pk_add_f32 v[78:79], v[78:79], v[118:119]
    s_waitcnt lgkmcnt(0)
    v_pk_add_f32 v[72:73], v[72:73], v[120:121]
    v_pk_add_f32 v[74:75], v[74:75], v[122:123]
    v_pk_add_f32 v[76:77], v[76:77], v[124:125]
    v_pk_add_f32 v[78:79], v[78:79], v[126:127]
    v_cvt_pk_bf16_f32 v84, v72, v73
    v_cvt_pk_bf16_f32 v85, v74, v75
    v_cvt_pk_bf16_f32 v86, v76, v77
    v_cvt_pk_bf16_f32 v87, v78, v79
    buffer_store_dwordx4 v[84:87], v41, s[52:55], s89 offen sc1
    s_endpgm
    .p2align 12
L_typeB:
L_padB0:
    s_cbranch_execz L_padB4
    s_lshl_b32 s72, s61, 10
    s_lshl_b32 s73, s58, 7
    s_add_u32 s72, s72, s73
    s_add_u32 s72, s72, 1024
    v_add_u32 v6, s72, v6
    v_xor_b32 v7, 64, v6
    buffer_load_dwordx4 v64, s[24:27], s62 offen offset:0 lds
    v_add_u32 v7, 23552, v7
    v_add_u32 v8, 47104, v6
    v_add_u32 v9, 47104, v7
    s_mul_i32 s72, s58, 7
    s_bitcmp0_b32 s58, 0
    s_cselect_b32 s73, 6, 0
    s_cselect_b32 s74, 4, 1
    s_add_u32 s67, s72, s73
    s_add_u32 s68, s72, s74
    s_lshl_b32 s72, s68, 6
    v_add_u32 v2, s72, v2
    v_xor_b32_e64 v3, 64, v2
    v_add_u32 v3, 27648, v3
    v_add_u32 v4, 55296, v2
    v_add_u32 v5, 55296, v3
    s_lshl_b32 s73, s67, 6
    s_lshl_b32 s72, s75, 6
    v_lshrrev_b32 v94, 2, v81
    s_waitcnt vmcnt(9)
    buffer_load_dwordx4 v65, s[24:27], s62 offen offset:1024 lds
    ds_read_b128 v[160:163], v68 offset:16384
    ds_read_b128 v[164:167], v68 offset:18432
    ds_read_b128 v[168:171], v69 offset:16384
    ds_read_b128 v[172:175], v69 offset:18432
    v_add_u32_e64 v94, s72, v94
    v_mul_u32_u24 v10, 3584, v94
    v_and_b32 v94, 0x30, v1
    v_and_b32 v89, 32, v81
    v_xor_b32_e64 v94, v89, v94
    v_add3_u32 v10, v94, s73, v10
    v_add_u32 v11, 56320, v10
    v_add_u32 v12, 112640, v10
    v_add_u32 v13, 168960, v10
    v_lshl_add_u32 v89, v85, 5, v92
    v_lshl_add_u32 v26, v88, 6, v89
    v_xor_b32_e64 v27, 32, v26
    buffer_load_dwordx4 v66, s[24:27], s62 offen offset:2048 lds
    v_add_u32 v28, 65536, v26
    v_add_u32 v29, 65536, v27
    v_add_u32_e64 v52, s99, v1
    v_lshl_add_u32 v54, v84, 4, s99
    v_and_b32_e64 v95, 15, v81
    v_lshl_add_u32 v38, v95, 2, s99
    s_lshl_b32 s72, s56, 11
    s_add_u32 s72, s72, 131072
    v_add_u32 v53, s72, v1
    v_lshlrev_b32 v39, 3, v81
    v_cmp_gt_u32 vcc, 4, v95
    v_lshlrev_b32_e64 v94, 3, v84
    v_lshl_add_u32 v94, v95, 5, v94
    v_mov_b32 v95, 1073741824
    v_cndmask_b32 v40, v95, v94, vcc
    v_add_u32 v89, 20971648, v1
    buffer_load_dwordx4 v67, s[24:27], s62 offen offset:3072 lds
    s_add_u32 s62, s62, 128
    s_bitset0_b32 s62, 10
    s_add_u32 m0, s60, 49152
    v_cmp_eq_u32 vcc, 3, v83
    s_nop 1
    v_cndmask_b32 v1, v1, v89, vcc
    v_dot2c_f32_bf16 v72, v155, v155
    v_dot2c_f32_bf16 v71, v156, v76
    v_dot2c_f32_bf16 v73, v156, v156
    v_dot2c_f32_bf16 v71, v157, v76
    v_dot2c_f32_bf16 v73, v157, v157
    v_dot2c_f32_bf16 v71, v158, v76
    v_dot2c_f32_bf16 v73, v158, v158
    v_dot2c_f32_bf16 v71, v159, v76
    v_dot2c_f32_bf16 v73, v159, v159
    s_waitcnt lgkmcnt(2)
    buffer_load_dwordx4 v64, s[24:27], s62 offen offset:0 lds
    v_dot2c_f32_bf16 v70, v160, v76
    v_dot2c_f32_bf16 v72, v160, v160
    v_dot2c_f32_bf16 v70, v161, v76
    v_dot2c_f32_bf16 v72, v161, v161
    v_dot2c_f32_bf16 v70, v162, v76
    v_dot2c_f32_bf16 v72, v162, v162
    v_dot2c_f32_bf16 v70, v163, v76
    v_dot2c_f32_bf16 v72, v163, v163
    v_dot2c_f32_bf16 v71, v164, v76
    v_dot2c_f32_bf16 v73, v164, v164
    v_dot2c_f32_bf16 v71, v165, v76
    v_dot2c_f32_bf16 v73, v165, v165
    v_dot2c_f32_bf16 v71, v166, v76
    v_dot2c_f32_bf16 v73, v166, v166
    v_dot2c_f32_bf16 v71, v167, v76
    v_dot2c_f32_bf16 v73, v167, v167
    s_waitcnt vmcnt(9) lgkmcnt(0)
    buffer_load_dwordx4 v65, s[24:27], s62 offen offset:1024 lds
    ds_read_b128 v[176:179], v68 offset:24576
    ds_read_b128 v[180:183], v68 offset:26624
    ds_read_b128 v[184:187], v69 offset:24576
    ds_read_b128 v[188:191], v69 offset:26624
    v_dot2c_f32_bf16 v70, v168, v76
    v_dot2c_f32_bf16 v72, v168, v168
    v_dot2c_f32_bf16 v70, v169, v76
    v_dot2c_f32_bf16 v72, v169, v169
    v_dot2c_f32_bf16 v70, v170, v76
    v_dot2c_f32_bf16 v72, v170, v170
    buffer_load_dwordx4 v66, s[24:27], s62 offen offset:2048 lds
    v_dot2c_f32_bf16 v70, v171, v76
    v_dot2c_f32_bf16 v72, v171, v171
    v_dot2c_f32_bf16 v71, v172, v76
    v_dot2c_f32_bf16 v73, v172, v172
    v_dot2c_f32_bf16 v71, v173, v76
    v_dot2c_f32_bf16 v73, v173, v173
    v_dot2c_f32_bf16 v71, v174, v76
    v_dot2c_f32_bf16 v73, v174, v174
    v_dot2c_f32_bf16 v71, v175, v76
    v_dot2c_f32_bf16 v73, v175, v175
    s_waitcnt lgkmcnt(2)
    v_dot2c_f32_bf16 v70, v176, v76
    v_dot2c_f32_bf16 v72, v176, v176
    v_dot2c_f32_bf16 v70, v177, v76
    v_dot2c_f32_bf16 v72, v177, v177
    v_dot2c_f32_bf16 v70, v178, v76
    v_dot2c_f32_bf16 v72, v178, v178
    buffer_load_dwordx4 v67, s[24:27], s62 offen offset:3072 lds
    s_add_u32 s62, s62, 128
    s_bitset0_b32 s62, 10
    s_add_u32 m0, s60, 57344
    v_dot2c_f32_bf16 v70, v179, v76
    v_dot2c_f32_bf16 v72, v179, v179
    v_dot2c_f32_bf16 v71, v180, v76
    v_dot2c_f32_bf16 v73, v180, v180
    v_dot2c_f32_bf16 v71, v181, v76
    v_dot2c_f32_bf16 v73, v181, v181
    v_dot2c_f32_bf16 v71, v182, v76
    v_dot2c_f32_bf16 v73, v182, v182
    v_dot2c_f32_bf16 v71, v183, v76
    v_dot2c_f32_bf16 v73, v183, v183
    s_waitcnt lgkmcnt(0)
    buffer_load_dwordx4 v64, s[24:27], s62 offen offset:0 lds
    v_dot2c_f32_bf16 v70, v184, v76
    v_dot2c_f32_bf16 v72, v184, v184
    v_dot2c_f32_bf16 v70, v185, v76
    v_dot2c_f32_bf16 v72, v185, v185
    v_dot2c_f32_bf16 v70, v186, v76
    v_dot2c_f32_bf16 v72, v186, v186
    v_dot2c_f32_bf16 v70, v187, v76
    v_dot2c_f32_bf16 v72, v187, v187
    v_dot2c_f32_bf16 v71, v188, v76
    v_dot2c_f32_bf16 v73, v188, v188
    v_dot2c_f32_bf16 v71, v189, v76
    v_dot2c_f32_bf16 v73, v189, v189
    v_dot2c_f32_bf16 v71, v190, v76
    v_dot2c_f32_bf16 v73, v190, v190
    v_dot2c_f32_bf16 v71, v191, v76
    v_dot2c_f32_bf16 v73, v191, v191
    s_waitcnt vmcnt(9)
    buffer_load_dwordx4 v65, s[24:27], s62 offen offset:1024 lds
    ds_read_b128 v[192:195], v68 offset:32768
    ds_read_b128 v[196:199], v68 offset:34816
    ds_read_b128 v[200:203], v69 offset:32768
    ds_read_b128 v[204:207], v69 offset:34816
    buffer_load_dwordx4 v66, s[24:27], s62 offen offset:2048 lds
    s_waitcnt lgkmcnt(2)
    v_dot2c_f32_bf16 v70, v192, v76
    v_dot2c_f32_bf16 v72, v192, v192
    v_dot2c_f32_bf16 v70, v193, v76
    v_dot2c_f32_bf16 v72, v193, v193
    v_dot2c_f32_bf16 v70, v194, v76
    v_dot2c_f32_bf16 v72, v194, v194
    buffer_load_dwordx4 v67, s[24:27], s62 offen offset:3072 lds
    s_mul_i32 s5, s4, 196608
    v_dot2c_f32_bf16 v70, v195, v76
    v_dot2c_f32_bf16 v72, v195, v195
    v_dot2c_f32_bf16 v71, v196, v76
    s_mov_b32 m0, s60
    v_dot2c_f32_bf16 v73, v196, v196
    v_dot2c_f32_bf16 v71, v197, v76
    v_dot2c_f32_bf16 v73, v197, v197
    v_dot2c_f32_bf16 v71, v198, v76
    v_dot2c_f32_bf16 v73, v198, v198
    v_dot2c_f32_bf16 v71, v199, v76
    v_dot2c_f32_bf16 v73, v199, v199
    s_waitcnt lgkmcnt(0)
    buffer_load_dwordx4 v6, s[32:35], s5 offen offset:0 lds
    v_dot2c_f32_bf16 v70, v200, v76
    v_dot2c_f32_bf16 v72, v200, v200
    v_dot2c_f32_bf16 v70, v201, v76
    v_dot2c_f32_bf16 v72, v201, v201
    v_dot2c_f32_bf16 v70, v202, v76
    v_dot2c_f32_bf16 v72, v202, v202
    v_dot2c_f32_bf16 v70, v203, v76
    v_dot2c_f32_bf16 v72, v203, v203
    v_dot2c_f32_bf16 v71, v204, v76
    v_dot2c_f32_bf16 v73, v204, v204
    v_dot2c_f32_bf16 v71, v205, v76
    v_dot2c_f32_bf16 v73, v205, v205
    v_dot2c_f32_bf16 v71, v206, v76
    v_dot2c_f32_bf16 v73, v206, v206
    v_dot2c_f32_bf16 v71, v207, v76
    v_dot2c_f32_bf16 v73, v207, v207
    s_waitcnt vmcnt(9)
    buffer_load_dwordx4 v7, s[32:35], s5 offen offset:1024 lds
    ds_read_b128 v[208:211], v68 offset:40960
    ds_read_b128 v[212:215], v68 offset:43008
    ds_read_b128 v[216:219], v69 offset:40960
    ds_read_b128 v[220:223], v69 offset:43008
    s_cmp_lt_u32 s98, 9
    s_cbranch_scc0 L_noinitB
    s_atomic_add s3, s[40:41], 0
L_noinitB:
    buffer_load_dwordx4 v8, s[32:35], s5 offen offset:2048 lds
    s_waitcnt lgkmcnt(2)
    v_dot2c_f32_bf16 v70, v208, v76
    v_dot2c_f32_bf16 v72, v208, v208
    v_dot2c_f32_bf16 v70, v209, v76
    v_dot2c_f32_bf16 v72, v209, v209
    v_dot2c_f32_bf16 v70, v210, v76
    v_dot2c_f32_bf16 v72, v210, v210
    buffer_load_dwordx4 v9, s[32:35], s5 offen offset:3072 lds
    s_add_u32 s4, s4, 1
    s_and_b32 s4, s4, 7
    s_mul_i32 s5, s4, 196608
    v_dot2c_f32_bf16 v70, v211, v76
    s_add_u32 m0, s60, 8192
    v_dot2c_f32_bf16 v72, v211, v211
    v_dot2c_f32_bf16 v71, v212, v76
    v_dot2c_f32_bf16 v73, v212, v212
    v_dot2c_f32_bf16 v71, v213, v76
    v_dot2c_f32_bf16 v73, v213, v213
    v_dot2c_f32_bf16 v71, v214, v76
    v_dot2c_f32_bf16 v73, v214, v214
    v_dot2c_f32_bf16 v71, v215, v76
    v_dot2c_f32_bf16 v73, v215, v215
    ds_read_b32 v55, v30
    s_waitcnt lgkmcnt(1)
    buffer_load_dwordx4 v6, s[32:35], s5 offen offset:0 lds
    v_dot2c_f32_bf16 v70, v216, v76
    v_dot2c_f32_bf16 v72, v216, v216
    v_dot2c_f32_bf16 v70, v217, v76
    v_dot2c_f32_bf16 v72, v217, v217
    v_dot2c_f32_bf16 v70, v218, v76
    v_dot2c_f32_bf16 v72, v218, v218
    v_dot2c_f32_bf16 v70, v219, v76
    v_dot2c_f32_bf16 v72, v219, v219
    v_dot2c_f32_bf16 v71, v220, v76
    v_dot2c_f32_bf16 v73, v220, v220
    v_dot2c_f32_bf16 v71, v221, v76
    v_dot2c_f32_bf16 v73, v221, v221
    v_dot2c_f32_bf16 v71, v222, v76
    v_dot2c_f32_bf16 v73, v222, v222
    v_dot2c_f32_bf16 v71, v223, v76
    v_dot2c_f32_bf16 v73, v223, v223
    s_waitcnt vmcnt(9)
    buffer_load_dwordx4 v7, s[32:35], s5 offen offset:1024 lds
    ds_read_b128 v[224:227], v68 offset:49152
    ds_read_b128 v[228:231], v68 offset:51200
    ds_read_b128 v[232:235], v69 offset:49152
    ds_read_b128 v[236:239], v69 offset:51200
    buffer_load_dwordx4 v8, s[32:35], s5 offen offset:2048 lds
    s_waitcnt lgkmcnt(2)
    v_dot2c_f32_bf16 v70, v224, v76
    v_dot2c_f32_bf16 v72, v224, v224
    v_dot2c_f32_bf16 v70, v225, v76
    v_dot2c_f32_bf16 v72, v225, v225
    v_dot2c_f32_bf16 v70, v226, v76
    v_dot2c_f32_bf16 v72, v226, v226
    buffer_load_dwordx4 v9, s[32:35], s5 offen offset:3072 lds
    s_add_u32 s4, s4, 1
    s_and_b32 s4, s4, 7
    s_mul_i32 s5, s4, 196608
    v_dot2c_f32_bf16 v70, v227, v76
    s_add_u32 m0, s60, 16384
    v_dot2c_f32_bf16 v72, v227, v227
    v_dot2c_f32_bf16 v71, v228, v76
    v_dot2c_f32_bf16 v73, v228, v228
    v_dot2c_f32_bf16 v71, v229, v76
    v_dot2c_f32_bf16 v73, v229, v229
    v_dot2c_f32_bf16 v71, v230, v76
    v_dot2c_f32_bf16 v73, v230, v230
    v_dot2c_f32_bf16 v71, v231, v76
    v_dot2c_f32_bf16 v73, v231, v231
    ds_read_b32 v55, v30
    s_waitcnt lgkmcnt(1)
    buffer_load_dwordx4 v6, s[32:35], s5 offen offset:0 lds
    v_dot2c_f32_bf16 v70, v232, v76
    v_dot2c_f32_bf16 v72, v232, v232
    v_dot2c_f32_bf16 v70, v233, v76
    v_dot2c_f32_bf16 v72, v233, v233
    v_dot2c_f32_bf16 v70, v234, v76
    v_dot2c_f32_bf16 v72, v234, v234
    v_dot2c_f32_bf16 v70, v235, v76
    v_dot2c_f32_bf16 v72, v235, v235
    v_dot2c_f32_bf16 v71, v236, v76
    v_dot2c_f32_bf16 v73, v236, v236
    v_dot2c_f32_bf16 v71, v237, v76
    v_dot2c_f32_bf16 v73, v237, v237
    v_dot2c_f32_bf16 v71, v238, v76
    v_dot2c_f32_bf16 v73, v238, v238
    v_dot2c_f32_bf16 v71, v239, v76
    v_dot2c_f32_bf16 v73, v239, v239
    s_waitcnt vmcnt(9)
    buffer_load_dwordx4 v7, s[32:35], s5 offen offset:1024 lds
    ds_read_b128 v[240:243], v68 offset:57344
    ds_read_b128 v[244:247], v68 offset:59392
    ds_read_b128 v[248:251], v69 offset:57344
    ds_read_b128 v[252:255], v69 offset:59392
    buffer_load_dwordx4 v8, s[32:35], s5 offen offset:2048 lds
    s_waitcnt lgkmcnt(2)
    v_dot2c_f32_bf16 v70, v240, v76
    v_dot2c_f32_bf16 v72, v240, v240
    v_dot2c_f32_bf16 v70, v241, v76
    v_dot2c_f32_bf16 v72, v241, v241
    v_dot2c_f32_bf16 v70, v242, v76
    v_dot2c_f32_bf16 v72, v242, v242
    buffer_load_dwordx4 v9, s[32:35], s5 offen offset:3072 lds
    s_add_u32 s4, s4, 1
    s_and_b32 s4, s4, 7
    s_mul_i32 s5, s4, 196608
    v_dot2c_f32_bf16 v70, v243, v76
    s_add_u32 m0, s60, 24576
    v_dot2c_f32_bf16 v72, v243, v243
    v_dot2c_f32_bf16 v71, v244, v76
    v_dot2c_f32_bf16 v73, v244, v244
    v_dot2c_f32_bf16 v71, v245, v76
    v_dot2c_f32_bf16 v73, v245, v245
    v_dot2c_f32_bf16 v71, v246, v76
    v_dot2c_f32_bf16 v73, v246, v246
    v_dot2c_f32_bf16 v71, v247, v76
    v_dot2c_f32_bf16 v73, v247, v247
    ds_read_b32 v55, v30
    s_waitcnt lgkmcnt(1)
    buffer_load_dwordx4 v6, s[32:35], s5 offen offset:0 lds
    v_dot2c_f32_bf16 v70, v248, v76
    v_dot2c_f32_bf16 v72, v248, v248
    v_dot2c_f32_bf16 v70, v249, v76
    v_dot2c_f32_bf16 v72, v249, v249
    v_dot2c_f32_bf16 v70, v250, v76
    v_dot2c_f32_bf16 v72, v250, v250
    v_dot2c_f32_bf16 v70, v251, v76
    v_dot2c_f32_bf16 v72, v251, v251
    v_dot2c_f32_bf16 v71, v252, v76
    v_dot2c_f32_bf16 v73, v252, v252
    v_dot2c_f32_bf16 v71, v253, v76
    v_dot2c_f32_bf16 v73, v253, v253
    v_dot2c_f32_bf16 v71, v254, v76
    v_dot2c_f32_bf16 v73, v254, v254
    v_dot2c_f32_bf16 v71, v255, v76
    v_dot2c_f32_bf16 v73, v255, v255
    v_mov_b32 v80, v70
    s_nop 0
    v_mov_b32 v81, v71
    v_mov_b32 v82, v72
    v_mov_b32 v83, v73
    v_permlane32_swap_b32 v70, v80
    v_permlane32_swap_b32 v71, v81
    v_permlane32_swap_b32 v72, v82
    v_permlane32_swap_b32 v73, v83
    v_add_f32 v70, v70, v80
    v_add_f32 v71, v71, v81
    v_add_f32 v72, v72, v82
    v_add_f32 v73, v73, v83
    v_mov_b32 v80, v70
    v_mov_b32 v81, v71
    v_mov_b32 v82, v72
    v_mov_b32 v83, v73
    v_permlane16_swap_b32 v70, v80
    v_permlane16_swap_b32 v71, v81
    v_permlane16_swap_b32 v72, v82
    v_permlane16_swap_b32 v73, v83
    v_add_f32 v70, v70, v80
    v_add_f32 v71, v71, v81
    v_add_f32 v72, v72, v82
    v_add_f32 v73, v73, v83
    v_mul_f32 v34, 0xbb000000, v70
    v_mul_f32 v35, 0xbb000000, v71
    v_cvt_pk_bf16_f32 v80, v34, v35
    v_lshlrev_b32 v44, 16, v80
    v_lshlrev_b32 v45, 16, v80
    v_lshlrev_b32 v46, 16, v80
    v_lshlrev_b32 v47, 16, v80
    v_and_b32 v48, 0xffff0000, v80
    v_and_b32 v49, 0xffff0000, v80
    v_and_b32 v50, 0xffff0000, v80
    v_and_b32 v51, 0xffff0000, v80
    v_mul_f32 v36, 0x3b000000, v72
    v_mul_f32 v37, 0x3b000000, v73
    v_mfma_f32_4x4x4_16b_bf16 v[112:115], v[42:43], v[128:129], v[44:47]
    v_mfma_f32_4x4x4_16b_bf16 v[116:119], v[42:43], v[130:131], v[44:47]
    v_mfma_f32_4x4x4_16b_bf16 v[120:123], v[42:43], v[132:133], v[48:51]
    v_mfma_f32_4x4x4_16b_bf16 v[124:127], v[42:43], v[134:135], v[48:51]
    v_mfma_f32_4x4x4_16b_bf16 v[56:59], v[42:43], v[136:137], v[44:47]
    v_mfma_f32_4x4x4_16b_bf16 v[60:63], v[42:43], v[138:139], v[44:47]
    s_waitcnt vmcnt(9)
    s_barrier
    ds_read_b64_tr_b16 a[64:65], v18 offset:0
    ds_read_b64_tr_b16 a[66:67], v18 offset:512
    ds_read_b64_tr_b16 a[68:69], v19 offset:0
    ds_read_b64_tr_b16 a[70:71], v19 offset:512
    ds_read_b64_tr_b16 a[72:73], v22 offset:0
    ds_read_b64_tr_b16 a[74:75], v22 offset:512
    ds_read_b64_tr_b16 a[76:77], v23 offset:0
    ds_read_b64_tr_b16 a[78:79], v23 offset:512
    ds_read_b64_tr_b16 a[80:81], v20 offset:0
    ds_read_b64_tr_b16 a[82:83], v20 offset:512
    ds_read_b64_tr_b16 a[84:85], v21 offset:0
    ds_read_b64_tr_b16 a[86:87], v21 offset:512
    v_cvt_pk_bf16_f32 v128, v112, v113
    v_cvt_pk_bf16_f32 v129, v114, v115
    v_cvt_pk_bf16_f32 v130, v116, v117
    v_cvt_pk_bf16_f32 v131, v118, v119
    v_cvt_pk_bf16_f32 v132, v120, v121
    v_cvt_pk_bf16_f32 v133, v122, v123
    v_cvt_pk_bf16_f32 v134, v124, v125
    v_cvt_pk_bf16_f32 v135, v126, v127
    s_waitcnt lgkmcnt(10)
    v_mfma_f32_16x16x32_bf16 v[64:67], v[128:131], a[64:67], 0
    s_lshl_b32 s20, s2, 2
    ds_read_b64_tr_b16 a[88:89], v24 offset:0
    ds_read_b64_tr_b16 a[90:91], v24 offset:512
    v_mfma_f32_16x16x32_bf16 v[68:71], v[132:135], a[64:67], 0
    s_waitcnt lgkmcnt(6)
    buffer_load_dwordx4 v7, s[32:35], s5 offen offset:1024 lds
    v_mfma_f32_16x16x32_bf16 v[72:75], v[128:131], a[68:71], 0
    s_add_u32 s20, s20, s56
    ds_read_b64_tr_b16 a[92:93], v25 offset:0
    ds_read_b64_tr_b16 a[94:95], v25 offset:512
    v_mfma_f32_16x16x32_bf16 v[76:79], v[132:135], a[68:71], 0
    buffer_load_dwordx4 v8, s[32:35], s5 offen offset:2048 lds
    v_mfma_f32_16x16x32_bf16 v[80:83], v[128:131], a[72:75], 0
    s_mul_i32 s81, s20, 1792
    ds_read_b64_tr_b16 a[64:65], v18 offset:4096
    ds_read_b64_tr_b16 a[66:67], v18 offset:4608
    v_mfma_f32_16x16x32_bf16 v[84:87], v[132:135], a[72:75], 0
    buffer_load_dwordx4 v9, s[32:35], s5 offen offset:3072 lds
    v_mfma_f32_16x16x32_bf16 v[88:91], v[128:131], a[76:79], 0
    s_add_u32 s4, s4, 1
    ds_read_b64_tr_b16 a[68:69], v19 offset:4096
    ds_read_b64_tr_b16 a[70:71], v19 offset:4608
    v_mfma_f32_16x16x32_bf16 v[92:95], v[132:135], a[76:79], 0
    s_waitcnt lgkmcnt(6)
    v_cvt_pk_bf16_f32 v136, v56, v57
    v_cvt_pk_bf16_f32 v137, v58, v59
    v_cvt_pk_bf16_f32 v138, v60, v61
    v_cvt_pk_bf16_f32 v139, v62, v63
    v_mfma_f32_4x4x4_16b_bf16 v[56:59], v[42:43], v[140:141], v[48:51]
    v_mfma_f32_4x4x4_16b_bf16 v[60:63], v[42:43], v[142:143], v[48:51]
    v_fma_f32 v36, -v34, v34, v36
    v_fma_f32 v37, -v35, v35, v37
    v_mfma_f32_16x16x32_bf16 v[96:99], v[128:131], a[80:83], 0
    s_and_b32 s4, s4, 7
    ds_read_b64_tr_b16 a[72:73], v22 offset:4096
    ds_read_b64_tr_b16 a[74:75], v22 offset:4608
    v_mfma_f32_16x16x32_bf16 v[100:103], v[132:135], a[80:83], 0
    s_nop 0
    v_cvt_pk_bf16_f32 v140, v56, v57
    v_cvt_pk_bf16_f32 v141, v58, v59
    v_mfma_f32_16x16x32_bf16 v[104:107], v[128:131], a[84:87], 0
    s_mul_i32 s5, s4, 196608
    ds_read_b64_tr_b16 a[76:77], v23 offset:4096
    ds_read_b64_tr_b16 a[78:79], v23 offset:4608
    v_mfma_f32_16x16x32_bf16 v[108:111], v[132:135], a[84:87], 0
    v_cvt_pk_bf16_f32 v142, v60, v61
    v_cvt_pk_bf16_f32 v143, v62, v63
    v_mfma_f32_16x16x32_bf16 v[112:115], v[128:131], a[88:91], 0
    s_add_u32 m0, s60, 32768
    ds_read_b64_tr_b16 a[80:81], v20 offset:4096
    ds_read_b64_tr_b16 a[82:83], v20 offset:4608
    v_mfma_f32_16x16x32_bf16 v[116:119], v[132:135], a[88:91], 0
    s_waitcnt lgkmcnt(6)
    buffer_load_dwordx4 v6, s[32:35], s5 offen offset:0 lds
    v_mfma_f32_16x16x32_bf16 v[120:123], v[128:131], a[92:95], 0
    s_lshl_b32 s96, s20, 9
    ds_read_b64_tr_b16 a[84:85], v21 offset:4096
    ds_read_b64_tr_b16 a[86:87], v21 offset:4608
    v_mfma_f32_16x16x32_bf16 v[124:127], v[132:135], a[92:95], 0
    buffer_load_dwordx4 v7, s[32:35], s5 offen offset:1024 lds
    v_mfma_f32_4x4x4_16b_bf16 v[56:59], v[42:43], v[144:145], v[44:47]
    v_mfma_f32_4x4x4_16b_bf16 v[60:63], v[42:43], v[146:147], v[44:47]
    buffer_load_dwordx4 v8, s[32:35], s5 offen offset:2048 lds
    v_mfma_f32_16x16x32_bf16 v[64:67], v[136:139], a[64:67], v[64:67]
    s_nop 0
    ds_read_b64_tr_b16 a[88:89], v24 offset:4096
    ds_read_b64_tr_b16 a[90:91], v24 offset:4608
    v_mfma_f32_16x16x32_bf16 v[68:71], v[140:143], a[64:67], v[68:71]
    s_nop 0
    v_cvt_pk_bf16_f32 v144, v56, v57
    v_cvt_pk_bf16_f32 v145, v58, v59
    v_mfma_f32_16x16x32_bf16 v[72:75], v[136:139], a[68:71], v[72:75]
    s_mov_b32 s93, 200000
    ds_read_b64_tr_b16 a[92:93], v25 offset:4096
    ds_read_b64_tr_b16 a[94:95], v25 offset:4608
    v_mfma_f32_16x16x32_bf16 v[76:79], v[140:143], a[68:71], v[76:79]
    s_waitcnt lgkmcnt(6) vmcnt(11)
    buffer_load_dwordx4 v9, s[32:35], s5 offen offset:3072 lds
    v_mfma_f32_16x16x32_bf16 v[80:83], v[136:139], a[72:75], v[80:83]
    s_barrier
    ds_read_b64_tr_b16 a[64:65], v18 offset:8192
    ds_read_b64_tr_b16 a[66:67], v18 offset:8704
    v_mfma_f32_16x16x32_bf16 v[84:87], v[140:143], a[72:75], v[84:87]
    v_cvt_pk_bf16_f32 v146, v60, v61
    v_cvt_pk_bf16_f32 v147, v62, v63
    v_mfma_f32_16x16x32_bf16 v[88:91], v[136:139], a[76:79], v[88:91]
    s_add_u32 s4, s4, 1
    ds_read_b64_tr_b16 a[68:69], v19 offset:8192
    ds_read_b64_tr_b16 a[70:71], v19 offset:8704
    v_mfma_f32_16x16x32_bf16 v[92:95], v[140:143], a[76:79], v[92:95]
    s_mov_b64 exec, 0x6cd9b36
    buffer_load_dword v55, v41, s[28:31], s80 offen sc0 sc1
    s_mov_b64 exec, -1
    v_mfma_f32_4x4x4_16b_bf16 v[56:59], v[42:43], v[148:149], v[48:51]
    v_mfma_f32_4x4x4_16b_bf16 v[60:63], v[42:43], v[150:151], v[48:51]
    v_max_f32 v36, 0, v36
    v_max_f32 v37, 0, v37
    v_mfma_f32_16x16x32_bf16 v[96:99], v[136:139], a[80:83], v[96:99]
    s_and_b32 s4, s4, 7
    ds_read_b64_tr_b16 a[72:73], v22 offset:8192
    ds_read_b64_tr_b16 a[74:75], v22 offset:8704
    v_mfma_f32_16x16x32_bf16 v[100:103], v[140:143], a[80:83], v[100:103]
    s_waitcnt lgkmcnt(6)
    v_cvt_pk_bf16_f32 v148, v56, v57
    v_cvt_pk_bf16_f32 v149, v58, v59
    v_mfma_f32_16x16x32_bf16 v[104:107], v[136:139], a[84:87], v[104:107]
    s_mul_i32 s5, s4, 196608
    ds_read_b64_tr_b16 a[76:77], v23 offset:8192
    ds_read_b64_tr_b16 a[78:79], v23 offset:8704
    v_mfma_f32_16x16x32_bf16 v[108:111], v[140:143], a[84:87], v[108:111]
    v_cvt_pk_bf16_f32 v150, v60, v61
    v_cvt_pk_bf16_f32 v151, v62, v63
    v_mfma_f32_16x16x32_bf16 v[112:115], v[136:139], a[88:91], v[112:115]
    s_add_u32 m0, s60, 40960
    ds_read_b64_tr_b16 a[80:81], v20 offset:8192
    ds_read_b64_tr_b16 a[82:83], v20 offset:8704
    v_mfma_f32_16x16x32_bf16 v[116:119], v[140:143], a[88:91], v[116:119]
    buffer_load_dwordx4 v6, s[32:35], s5 offen offset:0 lds
    v_mfma_f32_16x16x32_bf16 v[120:123], v[136:139], a[92:95], v[120:123]
    s_lshr_b32 s83, s2, 5
    ds_read_b64_tr_b16 a[84:85], v21 offset:8192
    ds_read_b64_tr_b16 a[86:87], v21 offset:8704
    v_mfma_f32_16x16x32_bf16 v[124:127], v[140:143], a[92:95], v[124:127]
    s_waitcnt lgkmcnt(6)
    v_cvt_pk_bf16_f32 v37, v36, v37
    v_lshlrev_b32_e64 v36, 16, v37
    v_mfma_f32_4x4x4_16b_bf16 v[56:59], v[42:43], v[152:153], v[44:47]
    v_mfma_f32_4x4x4_16b_bf16 v[60:63], v[42:43], v[154:155], v[44:47]
    buffer_load_dwordx4 v7, s[32:35], s5 offen offset:1024 lds
    v_mfma_f32_16x16x32_bf16 v[64:67], v[144:147], a[64:67], v[64:67]
    s_xor_b32 s83, s83, 2
    ds_read_b64_tr_b16 a[88:89], v24 offset:8192
    ds_read_b64_tr_b16 a[90:91], v24 offset:8704
    v_mfma_f32_16x16x32_bf16 v[68:71], v[148:151], a[64:67], v[68:71]
    s_nop 0
    v_cvt_pk_bf16_f32 v152, v56, v57
    v_cvt_pk_bf16_f32 v153, v58, v59
    v_mfma_f32_16x16x32_bf16 v[72:75], v[144:147], a[68:71], v[72:75]
    s_lshl_b32 s83, s83, 7
    ds_read_b64_tr_b16 a[92:93], v25 offset:8192
    ds_read_b64_tr_b16 a[94:95], v25 offset:8704
    v_mfma_f32_16x16x32_bf16 v[76:79], v[148:151], a[68:71], v[76:79]
    s_nop 0
    v_cvt_pk_bf16_f32 v154, v60, v61
    v_cvt_pk_bf16_f32 v155, v62, v63
    v_mfma_f32_16x16x32_bf16 v[80:83], v[144:147], a[72:75], v[80:83]
    s_mul_i32 s84, s56, 458752
    ds_read_b64_tr_b16 a[64:65], v18 offset:12288
    ds_read_b64_tr_b16 a[66:67], v18 offset:12800
    v_mfma_f32_16x16x32_bf16 v[84:87], v[148:151], a[72:75], v[84:87]
    s_waitcnt lgkmcnt(6)
    buffer_load_dwordx4 v8, s[32:35], s5 offen offset:2048 lds
    v_mfma_f32_16x16x32_bf16 v[88:91], v[144:147], a[76:79], v[88:91]
    s_add_u32 s84, s84, s83
    ds_read_b64_tr_b16 a[68:69], v19 offset:12288
    ds_read_b64_tr_b16 a[70:71], v19 offset:12800
    v_mfma_f32_16x16x32_bf16 v[92:95], v[148:151], a[76:79], v[92:95]
    v_and_b32 v37, 0xffff0000, v37
    v_add_f32 v36, 0x3727c5ac, v36
    v_mfma_f32_4x4x4_16b_bf16 v[56:59], v[42:43], v[156:157], v[48:51]
    v_mfma_f32_4x4x4_16b_bf16 v[60:63], v[42:43], v[158:159], v[48:51]
    v_add_f32 v37, 0x3727c5ac, v37
    v_cvt_pk_bf16_f32 v37, v36, v37
    v_mfma_f32_16x16x32_bf16 v[96:99], v[144:147], a[80:83], v[96:99]
    s_bfe_u32 s6, s2, 0x20003
    ds_read_b64_tr_b16 a[72:73], v22 offset:12288
    ds_read_b64_tr_b16 a[74:75], v22 offset:12800
    v_mfma_f32_16x16x32_bf16 v[100:103], v[148:151], a[80:83], v[100:103]
    buffer_load_dwordx4 v9, s[32:35], s5 offen offset:3072 lds
    v_mfma_f32_16x16x32_bf16 v[104:107], v[144:147], a[84:87], v[104:107]
    s_lshr_b32 s20, s83, 6
    ds_read_b64_tr_b16 a[76:77], v23 offset:12288
    ds_read_b64_tr_b16 a[78:79], v23 offset:12800
    v_mfma_f32_16x16x32_bf16 v[108:111], v[148:151], a[84:87], v[108:111]
    s_waitcnt lgkmcnt(6)
    v_cvt_pk_bf16_f32 v156, v56, v57
    v_cvt_pk_bf16_f32 v157, v58, v59
    v_mfma_f32_16x16x32_bf16 v[112:115], v[144:147], a[88:91], v[112:115]
    s_lshr_b32 s20, 192, s20
    ds_read_b64_tr_b16 a[80:81], v20 offset:12288
    ds_read_b64_tr_b16 a[82:83], v20 offset:12800
    v_mfma_f32_16x16x32_bf16 v[116:119], v[148:151], a[88:91], v[116:119]
    s_and_b32 s6, s6, s20
    v_cvt_pk_bf16_f32 v158, v60, v61
    v_cvt_pk_bf16_f32 v159, v62, v63
    v_mfma_f32_16x16x32_bf16 v[120:123], v[144:147], a[92:95], v[120:123]
    s_xor_b32 s6, s6, s2
    ds_read_b64_tr_b16 a[84:85], v21 offset:12288
    ds_read_b64_tr_b16 a[86:87], v21 offset:12800
    v_mfma_f32_16x16x32_bf16 v[124:127], v[148:151], a[92:95], v[124:127]
    s_and_b32 s20, s6, 1
    s_mov_b64 exec, 0x3fff
    buffer_load_dword v55, v41, s[44:47], s81 offen sc0 sc1
    s_mov_b64 exec, -1
    v_mfma_f32_4x4x4_16b_bf16 v[56:59], v[42:43], v[160:161], v[44:47]
    v_mfma_f32_4x4x4_16b_bf16 v[60:63], v[42:43], v[162:163], v[44:47]
    v_lshlrev_b32_e64 v36, 16, v37
    v_and_b32 v37, 0xffff0000, v37
    v_mfma_f32_16x16x32_bf16 v[64:67], v[152:155], a[64:67], v[64:67]
    s_lshl_b32 s10, s20, 12
    ds_read_b64_tr_b16 a[88:89], v24 offset:12288
    ds_read_b64_tr_b16 a[90:91], v24 offset:12800
    v_mfma_f32_16x16x32_bf16 v[68:71], v[156:159], a[64:67], v[68:71]
    s_waitcnt lgkmcnt(6)
    v_cvt_pk_bf16_f32 v160, v56, v57
    v_cvt_pk_bf16_f32 v161, v58, v59
    v_mfma_f32_16x16x32_bf16 v[72:75], v[152:155], a[68:71], v[72:75]
    s_lshl_b32 s20, s20, 13
    ds_read_b64_tr_b16 a[92:93], v25 offset:12288
    ds_read_b64_tr_b16 a[94:95], v25 offset:12800
    v_mfma_f32_16x16x32_bf16 v[76:79], v[156:159], a[68:71], v[76:79]
    s_waitcnt vmcnt(10)
    v_cvt_pk_bf16_f32 v162, v60, v61
    v_cvt_pk_bf16_f32 v163, v62, v63
    v_mfma_f32_16x16x32_bf16 v[80:83], v[152:155], a[72:75], v[80:83]
    s_barrier
    ds_read_b64_tr_b16 a[64:65], v18 offset:16384
    ds_read_b64_tr_b16 a[66:67], v18 offset:16896
    v_mfma_f32_16x16x32_bf16 v[84:87], v[156:159], a[72:75], v[84:87]
    s_sub_u32 s12, 4096, s20
    v_sqrt_f32 v36, v36
    v_mfma_f32_16x16x32_bf16 v[88:91], v[152:155], a[76:79], v[88:91]
    s_sub_u32 s13, s20, 4096
    ds_read_b64_tr_b16 a[68:69], v19 offset:16384
    ds_read_b64_tr_b16 a[70:71], v19 offset:16896
    v_mfma_f32_16x16x32_bf16 v[92:95], v[156:159], a[76:79], v[92:95]
    s_waitcnt lgkmcnt(6)
    v_sqrt_f32 v37, v37
    v_mfma_f32_4x4x4_16b_bf16 v[56:59], v[42:43], v[164:165], v[48:51]
    v_mfma_f32_4x4x4_16b_bf16 v[60:63], v[42:43], v[166:167], v[48:51]
    v_cvt_pk_bf16_f32 v37, v36, v37
    v_lshlrev_b32_e64 v36, 16, v37
    v_mfma_f32_16x16x32_bf16 v[96:99], v[152:155], a[80:83], v[96:99]
    s_and_b32 s20, s6, 2
    ds_read_b64_tr_b16 a[72:73], v22 offset:16384
    ds_read_b64_tr_b16 a[74:75], v22 offset:16896
    v_mfma_f32_16x16x32_bf16 v[100:103], v[156:159], a[80:83], v[100:103]
    s_mul_i32 s21, s20, 24576
    v_cvt_pk_bf16_f32 v164, v56, v57
    v_cvt_pk_bf16_f32 v165, v58, v59
    v_mfma_f32_16x16x32_bf16 v[104:107], v[152:155], a[84:87], v[104:107]
    s_add_u32 s8, s10, s21
    ds_read_b64_tr_b16 a[76:77], v23 offset:16384
    ds_read_b64_tr_b16 a[78:79], v23 offset:16896
    v_mfma_f32_16x16x32_bf16 v[108:111], v[156:159], a[84:87], v[108:111]
    s_lshl_b32 s21, s21, 1
    v_cvt_pk_bf16_f32 v166, v60, v61
    v_cvt_pk_bf16_f32 v167, v62, v63
    v_mfma_f32_16x16x32_bf16 v[112:115], v[152:155], a[88:91], v[112:115]
    s_sub_u32 s17, 49152, s21
    ds_read_b64_tr_b16 a[80:81], v20 offset:16384
    ds_read_b64_tr_b16 a[82:83], v20 offset:16896
    v_mfma_f32_16x16x32_bf16 v[116:119], v[156:159], a[88:91], v[116:119]
    s_waitcnt lgkmcnt(6)
    v_and_b32 v37, 0xffff0000, v37
    v_accvgpr_write_b32 a0, v128
    v_mfma_f32_16x16x32_bf16 v[120:123], v[152:155], a[92:95], v[120:123]
    s_add_u32 s4, s4, 1
    ds_read_b64_tr_b16 a[84:85], v21 offset:16384
    ds_read_b64_tr_b16 a[86:87], v21 offset:16896
    v_mfma_f32_16x16x32_bf16 v[124:127], v[156:159], a[92:95], v[124:127]
    v_rcp_f32 v34, v36
    v_mfma_f32_4x4x4_16b_bf16 v[56:59], v[42:43], v[168:169], v[44:47]
    v_mfma_f32_4x4x4_16b_bf16 v[60:63], v[42:43], v[170:171], v[44:47]
    v_rcp_f32_e64 v35, v37
    v_mfma_f32_16x16x32_bf16 v[64:67], v[160:163], a[64:67], v[64:67]
    s_and_b32 s4, s4, 7
    ds_read_b64_tr_b16 a[88:89], v24 offset:16384
    ds_read_b64_tr_b16 a[90:91], v24 offset:16896
L_padB1:
    s_cbranch_execz L_padB5
    v_mfma_f32_16x16x32_bf16 v[68:71], v[164:167], a[64:67], v[68:71]
    v_cvt_pk_bf16_f32 v168, v56, v57
    v_cvt_pk_bf16_f32 v169, v58, v59
    v_mfma_f32_16x16x32_bf16 v[72:75], v[160:163], a[68:71], v[72:75]
    s_mul_i32 s5, s4, 196608
    ds_read_b64_tr_b16 a[92:93], v25 offset:16384
    ds_read_b64_tr_b16 a[94:95], v25 offset:16896
    v_mfma_f32_16x16x32_bf16 v[76:79], v[164:167], a[68:71], v[76:79]
    s_waitcnt lgkmcnt(6)
    v_cvt_pk_bf16_f32 v170, v60, v61
    v_cvt_pk_bf16_f32 v171, v62, v63
    v_mfma_f32_16x16x32_bf16 v[80:83], v[160:163], a[72:75], v[80:83]
    s_mov_b32 m0, s60
    ds_read_b64_tr_b16 a[64:65], v18 offset:20480
    ds_read_b64_tr_b16 a[66:67], v18 offset:20992
    v_mfma_f32_16x16x32_bf16 v[84:87], v[164:167], a[72:75], v[84:87]
    buffer_load_dwordx4 v6, s[32:35], s5 offen offset:0 lds
    v_mfma_f32_16x16x32_bf16 v[88:91], v[160:163], a[76:79], v[88:91]
    s_lshl_b32 s21, s20, 12
    ds_read_b64_tr_b16 a[68:69], v19 offset:20480
    ds_read_b64_tr_b16 a[70:71], v19 offset:20992
    v_mfma_f32_16x16x32_bf16 v[92:95], v[164:167], a[76:79], v[92:95]
    buffer_load_dwordx4 v7, s[32:35], s5 offen offset:1024 lds
    v_mfma_f32_4x4x4_16b_bf16 v[56:59], v[42:43], v[172:173], v[48:51]
    v_mfma_f32_4x4x4_16b_bf16 v[60:63], v[42:43], v[174:175], v[48:51]
    buffer_load_dwordx4 v8, s[32:35], s5 offen offset:2048 lds
    v_mfma_f32_16x16x32_bf16 v[96:99], v[160:163], a[80:83], v[96:99]
    s_add_u32 s11, s10, s21
    ds_read_b64_tr_b16 a[72:73], v22 offset:20480
    ds_read_b64_tr_b16 a[74:75], v22 offset:20992
    v_mfma_f32_16x16x32_bf16 v[100:103], v[164:167], a[80:83], v[100:103]
    s_waitcnt lgkmcnt(6)
    v_cvt_pk_bf16_f32 v172, v56, v57
    v_cvt_pk_bf16_f32 v173, v58, v59
    v_mfma_f32_16x16x32_bf16 v[104:107], v[160:163], a[84:87], v[104:107]
    s_lshl_b32 s21, s21, 1
    ds_read_b64_tr_b16 a[76:77], v23 offset:20480
    ds_read_b64_tr_b16 a[78:79], v23 offset:20992
    v_mfma_f32_16x16x32_bf16 v[108:111], v[164:167], a[84:87], v[108:111]
    buffer_load_dwordx4 v9, s[32:35], s5 offen offset:3072 lds
    v_mfma_f32_16x16x32_bf16 v[112:115], v[160:163], a[88:91], v[112:115]
    s_sub_u32 s14, 8192, s21
    ds_read_b64_tr_b16 a[80:81], v20 offset:20480
    ds_read_b64_tr_b16 a[82:83], v20 offset:20992
    v_mfma_f32_16x16x32_bf16 v[116:119], v[164:167], a[88:91], v[116:119]
    s_sub_u32 s15, s21, 8192
    v_cvt_pk_bf16_f32 v174, v60, v61
    v_cvt_pk_bf16_f32 v175, v62, v63
    v_mfma_f32_16x16x32_bf16 v[120:123], v[160:163], a[92:95], v[120:123]
    s_and_b32 s20, s6, 4
    ds_read_b64_tr_b16 a[84:85], v21 offset:20480
    ds_read_b64_tr_b16 a[86:87], v21 offset:20992
    v_mfma_f32_16x16x32_bf16 v[124:127], v[164:167], a[92:95], v[124:127]
    s_waitcnt lgkmcnt(6)
    v_mul_f32 v36, v36, v36
    v_mul_f32 v37, v37, v37
    v_mfma_f32_4x4x4_16b_bf16 v[56:59], v[42:43], v[176:177], v[44:47]
    v_mfma_f32_4x4x4_16b_bf16 v[60:63], v[42:43], v[178:179], v[44:47]
    v_mul_f32 v34, 0xbfb8aa3b, v34
    v_mul_f32 v35, 0xbfb8aa3b, v35
    v_mfma_f32_16x16x32_bf16 v[64:67], v[168:171], a[64:67], v[64:67]
    s_mul_i32 s21, s20, 6144
    ds_read_b64_tr_b16 a[88:89], v24 offset:20480
    ds_read_b64_tr_b16 a[90:91], v24 offset:20992
    v_mfma_f32_16x16x32_bf16 v[68:71], v[172:175], a[64:67], v[68:71]
    ds_write2_b32 v38, v34, v35 offset1:16
    v_cvt_pk_bf16_f32 v176, v56, v57
    v_mfma_f32_16x16x32_bf16 v[72:75], v[168:171], a[68:71], v[72:75]
    s_lshl3_add_u32 s62, s8, s84
    ds_read_b64_tr_b16 a[92:93], v25 offset:20480
    ds_read_b64_tr_b16 a[94:95], v25 offset:20992
    v_mfma_f32_16x16x32_bf16 v[76:79], v[172:175], a[68:71], v[76:79]
    s_nop 0
    v_cvt_pk_bf16_f32 v177, v58, v59
    v_cvt_pk_bf16_f32 v178, v60, v61
    v_mfma_f32_16x16x32_bf16 v[80:83], v[168:171], a[72:75], v[80:83]
    s_add_u32 m0, s60, 49152
    ds_read_b64_tr_b16 a[64:65], v18 offset:24576
    ds_read_b64_tr_b16 a[66:67], v18 offset:25088
    v_mfma_f32_16x16x32_bf16 v[84:87], v[172:175], a[72:75], v[84:87]
    s_waitcnt lgkmcnt(7)
    buffer_load_dwordx4 v14, s[44:47], s62 offen offset:0 lds
    v_mfma_f32_16x16x32_bf16 v[88:91], v[168:171], a[76:79], v[88:91]
    s_add_u32 s9, s11, s21
    ds_read_b64_tr_b16 a[68:69], v19 offset:24576
    ds_read_b64_tr_b16 a[70:71], v19 offset:25088
    v_mfma_f32_16x16x32_bf16 v[92:95], v[172:175], a[76:79], v[92:95]
    buffer_load_dwordx4 v15, s[44:47], s62 offen offset:1024 lds
    v_cvt_pk_bf16_f32 v179, v62, v63
    v_mfma_f32_4x4x4_16b_bf16 v[56:59], v[42:43], v[180:181], v[48:51]
    v_mfma_f32_4x4x4_16b_bf16 v[60:63], v[42:43], v[182:183], v[48:51]
    buffer_load_dwordx4 v16, s[44:47], s62 offen offset:2048 lds
    v_mfma_f32_16x16x32_bf16 v[96:99], v[168:171], a[80:83], v[96:99]
    s_add_u32 s9, s9, 8192
    ds_read_b64_tr_b16 a[72:73], v22 offset:24576
    ds_read_b64_tr_b16 a[74:75], v22 offset:25088
    v_mfma_f32_16x16x32_bf16 v[100:103], v[172:175], a[80:83], v[100:103]
    buffer_load_dwordx4 v17, s[44:47], s62 offen offset:3072 lds
    v_mfma_f32_16x16x32_bf16 v[104:107], v[168:171], a[84:87], v[104:107]
    s_lshl_b32 s21, s21, 1
    ds_read_b64_tr_b16 a[76:77], v23 offset:24576
    ds_read_b64_tr_b16 a[78:79], v23 offset:25088
    v_mfma_f32_16x16x32_bf16 v[108:111], v[172:175], a[84:87], v[108:111]
    s_waitcnt lgkmcnt(6)
    v_cvt_pk_bf16_f32 v180, v56, v57
    v_cvt_pk_bf16_f32 v181, v58, v59
    v_mfma_f32_16x16x32_bf16 v[112:115], v[168:171], a[88:91], v[112:115]
    s_sub_u32 s16, 24576, s21
    ds_read_b64_tr_b16 a[80:81], v20 offset:24576
    ds_read_b64_tr_b16 a[82:83], v20 offset:25088
    v_mfma_f32_16x16x32_bf16 v[116:119], v[172:175], a[88:91], v[116:119]
    s_add_u32 s10, s10, 24576
    v_cvt_pk_bf16_f32 v182, v60, v61
    v_cvt_pk_bf16_f32 v183, v62, v63
    v_mfma_f32_16x16x32_bf16 v[120:123], v[168:171], a[92:95], v[120:123]
    s_lshl_b32 s85, s56, 17
    ds_read_b64_tr_b16 a[84:85], v21 offset:24576
    ds_read_b64_tr_b16 a[86:87], v21 offset:25088
    v_mfma_f32_16x16x32_bf16 v[124:127], v[172:175], a[92:95], v[124:127]
    s_add_u32 s85, s85, s83
    v_accvgpr_write_b32 a1, v129
    v_accvgpr_write_b32 a2, v130
    v_mfma_f32_4x4x4_16b_bf16 v[56:59], v[42:43], v[184:185], v[44:47]
    v_mfma_f32_4x4x4_16b_bf16 v[60:63], v[42:43], v[186:187], v[44:47]
    v_accvgpr_write_b32 a3, v131
    v_accvgpr_write_b32 a4, v132
    v_mfma_f32_16x16x32_bf16 v[64:67], v[176:179], a[64:67], v[64:67]
    s_mov_b32 s70, 0x35c1a2a0
    ds_read_b64_tr_b16 a[88:89], v24 offset:24576
    ds_read_b64_tr_b16 a[90:91], v24 offset:25088
    v_mfma_f32_16x16x32_bf16 v[68:71], v[180:183], a[64:67], v[68:71]
    s_waitcnt lgkmcnt(6)
    v_cvt_pk_bf16_f32 v184, v56, v57
    v_cvt_pk_bf16_f32 v185, v58, v59
    v_mfma_f32_16x16x32_bf16 v[72:75], v[176:179], a[68:71], v[72:75]
    s_mov_b32 s71, 0x3f317218
    ds_read_b64_tr_b16 a[92:93], v25 offset:24576
    ds_read_b64_tr_b16 a[94:95], v25 offset:25088
    v_mfma_f32_16x16x32_bf16 v[76:79], v[180:183], a[68:71], v[76:79]
    s_mov_b32 s69, 0x358637bd
    v_cvt_pk_bf16_f32 v186, v60, v61
    v_cvt_pk_bf16_f32 v187, v62, v63
    v_mfma_f32_16x16x32_bf16 v[80:83], v[176:179], a[72:75], v[80:83]
    s_lshl_b32 s20, s58, 2
    ds_read_b64_tr_b16 a[64:65], v18 offset:28672
    ds_read_b64_tr_b16 a[66:67], v18 offset:29184
    v_mfma_f32_16x16x32_bf16 v[84:87], v[180:183], a[72:75], v[84:87]
    v_accvgpr_write_b32 a5, v133
    v_accvgpr_write_b32 a6, v134
    v_mfma_f32_16x16x32_bf16 v[88:91], v[176:179], a[76:79], v[88:91]
    s_lshl3_add_u32 s62, s12, s62
    ds_read_b64_tr_b16 a[68:69], v19 offset:28672
    ds_read_b64_tr_b16 a[70:71], v19 offset:29184
    v_mfma_f32_16x16x32_bf16 v[92:95], v[180:183], a[76:79], v[92:95]
    s_waitcnt lgkmcnt(6)
    v_accvgpr_write_b32 a7, v135
    v_accvgpr_write_b32 a8, v136
    v_mfma_f32_4x4x4_16b_bf16 v[56:59], v[42:43], v[188:189], v[48:51]
    v_mfma_f32_4x4x4_16b_bf16 v[60:63], v[42:43], v[190:191], v[48:51]
    v_accvgpr_write_b32 a9, v137
    v_accvgpr_write_b32 a10, v138
    v_mfma_f32_16x16x32_bf16 v[96:99], v[176:179], a[80:83], v[96:99]
    s_add_u32 m0, s60, 57344
    ds_read_b64_tr_b16 a[72:73], v22 offset:28672
    ds_read_b64_tr_b16 a[74:75], v22 offset:29184
    v_mfma_f32_16x16x32_bf16 v[100:103], v[180:183], a[80:83], v[100:103]
    buffer_load_dwordx4 v14, s[44:47], s62 offen offset:0 lds
    v_mfma_f32_16x16x32_bf16 v[104:107], v[176:179], a[84:87], v[104:107]
    s_add_u32 s20, s20, s56
    ds_read_b64_tr_b16 a[76:77], v23 offset:28672
    ds_read_b64_tr_b16 a[78:79], v23 offset:29184
    v_mfma_f32_16x16x32_bf16 v[108:111], v[180:183], a[84:87], v[108:111]
    buffer_load_dwordx4 v15, s[44:47], s62 offen offset:1024 lds
    v_mfma_f32_16x16x32_bf16 v[112:115], v[176:179], a[88:91], v[112:115]
    s_mul_i32 s76, s20, 16384
    ds_read_b64_tr_b16 a[80:81], v20 offset:28672
    ds_read_b64_tr_b16 a[82:83], v20 offset:29184
    v_mfma_f32_16x16x32_bf16 v[116:119], v[180:183], a[88:91], v[116:119]
    s_waitcnt lgkmcnt(6)
    buffer_load_dwordx4 v16, s[44:47], s62 offen offset:2048 lds
    v_mfma_f32_16x16x32_bf16 v[120:123], v[176:179], a[92:95], v[120:123]
    s_add_u32 s76, s76, 10485760
    ds_read_b64_tr_b16 a[84:85], v21 offset:28672
    ds_read_b64_tr_b16 a[86:87], v21 offset:29184
    v_mfma_f32_16x16x32_bf16 v[124:127], v[180:183], a[92:95], v[124:127]
    buffer_load_dwordx4 v17, s[44:47], s62 offen offset:3072 lds
    v_cvt_pk_bf16_f32 v188, v56, v57
    v_cvt_pk_bf16_f32 v189, v58, v59
    v_cvt_pk_bf16_f32 v190, v60, v61
    v_cvt_pk_bf16_f32 v191, v62, v63
    v_mfma_f32_4x4x4_16b_bf16 v[56:59], v[42:43], v[192:193], v[44:47]
    v_mfma_f32_4x4x4_16b_bf16 v[60:63], v[42:43], v[194:195], v[44:47]
    v_accvgpr_write_b32 a11, v139
    v_accvgpr_write_b32 a12, v140
    v_mfma_f32_16x16x32_bf16 v[64:67], v[184:187], a[64:67], v[64:67]
    s_lshl_b32 s77, s20, 7
    ds_read_b64_tr_b16 a[88:89], v24 offset:28672
    ds_read_b64_tr_b16 a[90:91], v24 offset:29184
    v_mfma_f32_16x16x32_bf16 v[68:71], v[188:191], a[64:67], v[68:71]
    s_add_u32 s77, s77, 12648448
    v_cvt_pk_bf16_f32 v192, v56, v57
    v_cvt_pk_bf16_f32 v193, v58, v59
    v_mfma_f32_16x16x32_bf16 v[72:75], v[184:187], a[68:71], v[72:75]
    s_lshr_b32 s22, s63, 1
    ds_read_b64_tr_b16 a[92:93], v25 offset:28672
    ds_read_b64_tr_b16 a[94:95], v25 offset:29184
    v_mfma_f32_16x16x32_bf16 v[76:79], v[188:191], a[68:71], v[76:79]
    s_waitcnt lgkmcnt(6) vmcnt(13)
    v_cvt_pk_bf16_f32 v194, v60, v61
    v_cvt_pk_bf16_f32 v195, v62, v63
    v_mfma_f32_16x16x32_bf16 v[80:83], v[184:187], a[72:75], v[80:83]
    s_barrier
    ds_read_b64_tr_b16 a[64:65], v18 offset:32768
    ds_read_b64_tr_b16 a[66:67], v18 offset:33280
    v_mfma_f32_16x16x32_bf16 v[84:87], v[188:191], a[72:75], v[84:87]
    v_accvgpr_write_b32 a13, v141
    v_accvgpr_write_b32 a14, v142
    v_mfma_f32_16x16x32_bf16 v[88:91], v[184:187], a[76:79], v[88:91]
    s_add_u32 s4, s4, 1
    ds_read_b64_tr_b16 a[68:69], v19 offset:32768
    ds_read_b64_tr_b16 a[70:71], v19 offset:33280
    v_mfma_f32_16x16x32_bf16 v[92:95], v[188:191], a[76:79], v[92:95]
    s_mov_b64 exec, 0x1020408
    buffer_load_dword v55, v41, s[28:31], s80 offen sc0 sc1
    s_mov_b64 exec, -1
    v_mfma_f32_4x4x4_16b_bf16 v[56:59], v[42:43], v[196:197], v[48:51]
    v_mfma_f32_4x4x4_16b_bf16 v[60:63], v[42:43], v[198:199], v[48:51]
    s_mov_b64 exec, 0xf
    buffer_load_dword v55, v41, s[48:51], s96 offen sc0 sc1
    buffer_load_dword v55, v41, s[32:35], s97 offen sc0 sc1
    s_mov_b64 exec, -1
    v_mfma_f32_16x16x32_bf16 v[96:99], v[184:187], a[80:83], v[96:99]
    s_and_b32 s4, s4, 7
    ds_read_b64_tr_b16 a[72:73], v22 offset:32768
    ds_read_b64_tr_b16 a[74:75], v22 offset:33280
    v_mfma_f32_16x16x32_bf16 v[100:103], v[188:191], a[80:83], v[100:103]
    s_waitcnt lgkmcnt(6)
    v_cvt_pk_bf16_f32 v196, v56, v57
    v_cvt_pk_bf16_f32 v197, v58, v59
    v_mfma_f32_16x16x32_bf16 v[104:107], v[184:187], a[84:87], v[104:107]
    s_mul_i32 s5, s4, 196608
    ds_read_b64_tr_b16 a[76:77], v23 offset:32768
    ds_read_b64_tr_b16 a[78:79], v23 offset:33280
    v_mfma_f32_16x16x32_bf16 v[108:111], v[188:191], a[84:87], v[108:111]
    s_waitcnt vmcnt(7)
    ds_read_b64_tr_b16 a[96:97], v30 offset:49152
    ds_read_b64_tr_b16 a[98:99], v30 offset:51200
    v_mfma_f32_16x16x32_bf16 v[112:115], v[184:187], a[88:91], v[112:115]
    s_add_u32 m0, s60, 8192
    ds_read_b64_tr_b16 a[80:81], v20 offset:32768
    ds_read_b64_tr_b16 a[82:83], v20 offset:33280
    v_mfma_f32_16x16x32_bf16 v[116:119], v[188:191], a[88:91], v[116:119]
    buffer_load_dwordx4 v6, s[32:35], s5 offen offset:0 lds
    v_mfma_f32_16x16x32_bf16 v[120:123], v[184:187], a[92:95], v[120:123]
    s_lshl_b32 s21, s22, 2
    ds_read_b64_tr_b16 a[84:85], v21 offset:32768
    ds_read_b64_tr_b16 a[86:87], v21 offset:33280
    v_mfma_f32_16x16x32_bf16 v[124:127], v[188:191], a[92:95], v[124:127]
    s_waitcnt lgkmcnt(8)
    buffer_load_dwordx4 v7, s[32:35], s5 offen offset:1024 lds
    v_cvt_pk_bf16_f32 v198, v60, v61
    v_cvt_pk_bf16_f32 v199, v62, v63
    v_mfma_f32_4x4x4_16b_bf16 v[56:59], v[42:43], v[200:201], v[44:47]
    v_mfma_f32_4x4x4_16b_bf16 v[60:63], v[42:43], v[202:203], v[44:47]
    buffer_load_dwordx4 v8, s[32:35], s5 offen offset:2048 lds
    v_mfma_f32_16x16x32_bf16 v[64:67], v[192:195], a[64:67], v[64:67]
    s_lshr_b32 s20, s58, 1
    ds_read_b64_tr_b16 a[88:89], v24 offset:32768
    ds_read_b64_tr_b16 a[90:91], v24 offset:33280
    v_mfma_f32_16x16x32_bf16 v[68:71], v[196:199], a[64:67], v[68:71]
    ds_read_b64_tr_b16 a[100:101], v31 offset:49152
    ds_read_b64_tr_b16 a[102:103], v31 offset:51200
    v_mfma_f32_16x16x32_bf16 v[72:75], v[192:195], a[68:71], v[72:75]
    s_add_u32 s20, s20, s21
    ds_read_b64_tr_b16 a[92:93], v25 offset:32768
    ds_read_b64_tr_b16 a[94:95], v25 offset:33280
    v_mfma_f32_16x16x32_bf16 v[76:79], v[196:199], a[68:71], v[76:79]
    buffer_load_dwordx4 v9, s[32:35], s5 offen offset:3072 lds
    v_mfma_f32_16x16x32_bf16 v[80:83], v[192:195], a[72:75], v[80:83]
    s_add_u32 s4, s4, 1
    ds_read_b64_tr_b16 a[64:65], v18 offset:36864
    ds_read_b64_tr_b16 a[66:67], v18 offset:37376
    v_mfma_f32_16x16x32_bf16 v[84:87], v[196:199], a[72:75], v[84:87]
    s_waitcnt lgkmcnt(8)
    ds_read_b64_tr_b16 a[104:105], v32 offset:49152
    ds_read_b64_tr_b16 a[106:107], v32 offset:51200
    v_mfma_f32_16x16x32_bf16 v[88:91], v[192:195], a[76:79], v[88:91]
    s_and_b32 s4, s4, 7
    ds_read_b64_tr_b16 a[68:69], v19 offset:36864
    ds_read_b64_tr_b16 a[70:71], v19 offset:37376
    v_mfma_f32_16x16x32_bf16 v[92:95], v[196:199], a[76:79], v[92:95]
    ds_read_b64_tr_b16 a[108:109], v33 offset:49152
    ds_read_b64_tr_b16 a[110:111], v33 offset:51200
    v_cvt_pk_bf16_f32 v200, v56, v57
    v_cvt_pk_bf16_f32 v201, v58, v59
    v_cvt_pk_bf16_f32 v202, v60, v61
    v_cvt_pk_bf16_f32 v203, v62, v63
    v_mfma_f32_4x4x4_16b_bf16 v[56:59], v[42:43], v[204:205], v[48:51]
    v_mfma_f32_4x4x4_16b_bf16 v[60:63], v[42:43], v[206:207], v[48:51]
    v_accvgpr_write_b32 a15, v143
    v_accvgpr_write_b32 a16, v144
    v_mfma_f32_16x16x32_bf16 v[96:99], v[192:195], a[80:83], v[96:99]
    s_mul_i32 s5, s4, 229376
    ds_read_b64_tr_b16 a[72:73], v22 offset:36864
    ds_read_b64_tr_b16 a[74:75], v22 offset:37376
    v_mfma_f32_16x16x32_bf16 v[100:103], v[196:199], a[80:83], v[100:103]
    v_cvt_pk_bf16_f32 v204, v56, v57
    v_cvt_pk_bf16_f32 v205, v58, v59
    v_mfma_f32_16x16x32_bf16 v[104:107], v[192:195], a[84:87], v[104:107]
    s_add_u32 m0, s60, 16384
    ds_read_b64_tr_b16 a[76:77], v23 offset:36864
    ds_read_b64_tr_b16 a[78:79], v23 offset:37376
    v_mfma_f32_16x16x32_bf16 v[108:111], v[196:199], a[84:87], v[108:111]
    s_waitcnt lgkmcnt(10)
    buffer_load_dwordx4 v2, s[28:31], s5 offen offset:0 lds
    v_mfma_f32_16x16x32_bf16 v[112:115], v[192:195], a[88:91], v[112:115]
    s_lshl_b32 s78, s20, 9
    ds_read_b64_tr_b16 a[80:81], v20 offset:36864
    ds_read_b64_tr_b16 a[82:83], v20 offset:37376
    v_mfma_f32_16x16x32_bf16 v[116:119], v[196:199], a[88:91], v[116:119]
    buffer_load_dwordx4 v3, s[28:31], s5 offen offset:1024 lds
    v_mfma_f32_16x16x32_bf16 v[120:123], v[192:195], a[92:95], v[120:123]
    s_waitcnt vmcnt(9)
    ds_read_b64_tr_b16 a[84:85], v21 offset:36864
    ds_read_b64_tr_b16 a[86:87], v21 offset:37376
    v_mfma_f32_16x16x32_bf16 v[124:127], v[196:199], a[92:95], v[124:127]
    buffer_load_dwordx4 v4, s[28:31], s5 offen offset:2048 lds
    v_cvt_pk_bf16_f32 v206, v60, v61
    v_cvt_pk_bf16_f32 v207, v62, v63
    v_mfma_f32_4x4x4_16b_bf16 v[56:59], v[42:43], v[208:209], v[44:47]
    v_mfma_f32_4x4x4_16b_bf16 v[60:63], v[42:43], v[210:211], v[44:47]
    ds_read_b64_tr_b16 a[112:113], v30 offset:57344
    ds_read_b64_tr_b16 a[114:115], v30 offset:59392
    v_mfma_f32_16x16x32_bf16 v[64:67], v[200:203], a[64:67], v[64:67]
    s_add_u32 s78, s78, 12582912
    ds_read_b64_tr_b16 a[88:89], v24 offset:36864
    ds_read_b64_tr_b16 a[90:91], v24 offset:37376
    v_mfma_f32_16x16x32_bf16 v[68:71], v[204:207], a[64:67], v[68:71]
    s_waitcnt lgkmcnt(8)
    ds_read_b64_tr_b16 a[116:117], v31 offset:57344
    ds_read_b64_tr_b16 a[118:119], v31 offset:59392
    v_mfma_f32_16x16x32_bf16 v[72:75], v[200:203], a[68:71], v[72:75]
    s_mul_i32 s22, s22, 294912
    ds_read_b64_tr_b16 a[92:93], v25 offset:36864
    ds_read_b64_tr_b16 a[94:95], v25 offset:37376
    v_mfma_f32_16x16x32_bf16 v[76:79], v[204:207], a[68:71], v[76:79]
    ds_read_b64_tr_b16 a[120:121], v32 offset:57344
    ds_read_b64_tr_b16 a[122:123], v32 offset:59392
    v_mfma_f32_16x16x32_bf16 v[80:83], v[200:203], a[72:75], v[80:83]
    s_lshl_b32 s21, s75, 11
    ds_read_b64_tr_b16 a[64:65], v18 offset:40960
    ds_read_b64_tr_b16 a[66:67], v18 offset:41472
    v_mfma_f32_16x16x32_bf16 v[84:87], v[204:207], a[72:75], v[84:87]
    s_nop 0
    ds_read_b64_tr_b16 a[124:125], v33 offset:57344
    ds_read_b64_tr_b16 a[126:127], v33 offset:59392
    v_mfma_f32_16x16x32_bf16 v[88:91], v[200:203], a[76:79], v[88:91]
    s_add_u32 s22, s22, s21
    ds_read_b64_tr_b16 a[68:69], v19 offset:40960
    ds_read_b64_tr_b16 a[70:71], v19 offset:41472
    v_mfma_f32_16x16x32_bf16 v[92:95], v[204:207], a[76:79], v[92:95]
    s_waitcnt lgkmcnt(12)
    buffer_load_dwordx4 v5, s[28:31], s5 offen offset:3072 lds
    v_cvt_pk_bf16_f32 v208, v56, v57
    v_cvt_pk_bf16_f32 v209, v58, v59
    v_cvt_pk_bf16_f32 v210, v60, v61
    v_cvt_pk_bf16_f32 v211, v62, v63
    v_mfma_f32_4x4x4_16b_bf16 v[56:59], v[42:43], v[212:213], v[48:51]
    v_mfma_f32_4x4x4_16b_bf16 v[60:63], v[42:43], v[214:215], v[48:51]
    v_accvgpr_write_b32 a17, v145
    v_accvgpr_write_b32 a18, v146
    v_mfma_f32_16x16x32_bf16 v[96:99], v[200:203], a[80:83], v[96:99]
    s_lshl_b32 s68, s68, 12
    ds_read_b64_tr_b16 a[72:73], v22 offset:40960
    ds_read_b64_tr_b16 a[74:75], v22 offset:41472
    v_mfma_f32_16x16x32_bf16 v[100:103], v[204:207], a[80:83], v[100:103]
    s_nop 0
    v_cvt_pk_bf16_f32 v212, v56, v57
    v_cvt_pk_bf16_f32 v213, v58, v59
    v_mfma_f32_16x16x32_bf16 v[104:107], v[200:203], a[84:87], v[104:107]
    s_lshl3_add_u32 s62, s17, s62
    ds_read_b64_tr_b16 a[76:77], v23 offset:40960
    ds_read_b64_tr_b16 a[78:79], v23 offset:41472
    v_mfma_f32_16x16x32_bf16 v[108:111], v[204:207], a[84:87], v[108:111]
    s_nop 0
    v_cvt_pk_bf16_f32 v214, v60, v61
    v_cvt_pk_bf16_f32 v215, v62, v63
    v_mfma_f32_16x16x32_bf16 v[112:115], v[200:203], a[88:91], v[112:115]
    s_add_u32 m0, s60, 49152
    ds_read_b64_tr_b16 a[80:81], v20 offset:40960
    ds_read_b64_tr_b16 a[82:83], v20 offset:41472
    v_mfma_f32_16x16x32_bf16 v[116:119], v[204:207], a[88:91], v[116:119]
    s_waitcnt lgkmcnt(6)
    buffer_load_dwordx4 v14, s[44:47], s62 offen offset:0 lds
    v_mfma_f32_16x16x32_bf16 v[120:123], v[200:203], a[92:95], v[120:123]
    s_add_u32 s68, s68, s22
    ds_read_b64_tr_b16 a[84:85], v21 offset:40960
    ds_read_b64_tr_b16 a[86:87], v21 offset:41472
    v_mfma_f32_16x16x32_bf16 v[124:127], v[204:207], a[92:95], v[124:127]
    buffer_load_dwordx4 v15, s[44:47], s62 offen offset:1024 lds
    v_mfma_f32_4x4x4_16b_bf16 v[56:59], v[42:43], v[216:217], v[44:47]
    v_mfma_f32_4x4x4_16b_bf16 v[60:63], v[42:43], v[218:219], v[44:47]
    v_accvgpr_write_b32 a19, v147
    v_accvgpr_write_b32 a20, v148
    v_mfma_f32_16x16x32_bf16 v[64:67], v[208:211], a[64:67], v[64:67]
    s_lshl_b32 s67, s67, 12
    ds_read_b64_tr_b16 a[88:89], v24 offset:40960
    ds_read_b64_tr_b16 a[90:91], v24 offset:41472
    v_mfma_f32_16x16x32_bf16 v[68:71], v[212:215], a[64:67], v[68:71]
    s_nop 0
    v_cvt_pk_bf16_f32 v216, v56, v57
    v_cvt_pk_bf16_f32 v217, v58, v59
    v_mfma_f32_16x16x32_bf16 v[72:75], v[208:211], a[68:71], v[72:75]
    s_add_u32 s67, s67, s22
    ds_read_b64_tr_b16 a[92:93], v25 offset:40960
    ds_read_b64_tr_b16 a[94:95], v25 offset:41472
    v_mfma_f32_16x16x32_bf16 v[76:79], v[212:215], a[68:71], v[76:79]
    s_waitcnt lgkmcnt(6)
    buffer_load_dwordx4 v16, s[44:47], s62 offen offset:2048 lds
    v_mfma_f32_16x16x32_bf16 v[80:83], v[208:211], a[72:75], v[80:83]
    s_mul_i32 s20, s57, 1024
    ds_read_b64_tr_b16 a[64:65], v18 offset:45056
    ds_read_b64_tr_b16 a[66:67], v18 offset:45568
    v_mfma_f32_16x16x32_bf16 v[84:87], v[212:215], a[72:75], v[84:87]
    v_cvt_pk_bf16_f32 v218, v60, v61
    v_cvt_pk_bf16_f32 v219, v62, v63
    v_mfma_f32_16x16x32_bf16 v[88:91], v[208:211], a[76:79], v[88:91]
    s_add_u32 s76, s76, s20
    ds_read_b64_tr_b16 a[68:69], v19 offset:45056
    ds_read_b64_tr_b16 a[70:71], v19 offset:45568
    v_mfma_f32_16x16x32_bf16 v[92:95], v[212:215], a[76:79], v[92:95]
    buffer_load_dwordx4 v17, s[44:47], s62 offen offset:3072 lds
    v_mfma_f32_4x4x4_16b_bf16 v[56:59], v[42:43], v[220:221], v[48:51]
    v_mfma_f32_4x4x4_16b_bf16 v[60:63], v[42:43], v[222:223], v[48:51]
    v_accvgpr_write_b32 a21, v149
    v_accvgpr_write_b32 a22, v150
    v_mfma_f32_16x16x32_bf16 v[96:99], v[208:211], a[80:83], v[96:99]
    s_and_b32 s20, s2, 7
    ds_read_b64_tr_b16 a[72:73], v22 offset:45056
    ds_read_b64_tr_b16 a[74:75], v22 offset:45568
    v_mfma_f32_16x16x32_bf16 v[100:103], v[212:215], a[80:83], v[100:103]
    s_waitcnt lgkmcnt(6)
    v_cvt_pk_bf16_f32 v220, v56, v57
    v_cvt_pk_bf16_f32 v221, v58, v59
    v_mfma_f32_16x16x32_bf16 v[104:107], v[208:211], a[84:87], v[104:107]
    s_lshl3_add_u32 s62, s13, s62
    ds_read_b64_tr_b16 a[76:77], v23 offset:45056
    ds_read_b64_tr_b16 a[78:79], v23 offset:45568
    v_mfma_f32_16x16x32_bf16 v[108:111], v[212:215], a[84:87], v[108:111]
    v_cvt_pk_bf16_f32 v222, v60, v61
    v_cvt_pk_bf16_f32 v223, v62, v63
    v_mfma_f32_16x16x32_bf16 v[112:115], v[208:211], a[88:91], v[112:115]
    s_add_u32 m0, s60, 57344
    ds_read_b64_tr_b16 a[80:81], v20 offset:45056
    ds_read_b64_tr_b16 a[82:83], v20 offset:45568
    v_mfma_f32_16x16x32_bf16 v[116:119], v[212:215], a[88:91], v[116:119]
    buffer_load_dwordx4 v14, s[44:47], s62 offen offset:0 lds
    v_mfma_f32_16x16x32_bf16 v[120:123], v[208:211], a[92:95], v[120:123]
    s_lshl_b32 s20, s20, 2
    ds_read_b64_tr_b16 a[84:85], v21 offset:45056
    ds_read_b64_tr_b16 a[86:87], v21 offset:45568
    v_mfma_f32_16x16x32_bf16 v[124:127], v[212:215], a[92:95], v[124:127]
    s_waitcnt lgkmcnt(6)
    buffer_load_dwordx4 v15, s[44:47], s62 offen offset:1024 lds
    v_mfma_f32_4x4x4_16b_bf16 v[56:59], v[42:43], v[224:225], v[44:47]
    v_mfma_f32_4x4x4_16b_bf16 v[60:63], v[42:43], v[226:227], v[44:47]
    v_accvgpr_write_b32 a23, v151
    v_accvgpr_write_b32 a24, v152
    v_mfma_f32_16x16x32_bf16 v[64:67], v[216:219], a[64:67], v[64:67]
    s_bfe_u32 s21, s2, 0x20003
    ds_read_b64_tr_b16 a[88:89], v24 offset:45056
    ds_read_b64_tr_b16 a[90:91], v24 offset:45568
    v_mfma_f32_16x16x32_bf16 v[68:71], v[220:223], a[64:67], v[68:71]
    v_cvt_pk_bf16_f32 v224, v56, v57
    v_cvt_pk_bf16_f32 v225, v58, v59
    v_mfma_f32_16x16x32_bf16 v[72:75], v[216:219], a[68:71], v[72:75]
    s_add_u32 s82, s20, s21
    ds_read_b64_tr_b16 a[92:93], v25 offset:45056
    ds_read_b64_tr_b16 a[94:95], v25 offset:45568
    v_mfma_f32_16x16x32_bf16 v[76:79], v[220:223], a[68:71], v[76:79]
    s_waitcnt vmcnt(10)
    buffer_load_dwordx4 v16, s[44:47], s62 offen offset:2048 lds
    v_mfma_f32_16x16x32_bf16 v[80:83], v[216:219], a[72:75], v[80:83]
    s_barrier
    ds_read_b64_tr_b16 a[64:65], v18 offset:0
    ds_read_b64_tr_b16 a[66:67], v18 offset:512
    v_mfma_f32_16x16x32_bf16 v[84:87], v[220:223], a[72:75], v[84:87]
    s_waitcnt lgkmcnt(6)
    buffer_load_dwordx4 v17, s[44:47], s62 offen offset:3072 lds
    v_mfma_f32_16x16x32_bf16 v[88:91], v[216:219], a[76:79], v[88:91]
    s_add_u32 s4, s4, 1
    ds_read_b64_tr_b16 a[68:69], v19 offset:0
    ds_read_b64_tr_b16 a[70:71], v19 offset:512
    v_mfma_f32_16x16x32_bf16 v[92:95], v[220:223], a[76:79], v[92:95]
    s_nop 0
    v_cvt_pk_bf16_f32 v226, v60, v61
    v_cvt_pk_bf16_f32 v227, v62, v63
    v_mfma_f32_4x4x4_16b_bf16 v[56:59], v[42:43], v[228:229], v[48:51]
    v_mfma_f32_4x4x4_16b_bf16 v[60:63], v[42:43], v[230:231], v[48:51]
    v_accvgpr_write_b32 a25, v153
    v_accvgpr_write_b32 a26, v154
    v_mfma_f32_16x16x32_bf16 v[96:99], v[216:219], a[80:83], v[96:99]
    s_and_b32 s4, s4, 7
    ds_read_b64_tr_b16 a[72:73], v22 offset:0
    ds_read_b64_tr_b16 a[74:75], v22 offset:512
    v_mfma_f32_16x16x32_bf16 v[100:103], v[220:223], a[80:83], v[100:103]
    buffer_load_dword v38, off, s[40:43], 0 offset:0 sc1
    v_mfma_f32_16x16x32_bf16 v[104:107], v[216:219], a[84:87], v[104:107]
    s_mul_i32 s5, s4, 229376
    ds_read_b64_tr_b16 a[76:77], v23 offset:0
    ds_read_b64_tr_b16 a[78:79], v23 offset:512
    v_mfma_f32_16x16x32_bf16 v[108:111], v[220:223], a[84:87], v[108:111]
    s_waitcnt lgkmcnt(6)
    v_cvt_pk_bf16_f32 v228, v56, v57
    v_cvt_pk_bf16_f32 v229, v58, v59
    v_mfma_f32_16x16x32_bf16 v[112:115], v[216:219], a[88:91], v[112:115]
    s_add_u32 m0, s60, 24576
    ds_read_b64_tr_b16 a[80:81], v20 offset:0
    ds_read_b64_tr_b16 a[82:83], v20 offset:512
    v_mfma_f32_16x16x32_bf16 v[116:119], v[220:223], a[88:91], v[116:119]
    buffer_load_dwordx4 v2, s[28:31], s5 offen offset:0 lds
    v_mfma_f32_16x16x32_bf16 v[120:123], v[216:219], a[92:95], v[120:123]
    s_lshl_b32 s20, s82, 2
    ds_read_b64_tr_b16 a[84:85], v21 offset:0
    ds_read_b64_tr_b16 a[86:87], v21 offset:512
    v_mfma_f32_16x16x32_bf16 v[124:127], v[220:223], a[92:95], v[124:127]
    s_nop 0
    v_cvt_pk_bf16_f32 v230, v60, v61
    v_cvt_pk_bf16_f32 v231, v62, v63
    v_mfma_f32_4x4x4_16b_bf16 v[56:59], v[42:43], v[232:233], v[44:47]
    v_mfma_f32_4x4x4_16b_bf16 v[60:63], v[42:43], v[234:235], v[44:47]
    v_accvgpr_write_b32 a27, v155
    v_accvgpr_write_b32 a28, v156
    v_mfma_f32_16x16x32_bf16 v[64:67], v[224:227], a[64:67], v[64:67]
    s_add_u32 s20, s20, s56
    ds_read_b64_tr_b16 a[88:89], v24 offset:0
    ds_read_b64_tr_b16 a[90:91], v24 offset:512
    v_mfma_f32_16x16x32_bf16 v[68:71], v[228:231], a[64:67], v[68:71]
    s_waitcnt lgkmcnt(6)
    buffer_load_dwordx4 v3, s[28:31], s5 offen offset:1024 lds
    v_mfma_f32_16x16x32_bf16 v[72:75], v[224:227], a[68:71], v[72:75]
    s_lshl_b32 s79, s20, 9
    ds_read_b64_tr_b16 a[92:93], v25 offset:0
    ds_read_b64_tr_b16 a[94:95], v25 offset:512
    v_mfma_f32_16x16x32_bf16 v[76:79], v[228:231], a[68:71], v[76:79]
    s_nop 0
    v_cvt_pk_bf16_f32 v232, v56, v57
    v_cvt_pk_bf16_f32 v233, v58, v59
    v_mfma_f32_16x16x32_bf16 v[80:83], v[224:227], a[72:75], v[80:83]
    s_add_u32 s79, s79, 12582912
    ds_read_b64_tr_b16 a[64:65], v18 offset:4096
    ds_read_b64_tr_b16 a[66:67], v18 offset:4608
L_padB2:
    s_cbranch_execz L_padB6
    v_mfma_f32_16x16x32_bf16 v[84:87], v[228:231], a[72:75], v[84:87]
    buffer_load_dwordx4 v4, s[28:31], s5 offen offset:2048 lds
    v_mfma_f32_16x16x32_bf16 v[88:91], v[224:227], a[76:79], v[88:91]
    s_lshl3_add_u32 s88, s82, s56
    ds_read_b64_tr_b16 a[68:69], v19 offset:4096
    ds_read_b64_tr_b16 a[70:71], v19 offset:4608
    v_mfma_f32_16x16x32_bf16 v[92:95], v[228:231], a[76:79], v[92:95]
    s_waitcnt lgkmcnt(6)
    v_cvt_pk_bf16_f32 v234, v60, v61
    v_cvt_pk_bf16_f32 v235, v62, v63
    v_mfma_f32_4x4x4_16b_bf16 v[56:59], v[42:43], v[236:237], v[48:51]
    v_mfma_f32_4x4x4_16b_bf16 v[60:63], v[42:43], v[238:239], v[48:51]
    v_accvgpr_write_b32 a29, v157
    v_accvgpr_write_b32 a30, v158
    v_mfma_f32_16x16x32_bf16 v[96:99], v[224:227], a[80:83], v[96:99]
    s_lshl_b32 s88, s88, 13
    ds_read_b64_tr_b16 a[72:73], v22 offset:4096
    ds_read_b64_tr_b16 a[74:75], v22 offset:4608
    v_mfma_f32_16x16x32_bf16 v[100:103], v[228:231], a[80:83], v[100:103]
    s_waitcnt vmcnt(8)
    buffer_load_dwordx4 v5, s[28:31], s5 offen offset:3072 lds
    v_mfma_f32_16x16x32_bf16 v[104:107], v[224:227], a[84:87], v[104:107]
    s_add_u32 s4, s4, 1
    ds_read_b64_tr_b16 a[76:77], v23 offset:4096
    ds_read_b64_tr_b16 a[78:79], v23 offset:4608
    v_mfma_f32_16x16x32_bf16 v[108:111], v[228:231], a[84:87], v[108:111]
    ds_read_b64_tr_b16 a[128:129], v30 offset:49152
    ds_read_b64_tr_b16 a[130:131], v30 offset:51200
    v_mfma_f32_16x16x32_bf16 v[112:115], v[224:227], a[88:91], v[112:115]
    s_and_b32 s4, s4, 7
    ds_read_b64_tr_b16 a[80:81], v20 offset:4096
    ds_read_b64_tr_b16 a[82:83], v20 offset:4608
    v_mfma_f32_16x16x32_bf16 v[116:119], v[228:231], a[88:91], v[116:119]
    s_waitcnt lgkmcnt(8)
    ds_read_b64_tr_b16 a[132:133], v31 offset:49152
    ds_read_b64_tr_b16 a[134:135], v31 offset:51200
    v_mfma_f32_16x16x32_bf16 v[120:123], v[224:227], a[92:95], v[120:123]
    s_mul_i32 s5, s4, 229376
    ds_read_b64_tr_b16 a[84:85], v21 offset:4096
    ds_read_b64_tr_b16 a[86:87], v21 offset:4608
    v_mfma_f32_16x16x32_bf16 v[124:127], v[228:231], a[92:95], v[124:127]
    ds_read_b64_tr_b16 a[136:137], v32 offset:49152
    ds_read_b64_tr_b16 a[138:139], v32 offset:51200
    v_cvt_pk_bf16_f32 v236, v56, v57
    v_cvt_pk_bf16_f32 v237, v58, v59
    v_cvt_pk_bf16_f32 v238, v60, v61
    v_cvt_pk_bf16_f32 v239, v62, v63
    v_mfma_f32_4x4x4_16b_bf16 v[56:59], v[42:43], v[240:241], v[44:47]
    v_mfma_f32_4x4x4_16b_bf16 v[60:63], v[42:43], v[242:243], v[44:47]
    ds_read_b64_tr_b16 a[140:141], v33 offset:49152
    ds_read_b64_tr_b16 a[142:143], v33 offset:51200
    v_mfma_f32_16x16x32_bf16 v[64:67], v[232:235], a[64:67], v[64:67]
    s_add_u32 m0, s60, 32768
    ds_read_b64_tr_b16 a[88:89], v24 offset:4096
    ds_read_b64_tr_b16 a[90:91], v24 offset:4608
    v_mfma_f32_16x16x32_bf16 v[68:71], v[236:239], a[64:67], v[68:71]
    buffer_load_dwordx4 v2, s[28:31], s5 offen offset:0 lds
    v_mfma_f32_16x16x32_bf16 v[72:75], v[232:235], a[68:71], v[72:75]
    s_add_u32 s88, s88, s83
    ds_read_b64_tr_b16 a[92:93], v25 offset:4096
    ds_read_b64_tr_b16 a[94:95], v25 offset:4608
    v_mfma_f32_16x16x32_bf16 v[76:79], v[236:239], a[68:71], v[76:79]
    s_waitcnt lgkmcnt(12)
    buffer_load_dwordx4 v3, s[28:31], s5 offen offset:1024 lds
    v_mfma_f32_16x16x32_bf16 v[80:83], v[232:235], a[72:75], v[80:83]
    s_add_u32 s89, s88, 32768
    ds_read_b64_tr_b16 a[64:65], v18 offset:8192
    ds_read_b64_tr_b16 a[66:67], v18 offset:8704
    v_mfma_f32_16x16x32_bf16 v[84:87], v[236:239], a[72:75], v[84:87]
    buffer_load_dwordx4 v4, s[28:31], s5 offen offset:2048 lds
    v_mfma_f32_16x16x32_bf16 v[88:91], v[232:235], a[76:79], v[88:91]
    s_mul_i32 s21, s82, 294912
    ds_read_b64_tr_b16 a[68:69], v19 offset:8192
    ds_read_b64_tr_b16 a[70:71], v19 offset:8704
    v_mfma_f32_16x16x32_bf16 v[92:95], v[236:239], a[76:79], v[92:95]
    v_cvt_pk_bf16_f32 v240, v56, v57
    v_cvt_pk_bf16_f32 v241, v58, v59
    v_cvt_pk_bf16_f32 v242, v60, v61
    v_cvt_pk_bf16_f32 v243, v62, v63
    v_mfma_f32_4x4x4_16b_bf16 v[56:59], v[42:43], v[244:245], v[48:51]
    v_mfma_f32_4x4x4_16b_bf16 v[60:63], v[42:43], v[246:247], v[48:51]
    v_accvgpr_write_b32 a31, v159
    v_accvgpr_write_b32 a32, v160
    v_mfma_f32_16x16x32_bf16 v[96:99], v[232:235], a[80:83], v[96:99]
    s_waitcnt vmcnt(8)
    ds_read_b64_tr_b16 a[72:73], v22 offset:8192
    ds_read_b64_tr_b16 a[74:75], v22 offset:8704
    v_mfma_f32_16x16x32_bf16 v[100:103], v[236:239], a[80:83], v[100:103]
    s_waitcnt lgkmcnt(6)
    buffer_load_dwordx4 v5, s[28:31], s5 offen offset:3072 lds
    v_mfma_f32_16x16x32_bf16 v[104:107], v[232:235], a[84:87], v[104:107]
    s_mul_i32 s86, s56, 57344
    ds_read_b64_tr_b16 a[76:77], v23 offset:8192
    ds_read_b64_tr_b16 a[78:79], v23 offset:8704
    v_mfma_f32_16x16x32_bf16 v[108:111], v[236:239], a[84:87], v[108:111]
    ds_read_b64_tr_b16 a[144:145], v30 offset:57344
    ds_read_b64_tr_b16 a[146:147], v30 offset:59392
    v_mfma_f32_16x16x32_bf16 v[112:115], v[232:235], a[88:91], v[112:115]
    s_lshl3_add_u32 s62, s9, s84
    ds_read_b64_tr_b16 a[80:81], v20 offset:8192
    ds_read_b64_tr_b16 a[82:83], v20 offset:8704
    v_mfma_f32_16x16x32_bf16 v[116:119], v[236:239], a[88:91], v[116:119]
    s_nop 0
    ds_read_b64_tr_b16 a[148:149], v31 offset:57344
    ds_read_b64_tr_b16 a[150:151], v31 offset:59392
    v_mfma_f32_16x16x32_bf16 v[120:123], v[232:235], a[92:95], v[120:123]
    s_add_u32 m0, s60, 49152
    ds_read_b64_tr_b16 a[84:85], v21 offset:8192
    ds_read_b64_tr_b16 a[86:87], v21 offset:8704
    v_mfma_f32_16x16x32_bf16 v[124:127], v[236:239], a[92:95], v[124:127]
    s_waitcnt lgkmcnt(10)
    buffer_load_dwordx4 v14, s[44:47], s62 offen offset:0 lds
    v_cvt_pk_bf16_f32 v244, v56, v57
    v_cvt_pk_bf16_f32 v245, v58, v59
    v_cvt_pk_bf16_f32 v246, v60, v61
    v_cvt_pk_bf16_f32 v247, v62, v63
    v_mfma_f32_4x4x4_16b_bf16 v[56:59], v[42:43], v[248:249], v[44:47]
    v_mfma_f32_4x4x4_16b_bf16 v[60:63], v[42:43], v[250:251], v[44:47]
    buffer_load_dwordx4 v15, s[44:47], s62 offen offset:1024 lds
    v_mfma_f32_16x16x32_bf16 v[64:67], v[240:243], a[64:67], v[64:67]
    s_add_u32 s86, s86, s21
    ds_read_b64_tr_b16 a[88:89], v24 offset:8192
    ds_read_b64_tr_b16 a[90:91], v24 offset:8704
    v_mfma_f32_16x16x32_bf16 v[68:71], v[244:247], a[64:67], v[68:71]
    ds_read_b64_tr_b16 a[152:153], v32 offset:57344
    ds_read_b64_tr_b16 a[154:155], v32 offset:59392
    v_mfma_f32_16x16x32_bf16 v[72:75], v[240:243], a[68:71], v[72:75]
    s_lshl_b32 s87, s56, 14
    ds_read_b64_tr_b16 a[92:93], v25 offset:8192
    ds_read_b64_tr_b16 a[94:95], v25 offset:8704
    v_mfma_f32_16x16x32_bf16 v[76:79], v[244:247], a[68:71], v[76:79]
    buffer_load_dwordx4 v16, s[44:47], s62 offen offset:2048 lds
    v_mfma_f32_16x16x32_bf16 v[80:83], v[240:243], a[72:75], v[80:83]
    s_add_u32 s87, s87, s21
    ds_read_b64_tr_b16 a[64:65], v18 offset:12288
    ds_read_b64_tr_b16 a[66:67], v18 offset:12800
    v_mfma_f32_16x16x32_bf16 v[84:87], v[244:247], a[72:75], v[84:87]
    s_waitcnt lgkmcnt(8)
    ds_read_b64_tr_b16 a[156:157], v33 offset:57344
    ds_read_b64_tr_b16 a[158:159], v33 offset:59392
    v_mfma_f32_16x16x32_bf16 v[88:91], v[240:243], a[76:79], v[88:91]
    s_add_u32 s87, s87, 229376
    ds_read_b64_tr_b16 a[68:69], v19 offset:12288
    ds_read_b64_tr_b16 a[70:71], v19 offset:12800
    v_mfma_f32_16x16x32_bf16 v[92:95], v[244:247], a[76:79], v[92:95]
    buffer_load_dwordx4 v17, s[44:47], s62 offen offset:3072 lds
    v_cvt_pk_bf16_f32 v248, v56, v57
    v_cvt_pk_bf16_f32 v249, v58, v59
    v_cvt_pk_bf16_f32 v250, v60, v61
    v_cvt_pk_bf16_f32 v251, v62, v63
    v_mfma_f32_4x4x4_16b_bf16 v[56:59], v[42:43], v[252:253], v[48:51]
    v_mfma_f32_4x4x4_16b_bf16 v[60:63], v[42:43], v[254:255], v[48:51]
    v_accvgpr_write_b32 a33, v161
    v_accvgpr_write_b32 a34, v162
    v_mfma_f32_16x16x32_bf16 v[96:99], v[240:243], a[80:83], v[96:99]
    s_nop 0
    ds_read_b64_tr_b16 a[72:73], v22 offset:12288
    ds_read_b64_tr_b16 a[74:75], v22 offset:12800
    v_mfma_f32_16x16x32_bf16 v[100:103], v[244:247], a[80:83], v[100:103]
    s_waitcnt lgkmcnt(4) vmcnt(12)
    v_readfirstlane_b32 s72, v38
    s_nop 0
    s_cmp_ge_u32 s72, 9
    s_cbranch_scc0 L_slow_initB
L_back_initB:
    v_mfma_f32_16x16x32_bf16 v[104:107], v[240:243], a[84:87], v[104:107]
    s_lshl3_add_u32 s62, s12, s62
    ds_read_b64_tr_b16 a[76:77], v23 offset:12288
    ds_read_b64_tr_b16 a[78:79], v23 offset:12800
    v_mfma_f32_16x16x32_bf16 v[108:111], v[244:247], a[84:87], v[108:111]
    v_cvt_pk_bf16_f32 v252, v56, v57
    v_cvt_pk_bf16_f32 v253, v58, v59
    v_mfma_f32_16x16x32_bf16 v[112:115], v[240:243], a[88:91], v[112:115]
    s_add_u32 m0, s60, 57344
    ds_read_b64_tr_b16 a[80:81], v20 offset:12288
    ds_read_b64_tr_b16 a[82:83], v20 offset:12800
    v_mfma_f32_16x16x32_bf16 v[116:119], v[244:247], a[88:91], v[116:119]
    buffer_load_dwordx4 v14, s[44:47], s62 offen offset:0 lds
    v_mfma_f32_16x16x32_bf16 v[120:123], v[240:243], a[92:95], v[120:123]
    ds_read_b64_tr_b16 a[84:85], v21 offset:12288
    ds_read_b64_tr_b16 a[86:87], v21 offset:12800
    v_mfma_f32_16x16x32_bf16 v[124:127], v[244:247], a[92:95], v[124:127]
    buffer_load_dwordx4 v15, s[44:47], s62 offen offset:1024 lds
    v_cvt_pk_bf16_f32 v254, v60, v61
    v_cvt_pk_bf16_f32 v255, v62, v63
    v_mfma_f32_16x16x32_bf16 v[64:67], v[248:251], a[64:67], v[64:67]
    ds_read_b64_tr_b16 a[88:89], v24 offset:12288
    ds_read_b64_tr_b16 a[90:91], v24 offset:12800
    v_mfma_f32_16x16x32_bf16 v[68:71], v[252:255], a[64:67], v[68:71]
    s_waitcnt lgkmcnt(6)
    v_accvgpr_write_b32 a35, v163
    v_accvgpr_write_b32 a36, v164
    v_mfma_f32_16x16x32_bf16 v[72:75], v[248:251], a[68:71], v[72:75]
    s_nop 0
    ds_read_b64_tr_b16 a[92:93], v25 offset:12288
    ds_read_b64_tr_b16 a[94:95], v25 offset:12800
    v_mfma_f32_16x16x32_bf16 v[76:79], v[252:255], a[68:71], v[76:79]
    s_waitcnt vmcnt(10)
    buffer_load_dwordx4 v16, s[44:47], s62 offen offset:2048 lds
    v_mfma_f32_16x16x32_bf16 v[80:83], v[248:251], a[72:75], v[80:83]
    s_barrier
    ds_read_b64_tr_b16 a[64:65], v18 offset:16384
    ds_read_b64_tr_b16 a[66:67], v18 offset:16896
    v_mfma_f32_16x16x32_bf16 v[84:87], v[252:255], a[72:75], v[84:87]
    buffer_load_dwordx4 v17, s[44:47], s62 offen offset:3072 lds
    v_mfma_f32_16x16x32_bf16 v[88:91], v[248:251], a[76:79], v[88:91]
    s_add_u32 s4, s4, 1
    ds_read_b64_tr_b16 a[68:69], v19 offset:16384
    ds_read_b64_tr_b16 a[70:71], v19 offset:16896
    v_mfma_f32_16x16x32_bf16 v[92:95], v[252:255], a[76:79], v[92:95]
    s_waitcnt lgkmcnt(6)
    v_accvgpr_write_b32 a37, v165
    v_accvgpr_write_b32 a38, v166
    v_mfma_f32_16x16x32_bf16 v[96:99], v[248:251], a[80:83], v[96:99]
    s_and_b32 s4, s4, 7
    ds_read_b64_tr_b16 a[72:73], v22 offset:16384
    ds_read_b64_tr_b16 a[74:75], v22 offset:16896
    v_mfma_f32_16x16x32_bf16 v[100:103], v[252:255], a[80:83], v[100:103]
    s_nop 0
    v_accvgpr_write_b32 a39, v167
    v_accvgpr_write_b32 a40, v168
    v_mfma_f32_16x16x32_bf16 v[104:107], v[248:251], a[84:87], v[104:107]
    s_mul_i32 s5, s4, 229376
    ds_read_b64_tr_b16 a[76:77], v23 offset:16384
    ds_read_b64_tr_b16 a[78:79], v23 offset:16896
    v_mfma_f32_16x16x32_bf16 v[108:111], v[252:255], a[84:87], v[108:111]
    v_accvgpr_write_b32 a41, v169
    v_accvgpr_write_b32 a42, v170
    v_mfma_f32_16x16x32_bf16 v[112:115], v[248:251], a[88:91], v[112:115]
    s_add_u32 m0, s60, 40960
    ds_read_b64_tr_b16 a[80:81], v20 offset:16384
    ds_read_b64_tr_b16 a[82:83], v20 offset:16896
    v_mfma_f32_16x16x32_bf16 v[116:119], v[252:255], a[88:91], v[116:119]
    s_waitcnt lgkmcnt(6)
    buffer_load_dwordx4 v2, s[28:31], s5 offen offset:0 lds
    v_mfma_f32_16x16x32_bf16 v[120:123], v[248:251], a[92:95], v[120:123]
    s_nop 0
    ds_read_b64_tr_b16 a[84:85], v21 offset:16384
    ds_read_b64_tr_b16 a[86:87], v21 offset:16896
    v_mfma_f32_16x16x32_bf16 v[124:127], v[252:255], a[92:95], v[124:127]
    buffer_load_dwordx4 v3, s[28:31], s5 offen offset:1024 lds
    v_accvgpr_write_b32 a43, v171
    v_accvgpr_write_b32 a44, v172
    v_accvgpr_write_b32 a45, v173
    v_accvgpr_write_b32 a46, v174
    v_accvgpr_write_b32 a47, v175
    v_accvgpr_write_b32 a48, v176
    v_accvgpr_write_b32 a49, v177
    v_accvgpr_write_b32 a50, v178
    v_accvgpr_write_b32 a51, v179
    v_accvgpr_write_b32 a52, v180
    v_accvgpr_write_b32 a53, v181
    v_accvgpr_write_b32 a54, v182
    v_accvgpr_write_b32 a55, v183
    v_accvgpr_write_b32 a56, v184
    v_accvgpr_write_b32 a57, v185
    v_accvgpr_write_b32 a58, v186
    v_accvgpr_write_b32 a59, v187
    v_accvgpr_write_b32 a60, v188
    v_accvgpr_write_b32 a61, v189
    v_accvgpr_write_b32 a62, v190
    v_accvgpr_write_b32 a63, v191
    ds_read_b128 v[56:59], v54 offset:0
    ds_read_b128 v[60:63], v54 offset:64
    v_mfma_f32_16x16x32_bf16 v[128:131], a[64:67], a[0:3], 0
    ds_read_b64_tr_b16 a[88:89], v24 offset:16384
    ds_read_b64_tr_b16 a[90:91], v24 offset:16896
    v_mfma_f32_16x16x32_bf16 v[144:147], a[64:67], a[4:7], 0
    buffer_load_dwordx4 v4, s[28:31], s5 offen offset:2048 lds
    v_mfma_f32_16x16x32_bf16 v[132:135], a[68:71], a[0:3], 0
    ds_read_b64_tr_b16 a[92:93], v25 offset:16384
    ds_read_b64_tr_b16 a[94:95], v25 offset:16896
    v_mfma_f32_16x16x32_bf16 v[148:151], a[68:71], a[4:7], 0
    s_waitcnt lgkmcnt(8)
    buffer_load_dwordx4 v5, s[28:31], s5 offen offset:3072 lds
    s_add_u32 s4, s4, 1
    s_and_b32 s4, s4, 7
    s_mul_i32 s5, s4, 229376
    s_mov_b32 m0, s60
    v_mfma_f32_16x16x32_bf16 v[136:139], a[72:75], a[0:3], 0
    ds_read_b64_tr_b16 a[64:65], v18 offset:20480
    ds_read_b64_tr_b16 a[66:67], v18 offset:20992
    v_mfma_f32_16x16x32_bf16 v[152:155], a[72:75], a[4:7], 0
    s_waitcnt lgkmcnt(6)
    v_pk_fma_f32 v[64:65], v[64:65], v[56:57], s[70:71] op_sel:[0,0,0] op_sel_hi:[1,1,0] neg_lo:[0,1,0] neg_hi:[0,1,0]
    v_pk_fma_f32 v[66:67], v[66:67], v[58:59], s[70:71] op_sel:[0,0,0] op_sel_hi:[1,1,0] neg_lo:[0,1,0] neg_hi:[0,1,0]
    v_pk_fma_f32 v[68:69], v[68:69], v[60:61], s[70:71] op_sel:[0,0,0] op_sel_hi:[1,1,0] neg_lo:[0,1,0] neg_hi:[0,1,0]
    v_pk_fma_f32 v[70:71], v[70:71], v[62:63], s[70:71] op_sel:[0,0,0] op_sel_hi:[1,1,0] neg_lo:[0,1,0] neg_hi:[0,1,0]
    v_mfma_f32_16x16x32_bf16 v[140:143], a[76:79], a[0:3], 0
    s_waitcnt vmcnt(8)
    ds_read_b64_tr_b16 a[68:69], v19 offset:20480
    ds_read_b64_tr_b16 a[70:71], v19 offset:20992
    v_mfma_f32_16x16x32_bf16 v[156:159], a[76:79], a[4:7], 0
    buffer_load_dwordx4 v2, s[28:31], s5 offen offset:0 lds
    ds_read_b64_tr_b16 a[160:161], v30 offset:49152
    ds_read_b64_tr_b16 a[162:163], v30 offset:51200
    v_exp_f32 v44, v64 clamp
    v_exp_f32 v45, v65 clamp
    v_pk_fma_f32 v[72:73], v[72:73], v[56:57], s[70:71] op_sel:[0,0,0] op_sel_hi:[1,1,0] neg_lo:[0,1,0] neg_hi:[0,1,0]
    v_max_f32_e64 v64, s70, v64
    v_mfma_f32_16x16x32_bf16 v[160:163], a[80:83], a[0:3], 0
    ds_read_b64_tr_b16 a[72:73], v22 offset:20480
    ds_read_b64_tr_b16 a[74:75], v22 offset:20992
    v_mfma_f32_16x16x32_bf16 v[176:179], a[80:83], a[4:7], 0
    s_waitcnt lgkmcnt(8)
    buffer_load_dwordx4 v3, s[28:31], s5 offen offset:1024 lds
    ds_read_b64_tr_b16 a[164:165], v31 offset:49152
    ds_read_b64_tr_b16 a[166:167], v31 offset:51200
    v_max_f32 v65, s70, v65
    v_pk_fma_f32 v[64:65], v[64:65], s[70:71], v[44:45] op_sel:[0,1,0] op_sel_hi:[1,1,1]
    v_exp_f32 v46, v66 clamp
    v_exp_f32 v47, v67 clamp
    v_mfma_f32_16x16x32_bf16 v[164:167], a[84:87], a[0:3], 0
    ds_read_b64_tr_b16 a[76:77], v23 offset:20480
    ds_read_b64_tr_b16 a[78:79], v23 offset:20992
    v_mfma_f32_16x16x32_bf16 v[180:183], a[84:87], a[4:7], 0
    buffer_load_dwordx4 v4, s[28:31], s5 offen offset:2048 lds
    ds_read_b64_tr_b16 a[168:169], v32 offset:49152
    ds_read_b64_tr_b16 a[170:171], v32 offset:51200
    v_max_f32_e64 v66, s70, v66
    v_pk_fma_f32 v[74:75], v[74:75], v[58:59], s[70:71] op_sel:[0,0,0] op_sel_hi:[1,1,0] neg_lo:[0,1,0] neg_hi:[0,1,0]
    v_max_f32_e64 v67, s70, v67
    v_pk_fma_f32 v[66:67], v[66:67], s[70:71], v[46:47] op_sel:[0,1,0] op_sel_hi:[1,1,1]
    v_exp_f32 v44, v68 clamp
    v_mfma_f32_16x16x32_bf16 v[168:171], a[88:91], a[0:3], 0
    ds_read_b64_tr_b16 a[80:81], v20 offset:20480
    ds_read_b64_tr_b16 a[82:83], v20 offset:20992
    v_mfma_f32_16x16x32_bf16 v[184:187], a[88:91], a[4:7], 0
    buffer_load_dwordx4 v5, s[28:31], s5 offen offset:3072 lds
    ds_read_b64_tr_b16 a[172:173], v33 offset:49152
    ds_read_b64_tr_b16 a[174:175], v33 offset:51200
    v_exp_f32 v45, v69 clamp
    v_max_f32 v68, s70, v68
    v_max_f32 v69, s70, v69
    v_pk_fma_f32 v[68:69], v[68:69], s[70:71], v[44:45] op_sel:[0,1,0] op_sel_hi:[1,1,1]
    v_pk_fma_f32 v[76:77], v[76:77], v[60:61], s[70:71] op_sel:[0,0,0] op_sel_hi:[1,1,0] neg_lo:[0,1,0] neg_hi:[0,1,0]
    v_mfma_f32_16x16x32_bf16 v[172:175], a[92:95], a[0:3], 0
    ds_read_b64_tr_b16 a[84:85], v21 offset:20480
    ds_read_b64_tr_b16 a[86:87], v21 offset:20992
    v_mfma_f32_16x16x32_bf16 v[188:191], a[92:95], a[4:7], 0
    s_waitcnt lgkmcnt(12)
    v_cvt_pk_bf16_f32 v64, v64, v65
    v_exp_f32 v46, v70 clamp
    v_exp_f32 v47, v71 clamp
    v_max_f32 v70, s70, v70
    v_max_f32_e64 v71, s70, v71
    v_pk_fma_f32 v[70:71], v[70:71], s[70:71], v[46:47] op_sel:[0,1,0] op_sel_hi:[1,1,1]
    v_pk_fma_f32 v[78:79], v[78:79], v[62:63], s[70:71] op_sel:[0,0,0] op_sel_hi:[1,1,0] neg_lo:[0,1,0] neg_hi:[0,1,0]
    v_cvt_pk_bf16_f32 v65, v66, v67
    v_mfma_f32_16x16x32_bf16 v[128:131], a[64:67], a[8:11], v[128:131]
    s_waitcnt lgkmcnt(2) vmcnt(8)
    ds_read_b64_tr_b16 a[88:89], v24 offset:20480
    ds_read_b64_tr_b16 a[90:91], v24 offset:20992
    v_mfma_f32_16x16x32_bf16 v[144:147], a[64:67], a[12:15], v[144:147]
    s_nop 0
    ds_read_b64_tr_b16 a[176:177], v30 offset:57344
    ds_read_b64_tr_b16 a[178:179], v30 offset:59392
    v_exp_f32 v44, v72 clamp
    v_exp_f32 v45, v73 clamp
    v_max_f32 v72, s70, v72
    v_max_f32 v73, s70, v73
    v_pk_fma_f32 v[72:73], v[72:73], s[70:71], v[44:45] op_sel:[0,1,0] op_sel_hi:[1,1,1]
    v_cvt_pk_bf16_f32 v66, v68, v69
    v_mfma_f32_16x16x32_bf16 v[132:135], a[68:71], a[8:11], v[132:135]
    s_lshl3_add_u32 s62, s14, s62
    ds_read_b64_tr_b16 a[92:93], v25 offset:20480
    ds_read_b64_tr_b16 a[94:95], v25 offset:20992
    v_mfma_f32_16x16x32_bf16 v[148:151], a[68:71], a[12:15], v[148:151]
    s_nop 0
    ds_read_b64_tr_b16 a[180:181], v31 offset:57344
    ds_read_b64_tr_b16 a[182:183], v31 offset:59392
    v_exp_f32 v46, v74 clamp
    v_exp_f32 v47, v75 clamp
    v_max_f32 v74, s70, v74
    v_max_f32 v75, s70, v75
    v_pk_fma_f32 v[74:75], v[74:75], s[70:71], v[46:47] op_sel:[0,1,0] op_sel_hi:[1,1,1]
    v_cvt_pk_bf16_f32 v67, v70, v71
    v_mfma_f32_16x16x32_bf16 v[136:139], a[72:75], a[8:11], v[136:139]
    s_add_u32 m0, s60, 49152
    ds_read_b64_tr_b16 a[64:65], v18 offset:24576
    ds_read_b64_tr_b16 a[66:67], v18 offset:25088
    v_mfma_f32_16x16x32_bf16 v[152:155], a[72:75], a[12:15], v[152:155]
    s_waitcnt lgkmcnt(10)
    buffer_load_dwordx4 v14, s[44:47], s62 offen offset:0 lds
    ds_read_b64_tr_b16 a[184:185], v32 offset:57344
    ds_read_b64_tr_b16 a[186:187], v32 offset:59392
    v_exp_f32 v44, v76 clamp
    v_pk_mul_f32 v[80:81], v[56:57], v[80:81]
    v_pk_mul_f32 v[82:83], v[58:59], v[82:83]
    v_pk_mul_f32 v[84:85], v[60:61], v[84:85]
    v_pk_mul_f32 v[86:87], v[62:63], v[86:87]
    v_mfma_f32_16x16x32_bf16 v[140:143], a[76:79], a[8:11], v[140:143]
    s_nop 0
    ds_read_b64_tr_b16 a[68:69], v19 offset:24576
    ds_read_b64_tr_b16 a[70:71], v19 offset:25088
    v_mfma_f32_16x16x32_bf16 v[156:159], a[76:79], a[12:15], v[156:159]
    buffer_load_dwordx4 v15, s[44:47], s62 offen offset:1024 lds
    ds_read_b64_tr_b16 a[188:189], v33 offset:57344
    ds_read_b64_tr_b16 a[190:191], v33 offset:59392
    v_exp_f32 v45, v77 clamp
    v_max_f32 v76, s70, v76
    v_max_f32 v77, s70, v77
    v_pk_fma_f32 v[76:77], v[76:77], s[70:71], v[44:45] op_sel:[0,1,0] op_sel_hi:[1,1,1]
    v_pk_mul_f32 v[88:89], v[56:57], v[88:89]
    v_mfma_f32_16x16x32_bf16 v[160:163], a[80:83], a[8:11], v[160:163]
    ds_read_b64_tr_b16 a[72:73], v22 offset:24576
    ds_read_b64_tr_b16 a[74:75], v22 offset:25088
    v_mfma_f32_16x16x32_bf16 v[176:179], a[80:83], a[12:15], v[176:179]
    buffer_load_dwordx4 v16, s[44:47], s62 offen offset:2048 lds
    v_cvt_pk_bf16_f32 v68, v72, v73
    v_exp_f32 v46, v78 clamp
    v_pk_mul_f32 v[90:91], v[58:59], v[90:91]
    v_pk_mul_f32 v[92:93], v[60:61], v[92:93]
    v_pk_mul_f32 v[94:95], v[62:63], v[94:95]
    v_exp_f32 v47, v79 clamp
    v_mfma_f32_16x16x32_bf16 v[164:167], a[84:87], a[8:11], v[164:167]
    ds_read_b64_tr_b16 a[76:77], v23 offset:24576
    ds_read_b64_tr_b16 a[78:79], v23 offset:25088
    v_mfma_f32_16x16x32_bf16 v[180:183], a[84:87], a[12:15], v[180:183]
    s_waitcnt lgkmcnt(10)
    buffer_load_dwordx4 v17, s[44:47], s62 offen offset:3072 lds
    v_max_f32 v78, s70, v78
    v_max_f32_e64 v79, s70, v79
    v_cvt_pk_bf16_f32 v69, v74, v75
    v_pk_fma_f32 v[78:79], v[78:79], s[70:71], v[46:47] op_sel:[0,1,0] op_sel_hi:[1,1,1]
    v_pk_fma_f32 v[96:97], v[96:97], v[56:57], s[70:71] op_sel:[0,0,0] op_sel_hi:[1,1,0] neg_lo:[0,1,0] neg_hi:[0,1,0]
    v_pk_fma_f32 v[98:99], v[98:99], v[58:59], s[70:71] op_sel:[0,0,0] op_sel_hi:[1,1,0] neg_lo:[0,1,0] neg_hi:[0,1,0]
    v_cvt_pk_bf16_f32 v70, v76, v77
    v_pk_fma_f32 v[100:101], v[100:101], v[60:61], s[70:71] op_sel:[0,0,0] op_sel_hi:[1,1,0] neg_lo:[0,1,0] neg_hi:[0,1,0]
    v_mfma_f32_16x16x32_bf16 v[168:171], a[88:91], a[8:11], v[168:171]
    ds_read_b64_tr_b16 a[80:81], v20 offset:24576
    ds_read_b64_tr_b16 a[82:83], v20 offset:25088
    v_mfma_f32_16x16x32_bf16 v[184:187], a[88:91], a[12:15], v[184:187]
    s_waitcnt lgkmcnt(6)
    v_cvt_pk_bf16_f32 v71, v78, v79
    v_cvt_pk_bf16_f32 v80, v80, v81
    v_cvt_pk_bf16_f32 v81, v82, v83
    v_cvt_pk_bf16_f32 v82, v84, v85
    v_cvt_pk_bf16_f32 v83, v86, v87
    v_pk_fma_f32 v[102:103], v[102:103], v[62:63], s[70:71] op_sel:[0,0,0] op_sel_hi:[1,1,0] neg_lo:[0,1,0] neg_hi:[0,1,0]
    v_cvt_pk_bf16_f32 v84, v88, v89
    v_cvt_pk_bf16_f32 v85, v90, v91
    v_cvt_pk_bf16_f32 v86, v92, v93
    v_cvt_pk_bf16_f32 v87, v94, v95
    v_mfma_f32_16x16x32_bf16 v[172:175], a[92:95], a[8:11], v[172:175]
    s_lshl3_add_u32 s62, s13, s62
    ds_read_b64_tr_b16 a[84:85], v21 offset:24576
    ds_read_b64_tr_b16 a[86:87], v21 offset:25088
    v_mfma_f32_16x16x32_bf16 v[188:191], a[92:95], a[12:15], v[188:191]
    v_exp_f32 v44, v96 clamp
    v_exp_f32 v45, v97 clamp
    v_max_f32_e64 v96, s70, v96
    v_pk_fma_f32 v[104:105], v[104:105], v[56:57], s[70:71] op_sel:[0,0,0] op_sel_hi:[1,1,0] neg_lo:[0,1,0] neg_hi:[0,1,0]
    v_max_f32_e64 v97, s70, v97
    v_pk_fma_f32 v[96:97], v[96:97], s[70:71], v[44:45] op_sel:[0,1,0] op_sel_hi:[1,1,1]
    v_exp_f32 v46, v98 clamp
    v_mfma_f32_16x16x32_bf16 v[128:131], a[64:67], a[16:19], v[128:131]
    s_add_u32 m0, s60, 57344
    ds_read_b64_tr_b16 a[88:89], v24 offset:24576
    ds_read_b64_tr_b16 a[90:91], v24 offset:25088
    v_mfma_f32_16x16x32_bf16 v[144:147], a[64:67], a[20:23], v[144:147]
    s_waitcnt lgkmcnt(6)
    buffer_load_dwordx4 v14, s[44:47], s62 offen offset:0 lds
    v_exp_f32 v47, v99 clamp
    v_max_f32 v98, s70, v98
    v_pk_fma_f32 v[106:107], v[106:107], v[58:59], s[70:71] op_sel:[0,0,0] op_sel_hi:[1,1,0] neg_lo:[0,1,0] neg_hi:[0,1,0]
    v_max_f32_e64 v99, s70, v99
    v_pk_fma_f32 v[98:99], v[98:99], s[70:71], v[46:47] op_sel:[0,1,0] op_sel_hi:[1,1,1]
    v_exp_f32 v44, v100 clamp
    v_mfma_f32_16x16x32_bf16 v[132:135], a[68:71], a[16:19], v[132:135]
    ds_read_b64_tr_b16 a[92:93], v25 offset:24576
    ds_read_b64_tr_b16 a[94:95], v25 offset:25088
    v_mfma_f32_16x16x32_bf16 v[148:151], a[68:71], a[20:23], v[148:151]
    buffer_load_dwordx4 v15, s[44:47], s62 offen offset:1024 lds
    v_exp_f32 v45, v101 clamp
    v_max_f32 v100, s70, v100
    v_max_f32 v101, s70, v101
    v_pk_fma_f32 v[100:101], v[100:101], s[70:71], v[44:45] op_sel:[0,1,0] op_sel_hi:[1,1,1]
    v_pk_fma_f32 v[108:109], v[108:109], v[60:61], s[70:71] op_sel:[0,0,0] op_sel_hi:[1,1,0] neg_lo:[0,1,0] neg_hi:[0,1,0]
    v_cvt_pk_bf16_f32 v96, v96, v97
    v_cvt_pk_bf16_f32 v97, v98, v99
    v_mfma_f32_16x16x32_bf16 v[136:139], a[72:75], a[16:19], v[136:139]
    ds_read_b64_tr_b16 a[64:65], v18 offset:28672
    ds_read_b64_tr_b16 a[66:67], v18 offset:29184
    v_mfma_f32_16x16x32_bf16 v[152:155], a[72:75], a[20:23], v[152:155]
    buffer_load_dwordx4 v16, s[44:47], s62 offen offset:2048 lds
    v_exp_f32 v46, v102 clamp
    v_exp_f32 v47, v103 clamp
    v_max_f32_e64 v102, s70, v102
    v_pk_fma_f32 v[110:111], v[110:111], v[62:63], s[70:71] op_sel:[0,0,0] op_sel_hi:[1,1,0] neg_lo:[0,1,0] neg_hi:[0,1,0]
    v_max_f32_e64 v103, s70, v103
    v_pk_fma_f32 v[102:103], v[102:103], s[70:71], v[46:47] op_sel:[0,1,0] op_sel_hi:[1,1,1]
    v_mfma_f32_16x16x32_bf16 v[140:143], a[76:79], a[16:19], v[140:143]
    ds_read_b64_tr_b16 a[68:69], v19 offset:28672
    ds_read_b64_tr_b16 a[70:71], v19 offset:29184
    v_mfma_f32_16x16x32_bf16 v[156:159], a[76:79], a[20:23], v[156:159]
    s_waitcnt lgkmcnt(6)
    buffer_load_dwordx4 v17, s[44:47], s62 offen offset:3072 lds
    v_exp_f32 v44, v104 clamp
    v_exp_f32 v45, v105 clamp
    v_max_f32 v104, s70, v104
    v_max_f32_e64 v105, s70, v105
    v_pk_fma_f32 v[104:105], v[104:105], s[70:71], v[44:45] op_sel:[0,1,0] op_sel_hi:[1,1,1]
    v_cvt_pk_bf16_f32 v98, v100, v101
    v_mfma_f32_16x16x32_bf16 v[160:163], a[80:83], a[16:19], v[160:163]
    ds_read_b64_tr_b16 a[72:73], v22 offset:28672
    ds_read_b64_tr_b16 a[74:75], v22 offset:29184
    v_mfma_f32_16x16x32_bf16 v[176:179], a[80:83], a[20:23], v[176:179]
    v_exp_f32 v46, v106 clamp
    v_exp_f32 v47, v107 clamp
    v_max_f32 v106, s70, v106
    v_max_f32 v107, s70, v107
    v_pk_fma_f32 v[106:107], v[106:107], s[70:71], v[46:47] op_sel:[0,1,0] op_sel_hi:[1,1,1]
    v_cvt_pk_bf16_f32 v99, v102, v103
    v_exp_f32 v44, v108 clamp
    v_mfma_f32_16x16x32_bf16 v[164:167], a[84:87], a[16:19], v[164:167]
    ds_read_b64_tr_b16 a[76:77], v23 offset:28672
    ds_read_b64_tr_b16 a[78:79], v23 offset:29184
    v_mfma_f32_16x16x32_bf16 v[180:183], a[84:87], a[20:23], v[180:183]
    v_exp_f32 v45, v109 clamp
    v_max_f32 v108, s70, v108
    v_max_f32 v109, s70, v109
    v_cvt_pk_bf16_f32 v100, v104, v105
    v_pk_fma_f32 v[108:109], v[108:109], s[70:71], v[44:45] op_sel:[0,1,0] op_sel_hi:[1,1,1]
    v_exp_f32 v46, v110 clamp
    v_exp_f32 v47, v111 clamp
    v_mfma_f32_16x16x32_bf16 v[168:171], a[88:91], a[16:19], v[168:171]
    ds_read_b64_tr_b16 a[80:81], v20 offset:28672
    ds_read_b64_tr_b16 a[82:83], v20 offset:29184
    v_mfma_f32_16x16x32_bf16 v[184:187], a[88:91], a[20:23], v[184:187]
    s_waitcnt lgkmcnt(6)
    v_max_f32 v110, s70, v110
    v_max_f32_e64 v111, s70, v111
    v_cvt_pk_bf16_f32 v101, v106, v107
    v_cvt_pk_bf16_f32 v102, v108, v109
    v_pk_fma_f32 v[110:111], v[110:111], s[70:71], v[46:47] op_sel:[0,1,0] op_sel_hi:[1,1,1]
    v_cvt_pk_bf16_f32 v103, v110, v111
    s_nop 0
    v_pk_mul_f32 v[112:113], v[56:57], v[112:113]
    v_pk_mul_f32 v[114:115], v[58:59], v[114:115]
    v_mfma_f32_16x16x32_bf16 v[172:175], a[92:95], a[16:19], v[172:175]
    s_waitcnt vmcnt(4)
    ds_read_b64_tr_b16 a[84:85], v21 offset:28672
    ds_read_b64_tr_b16 a[86:87], v21 offset:29184
    v_mfma_f32_16x16x32_bf16 v[188:191], a[92:95], a[20:23], v[188:191]
L_padB3:
    s_cbranch_execz L_padret
    ds_read_b64_tr_b16 a[192:193], v30 offset:49152
    ds_read_b64_tr_b16 a[194:195], v30 offset:51200
    v_cvt_pk_bf16_f32 v112, v112, v113
    v_cvt_pk_bf16_f32 v113, v114, v115
    v_pk_mul_f32 v[116:117], v[60:61], v[116:117]
    v_pk_mul_f32 v[118:119], v[62:63], v[118:119]
    v_pk_mul_f32 v[120:121], v[56:57], v[120:121]
    v_pk_mul_f32 v[122:123], v[58:59], v[122:123]
    v_pk_mul_f32 v[124:125], v[60:61], v[124:125]
    v_mfma_f32_16x16x32_bf16 v[128:131], a[64:67], a[24:27], v[128:131]
    s_nop 0
    ds_read_b64_tr_b16 a[88:89], v24 offset:28672
    ds_read_b64_tr_b16 a[90:91], v24 offset:29184
    v_mfma_f32_16x16x32_bf16 v[144:147], a[64:67], a[28:31], v[144:147]
    ds_write_b128 v52, v[64:67] offset:0
    ds_write_b128 v52, v[68:71] offset:2048
    v_pk_mul_f32 v[126:127], v[62:63], v[126:127]
    v_cvt_pk_bf16_f32 v114, v116, v117
    v_cvt_pk_bf16_f32 v115, v118, v119
    v_cvt_pk_bf16_f32 v116, v120, v121
    v_cvt_pk_bf16_f32 v117, v122, v123
    v_cvt_pk_bf16_f32 v118, v124, v125
    v_mfma_f32_16x16x32_bf16 v[132:135], a[68:71], a[24:27], v[132:135]
    ds_read_b64_tr_b16 a[92:93], v25 offset:28672
    ds_read_b64_tr_b16 a[94:95], v25 offset:29184
    v_mfma_f32_16x16x32_bf16 v[148:151], a[68:71], a[28:31], v[148:151]
    s_waitcnt lgkmcnt(10)
    ds_write_b128 v52, v[80:83] offset:1024
    ds_write_b128 v52, v[84:87] offset:3072
    v_cvt_pk_bf16_f32 v119, v126, v127
    v_mov_b32 v48, 0x3f803f80
    v_mov_b32 v49, 0x3f803f80
    v_mov_b32 v50, 0x3f803f80
    v_mov_b32 v51, 0x3f803f80
    v_mfma_f32_16x16x32_bf16 v[136:139], a[72:75], a[24:27], v[136:139]
    s_barrier
    ds_read_b64_tr_b16 a[64:65], v18 offset:32768
    ds_read_b64_tr_b16 a[66:67], v18 offset:33280
    v_mfma_f32_16x16x32_bf16 v[152:155], a[72:75], a[28:31], v[152:155]
    ds_write_b128 v52, v[96:99] offset:4096
    ds_write_b128 v52, v[100:103] offset:6144
    s_add_u32 s4, s4, 1
    s_and_b32 s4, s4, 7
    s_mul_i32 s5, s4, 229376
    s_add_u32 m0, s60, 8192
    v_mfma_f32_16x16x32_bf16 v[140:143], a[76:79], a[24:27], v[140:143]
    ds_read_b64_tr_b16 a[68:69], v19 offset:32768
    ds_read_b64_tr_b16 a[70:71], v19 offset:33280
    v_mfma_f32_16x16x32_bf16 v[156:159], a[76:79], a[28:31], v[156:159]
    ds_write_b128 v52, v[112:115] offset:5120
    ds_write_b128 v52, v[116:119] offset:7168
    v_mfma_f32_16x16x32_bf16 v[160:163], a[80:83], a[24:27], v[160:163]
    ds_read_b64_tr_b16 a[72:73], v22 offset:32768
    ds_read_b64_tr_b16 a[74:75], v22 offset:33280
    v_mfma_f32_16x16x32_bf16 v[176:179], a[80:83], a[28:31], v[176:179]
    s_waitcnt lgkmcnt(12)
    buffer_load_dwordx4 v2, s[28:31], s5 offen offset:0 lds
    ds_read_b64_tr_b16 a[196:197], v31 offset:49152
    ds_read_b64_tr_b16 a[198:199], v31 offset:51200
    v_mfma_f32_16x16x32_bf16 v[164:167], a[84:87], a[24:27], v[164:167]
    s_waitcnt lgkmcnt(4)
    ds_read_b64_tr_b16 a[76:77], v23 offset:32768
    ds_read_b64_tr_b16 a[78:79], v23 offset:33280
    v_mfma_f32_16x16x32_bf16 v[180:183], a[84:87], a[28:31], v[180:183]
    buffer_load_dwordx4 v3, s[28:31], s5 offen offset:1024 lds
    ds_read_b64_tr_b16 a[200:201], v32 offset:49152
    ds_read_b64_tr_b16 a[202:203], v32 offset:51200
    s_barrier
    v_mfma_f32_16x16x32_bf16 v[168:171], a[88:91], a[24:27], v[168:171]
    s_nop 0
    ds_read_b64_tr_b16 a[80:81], v20 offset:32768
    ds_read_b64_tr_b16 a[82:83], v20 offset:33280
    v_mfma_f32_16x16x32_bf16 v[184:187], a[88:91], a[28:31], v[184:187]
    buffer_load_dwordx4 v4, s[28:31], s5 offen offset:2048 lds
    ds_read_b128 v[64:67], v53 offset:0
    ds_read_b128 v[68:71], v53 offset:1024
    v_mfma_f32_16x16x32_bf16 v[172:175], a[92:95], a[24:27], v[172:175]
    ds_read_b64_tr_b16 a[84:85], v21 offset:32768
    ds_read_b64_tr_b16 a[86:87], v21 offset:33280
    v_mfma_f32_16x16x32_bf16 v[188:191], a[92:95], a[28:31], v[188:191]
    s_waitcnt lgkmcnt(12)
    buffer_load_dwordx4 v5, s[28:31], s5 offen offset:3072 lds
    ds_read_b128 v[72:75], v53 offset:8192
    ds_read_b128 v[76:79], v53 offset:9216
    s_add_u32 s4, s4, 1
    s_and_b32 s4, s4, 7
    s_mul_i32 s5, s4, 229376
    s_add_u32 m0, s60, 16384
    v_mfma_f32_16x16x32_bf16 v[128:131], a[64:67], a[32:35], v[128:131]
    s_nop 0
    ds_read_b64_tr_b16 a[88:89], v24 offset:32768
    ds_read_b64_tr_b16 a[90:91], v24 offset:33280
    v_mfma_f32_16x16x32_bf16 v[144:147], a[64:67], a[36:39], v[144:147]
    buffer_load_dwordx4 v2, s[28:31], s5 offen offset:0 lds
    ds_read_b128 v[80:83], v53 offset:16384
    ds_read_b128 v[84:87], v53 offset:17408
    v_mfma_f32_16x16x32_bf16 v[132:135], a[68:71], a[32:35], v[132:135]
    ds_read_b64_tr_b16 a[92:93], v25 offset:32768
    ds_read_b64_tr_b16 a[94:95], v25 offset:33280
    v_mfma_f32_16x16x32_bf16 v[148:151], a[68:71], a[36:39], v[148:151]
    buffer_load_dwordx4 v3, s[28:31], s5 offen offset:1024 lds
    ds_read_b128 v[88:91], v53 offset:24576
    ds_read_b128 v[92:95], v53 offset:25600
    v_mfma_f32_16x16x32_bf16 v[136:139], a[72:75], a[32:35], v[136:139]
    ds_read_b64_tr_b16 a[64:65], v18 offset:36864
    ds_read_b64_tr_b16 a[66:67], v18 offset:37376
    v_mfma_f32_16x16x32_bf16 v[152:155], a[72:75], a[36:39], v[152:155]
    s_waitcnt lgkmcnt(12)
    buffer_load_dwordx4 v4, s[28:31], s5 offen offset:2048 lds
    ds_read_b64_tr_b16 a[204:205], v33 offset:49152
    ds_read_b64_tr_b16 a[206:207], v33 offset:51200
    v_mfma_f32_16x16x32_bf16 v[140:143], a[76:79], a[32:35], v[140:143]
    s_waitcnt vmcnt(7)
    ds_read_b64_tr_b16 a[68:69], v19 offset:36864
    ds_read_b64_tr_b16 a[70:71], v19 offset:37376
    v_mfma_f32_16x16x32_bf16 v[156:159], a[76:79], a[36:39], v[156:159]
    ds_read_b64_tr_b16 a[208:209], v30 offset:57344
    ds_read_b64_tr_b16 a[210:211], v30 offset:59392
    v_mfma_f32_16x16x32_bf16 v[160:163], a[80:83], a[32:35], v[160:163]
    ds_read_b64_tr_b16 a[72:73], v22 offset:36864
    ds_read_b64_tr_b16 a[74:75], v22 offset:37376
    v_mfma_f32_16x16x32_bf16 v[176:179], a[80:83], a[36:39], v[176:179]
    buffer_load_dwordx4 v5, s[28:31], s5 offen offset:3072 lds
    ds_read_b64_tr_b16 a[212:213], v31 offset:57344
    ds_read_b64_tr_b16 a[214:215], v31 offset:59392
    s_waitcnt lgkmcnt(12)
    v_mfma_f32_16x16x32_bf16 v[96:99], v[64:67], v[68:71], 0
    v_mfma_f32_16x16x32_bf16 v[100:103], v[64:67], v[48:51], 0
    v_mfma_f32_16x16x32_bf16 v[96:99], v[72:75], v[76:79], v[96:99]
    v_mfma_f32_16x16x32_bf16 v[100:103], v[72:75], v[48:51], v[100:103]
    v_mfma_f32_16x16x32_bf16 v[96:99], v[80:83], v[84:87], v[96:99]
    v_mfma_f32_16x16x32_bf16 v[100:103], v[80:83], v[48:51], v[100:103]
    v_mfma_f32_16x16x32_bf16 v[96:99], v[88:91], v[92:95], v[96:99]
    v_mfma_f32_16x16x32_bf16 v[100:103], v[88:91], v[48:51], v[100:103]
    v_mfma_f32_16x16x32_bf16 v[164:167], a[84:87], a[32:35], v[164:167]
    s_nop 0
    ds_read_b64_tr_b16 a[76:77], v23 offset:36864
    ds_read_b64_tr_b16 a[78:79], v23 offset:37376
    v_mfma_f32_16x16x32_bf16 v[180:183], a[84:87], a[36:39], v[180:183]
    s_waitcnt lgkmcnt(10)
    ds_read_b64_tr_b16 a[216:217], v32 offset:57344
    ds_read_b64_tr_b16 a[218:219], v32 offset:59392
    v_cvt_pk_bf16_f32 v104, v96, v97
    v_cvt_pk_bf16_f32 v105, v98, v99
    v_cvt_pk_bf16_f32 v106, v100, v101
    v_cvt_pk_bf16_f32 v107, v102, v103
    s_lshl3_add_u32 s62, s16, s62
    s_add_u32 m0, s60, 49152
    v_mfma_f32_16x16x32_bf16 v[168:171], a[88:91], a[32:35], v[168:171]
    ds_read_b64_tr_b16 a[80:81], v20 offset:36864
    ds_read_b64_tr_b16 a[82:83], v20 offset:37376
    buffer_store_dwordx2 v[104:105], v39, s[36:39], s76 offen offset:512 sc1
    buffer_store_dwordx2 v[106:107], v40, s[36:39], s76 offen offset:0 sc1
    v_mfma_f32_16x16x32_bf16 v[184:187], a[88:91], a[36:39], v[184:187]
    buffer_load_dwordx4 v14, s[44:47], s62 offen offset:0 lds
    v_mfma_f32_16x16x32_bf16 v[172:175], a[92:95], a[32:35], v[172:175]
    s_sub_u32 s73, s99, s60
    ds_read_b64_tr_b16 a[84:85], v21 offset:36864
    ds_read_b64_tr_b16 a[86:87], v21 offset:37376
    v_mfma_f32_16x16x32_bf16 v[188:191], a[92:95], a[36:39], v[188:191]
    buffer_load_dwordx4 v15, s[44:47], s62 offen offset:1024 lds
    v_mfma_f32_16x16x32_bf16 v[128:131], a[64:67], a[40:43], v[128:131]
    s_nop 0
    ds_read_b64_tr_b16 a[88:89], v24 offset:36864
    ds_read_b64_tr_b16 a[90:91], v24 offset:37376
    v_mfma_f32_16x16x32_bf16 v[144:147], a[64:67], a[44:47], v[144:147]
    s_waitcnt lgkmcnt(8)
    ds_read_b64_tr_b16 a[220:221], v33 offset:57344
    ds_read_b64_tr_b16 a[222:223], v33 offset:59392
    v_mfma_f32_16x16x32_bf16 v[132:135], a[68:71], a[40:43], v[132:135]
    s_nop 0
    ds_read_b64_tr_b16 a[92:93], v25 offset:36864
    ds_read_b64_tr_b16 a[94:95], v25 offset:37376
    v_mfma_f32_16x16x32_bf16 v[148:151], a[68:71], a[44:47], v[148:151]
    buffer_load_dwordx4 v16, s[44:47], s62 offen offset:2048 lds
    v_mfma_f32_16x16x32_bf16 v[136:139], a[72:75], a[40:43], v[136:139]
    ds_read_b64_tr_b16 a[64:65], v18 offset:40960
    ds_read_b64_tr_b16 a[66:67], v18 offset:41472
    v_mfma_f32_16x16x32_bf16 v[152:155], a[72:75], a[44:47], v[152:155]
    v_add_u32 v48, s73, v30
    v_add_u32 v49, s73, v31
    v_mfma_f32_16x16x32_bf16 v[140:143], a[76:79], a[40:43], v[140:143]
    ds_read_b64_tr_b16 a[68:69], v19 offset:40960
    ds_read_b64_tr_b16 a[70:71], v19 offset:41472
    v_mfma_f32_16x16x32_bf16 v[156:159], a[76:79], a[44:47], v[156:159]
    s_waitcnt lgkmcnt(8)
    buffer_load_dwordx4 v17, s[44:47], s62 offen offset:3072 lds
    v_mfma_f32_16x16x32_bf16 v[160:163], a[80:83], a[40:43], v[160:163]
    s_nop 0
    ds_read_b64_tr_b16 a[72:73], v22 offset:40960
    ds_read_b64_tr_b16 a[74:75], v22 offset:41472
    v_mfma_f32_16x16x32_bf16 v[176:179], a[80:83], a[44:47], v[176:179]
    s_waitcnt lgkmcnt(8)
    v_add_u32 v50, s73, v32
    v_add_u32_e64 v51, s73, v33
    v_mfma_f32_16x16x32_bf16 v[164:167], a[84:87], a[40:43], v[164:167]
    s_lshl3_add_u32 s62, s12, s62
    ds_read_b64_tr_b16 a[76:77], v23 offset:40960
    ds_read_b64_tr_b16 a[78:79], v23 offset:41472
    v_mfma_f32_16x16x32_bf16 v[180:183], a[84:87], a[44:47], v[180:183]
    s_add_u32 m0, s60, 57344
    v_mfma_f32_16x16x32_bf16 v[168:171], a[88:91], a[40:43], v[168:171]
    s_nop 0
    ds_read_b64_tr_b16 a[80:81], v20 offset:40960
    ds_read_b64_tr_b16 a[82:83], v20 offset:41472
    v_mfma_f32_16x16x32_bf16 v[184:187], a[88:91], a[44:47], v[184:187]
    s_waitcnt lgkmcnt(6)
    buffer_load_dwordx4 v14, s[44:47], s62 offen offset:0 lds
    v_mfma_f32_16x16x32_bf16 v[172:175], a[92:95], a[40:43], v[172:175]
    s_nop 0
    ds_read_b64_tr_b16 a[84:85], v21 offset:40960
    ds_read_b64_tr_b16 a[86:87], v21 offset:41472
    v_mfma_f32_16x16x32_bf16 v[188:191], a[92:95], a[44:47], v[188:191]
    v_mfma_f32_16x16x32_bf16 v[128:131], a[64:67], a[48:51], v[128:131]
    ds_read_b64_tr_b16 a[88:89], v24 offset:40960
    ds_read_b64_tr_b16 a[90:91], v24 offset:41472
    v_mfma_f32_16x16x32_bf16 v[144:147], a[64:67], a[52:55], v[144:147]
    buffer_load_dwordx4 v15, s[44:47], s62 offen offset:1024 lds
    v_mfma_f32_16x16x32_bf16 v[132:135], a[68:71], a[48:51], v[132:135]
    ds_read_b64_tr_b16 a[92:93], v25 offset:40960
    ds_read_b64_tr_b16 a[94:95], v25 offset:41472
    v_mfma_f32_16x16x32_bf16 v[148:151], a[68:71], a[52:55], v[148:151]
    s_waitcnt lgkmcnt(6)
    v_mfma_f32_16x16x32_bf16 v[136:139], a[72:75], a[48:51], v[136:139]
    s_nop 0
    ds_read_b64_tr_b16 a[64:65], v18 offset:45056
    ds_read_b64_tr_b16 a[66:67], v18 offset:45568
    v_mfma_f32_16x16x32_bf16 v[152:155], a[72:75], a[52:55], v[152:155]
    v_mfma_f32_16x16x32_bf16 v[140:143], a[76:79], a[48:51], v[140:143]
    ds_read_b64_tr_b16 a[68:69], v19 offset:45056
    ds_read_b64_tr_b16 a[70:71], v19 offset:45568
    v_mfma_f32_16x16x32_bf16 v[156:159], a[76:79], a[52:55], v[156:159]
    buffer_load_dwordx4 v16, s[44:47], s62 offen offset:2048 lds
    v_mfma_f32_16x16x32_bf16 v[160:163], a[80:83], a[48:51], v[160:163]
    ds_read_b64_tr_b16 a[72:73], v22 offset:45056
    ds_read_b64_tr_b16 a[74:75], v22 offset:45568
    v_mfma_f32_16x16x32_bf16 v[176:179], a[80:83], a[52:55], v[176:179]
    s_waitcnt lgkmcnt(6)
    v_mfma_f32_16x16x32_bf16 v[164:167], a[84:87], a[48:51], v[164:167]
    s_nop 0
    ds_read_b64_tr_b16 a[76:77], v23 offset:45056
    ds_read_b64_tr_b16 a[78:79], v23 offset:45568
    v_mfma_f32_16x16x32_bf16 v[180:183], a[84:87], a[52:55], v[180:183]
    buffer_load_dwordx4 v17, s[44:47], s62 offen offset:3072 lds
    v_mfma_f32_16x16x32_bf16 v[168:171], a[88:91], a[48:51], v[168:171]
    ds_read_b64_tr_b16 a[80:81], v20 offset:45056
    ds_read_b64_tr_b16 a[82:83], v20 offset:45568
    v_mfma_f32_16x16x32_bf16 v[184:187], a[88:91], a[52:55], v[184:187]
    v_mfma_f32_16x16x32_bf16 v[172:175], a[92:95], a[48:51], v[172:175]
    ds_read_b64_tr_b16 a[84:85], v21 offset:45056
    ds_read_b64_tr_b16 a[86:87], v21 offset:45568
    v_mfma_f32_16x16x32_bf16 v[188:191], a[92:95], a[52:55], v[188:191]
    s_waitcnt lgkmcnt(6)
    v_mfma_f32_16x16x32_bf16 v[128:131], a[64:67], a[56:59], v[128:131]
    s_nop 0
    ds_read_b64_tr_b16 a[88:89], v24 offset:45056
    ds_read_b64_tr_b16 a[90:91], v24 offset:45568
    v_mfma_f32_16x16x32_bf16 v[144:147], a[64:67], a[60:63], v[144:147]
    v_mfma_f32_16x16x32_bf16 v[132:135], a[68:71], a[56:59], v[132:135]
    ds_read_b64_tr_b16 a[92:93], v25 offset:45056
    ds_read_b64_tr_b16 a[94:95], v25 offset:45568
    v_mfma_f32_16x16x32_bf16 v[148:151], a[68:71], a[60:63], v[148:151]
    s_waitcnt vmcnt(14)
    v_mfma_f32_16x16x32_bf16 v[136:139], a[72:75], a[56:59], v[136:139]
    s_barrier
    ds_read_b64_tr_b16 a[64:65], v18 offset:0
    ds_read_b64_tr_b16 a[66:67], v18 offset:512
    v_mfma_f32_16x16x32_bf16 v[152:155], a[72:75], a[60:63], v[152:155]
    s_waitcnt lgkmcnt(6)
    s_add_u32 s4, s4, 1
    s_and_b32 s4, s4, 7
    v_mfma_f32_16x16x32_bf16 v[140:143], a[76:79], a[56:59], v[140:143]
    s_mul_i32 s5, s4, 229376
    ds_read_b64_tr_b16 a[68:69], v19 offset:0
    ds_read_b64_tr_b16 a[70:71], v19 offset:512
    v_mfma_f32_16x16x32_bf16 v[156:159], a[76:79], a[60:63], v[156:159]
    s_add_u32 m0, s60, 24576
    v_mfma_f32_16x16x32_bf16 v[160:163], a[80:83], a[56:59], v[160:163]
    s_nop 0
    ds_read_b64_tr_b16 a[72:73], v22 offset:0
    ds_read_b64_tr_b16 a[74:75], v22 offset:512
    v_mfma_f32_16x16x32_bf16 v[176:179], a[80:83], a[60:63], v[176:179]
    buffer_load_dwordx4 v2, s[28:31], s5 offen offset:0 lds
    v_mfma_f32_16x16x32_bf16 v[164:167], a[84:87], a[56:59], v[164:167]
    ds_read_b64_tr_b16 a[76:77], v23 offset:0
    ds_read_b64_tr_b16 a[78:79], v23 offset:512
    v_mfma_f32_16x16x32_bf16 v[180:183], a[84:87], a[60:63], v[180:183]
    s_waitcnt lgkmcnt(6) vmcnt(9)
    s_add_u32 s72, s77, 0
    s_atomic_add s3, s[36:37], s72
    v_mfma_f32_16x16x32_bf16 v[168:171], a[88:91], a[56:59], v[168:171]
    ds_read_b64_tr_b16 a[80:81], v20 offset:0
    ds_read_b64_tr_b16 a[82:83], v20 offset:512
    v_mfma_f32_16x16x32_bf16 v[184:187], a[88:91], a[60:63], v[184:187]
    v_mfma_f32_16x16x32_bf16 v[172:175], a[92:95], a[56:59], v[172:175]
    ds_read_b64_tr_b16 a[84:85], v21 offset:0
    ds_read_b64_tr_b16 a[86:87], v21 offset:512
    v_mfma_f32_16x16x32_bf16 v[188:191], a[92:95], a[60:63], v[188:191]
    buffer_load_dwordx4 v3, s[28:31], s5 offen offset:1024 lds
    v_mfma_f32_16x16x32_bf16 v[128:131], a[64:67], v[192:195], v[128:131]
    ds_read_b64_tr_b16 a[88:89], v24 offset:0
    ds_read_b64_tr_b16 a[90:91], v24 offset:512
    v_mfma_f32_16x16x32_bf16 v[144:147], a[64:67], v[196:199], v[144:147]
    s_waitcnt lgkmcnt(6)
    v_mfma_f32_16x16x32_bf16 v[132:135], a[68:71], v[192:195], v[132:135]
    s_nop 0
    ds_read_b64_tr_b16 a[92:93], v25 offset:0
    ds_read_b64_tr_b16 a[94:95], v25 offset:512
    v_mfma_f32_16x16x32_bf16 v[148:151], a[68:71], v[196:199], v[148:151]
    buffer_load_dwordx4 v4, s[28:31], s5 offen offset:2048 lds
    v_mfma_f32_16x16x32_bf16 v[136:139], a[72:75], v[192:195], v[136:139]
    ds_read_b64_tr_b16 a[64:65], v18 offset:4096
    ds_read_b64_tr_b16 a[66:67], v18 offset:4608
    v_mfma_f32_16x16x32_bf16 v[152:155], a[72:75], v[196:199], v[152:155]
    v_mfma_f32_16x16x32_bf16 v[140:143], a[76:79], v[192:195], v[140:143]
    ds_read_b64_tr_b16 a[68:69], v19 offset:4096
    ds_read_b64_tr_b16 a[70:71], v19 offset:4608
    v_mfma_f32_16x16x32_bf16 v[156:159], a[76:79], v[196:199], v[156:159]
    s_waitcnt lgkmcnt(6)
    v_mfma_f32_16x16x32_bf16 v[160:163], a[80:83], v[192:195], v[160:163]
    s_nop 0
    ds_read_b64_tr_b16 a[72:73], v22 offset:4096
    ds_read_b64_tr_b16 a[74:75], v22 offset:4608
    v_mfma_f32_16x16x32_bf16 v[176:179], a[80:83], v[196:199], v[176:179]
    buffer_load_dwordx4 v5, s[28:31], s5 offen offset:3072 lds
    v_mfma_f32_16x16x32_bf16 v[164:167], a[84:87], v[192:195], v[164:167]
    s_add_u32 s4, s4, 1
    ds_read_b64_tr_b16 a[76:77], v23 offset:4096
    ds_read_b64_tr_b16 a[78:79], v23 offset:4608
    v_mfma_f32_16x16x32_bf16 v[180:183], a[84:87], v[196:199], v[180:183]
    s_and_b32 s4, s4, 7
    s_mul_i32 s5, s4, 229376
    v_mfma_f32_16x16x32_bf16 v[168:171], a[88:91], v[192:195], v[168:171]
    s_add_u32 m0, s60, 32768
    ds_read_b64_tr_b16 a[80:81], v20 offset:4096
    ds_read_b64_tr_b16 a[82:83], v20 offset:4608
    v_mfma_f32_16x16x32_bf16 v[184:187], a[88:91], v[196:199], v[184:187]
    s_waitcnt lgkmcnt(6) vmcnt(8)
    ds_read_b64_tr_b16 a[224:225], v30 offset:49152
    ds_read_b64_tr_b16 a[226:227], v30 offset:51200
    v_mfma_f32_16x16x32_bf16 v[172:175], a[92:95], v[192:195], v[172:175]
    s_nop 0
    ds_read_b64_tr_b16 a[84:85], v21 offset:4096
    ds_read_b64_tr_b16 a[86:87], v21 offset:4608
    v_mfma_f32_16x16x32_bf16 v[188:191], a[92:95], v[196:199], v[188:191]
    ds_read_b64_tr_b16 a[228:229], v31 offset:49152
    ds_read_b64_tr_b16 a[230:231], v31 offset:51200
    v_mfma_f32_16x16x32_bf16 v[128:131], a[64:67], v[200:203], v[128:131]
    ds_read_b64_tr_b16 a[88:89], v24 offset:4096
    ds_read_b64_tr_b16 a[90:91], v24 offset:4608
    v_mfma_f32_16x16x32_bf16 v[144:147], a[64:67], v[204:207], v[144:147]
    buffer_load_dwordx4 v10, s[28:31], s5 offen offset:0 lds
    v_mfma_f32_16x16x32_bf16 v[132:135], a[68:71], v[200:203], v[132:135]
    ds_read_b64_tr_b16 a[92:93], v25 offset:4096
    ds_read_b64_tr_b16 a[94:95], v25 offset:4608
    v_mfma_f32_16x16x32_bf16 v[148:151], a[68:71], v[204:207], v[148:151]
    s_waitcnt lgkmcnt(10)
    ds_read_b64_tr_b16 a[232:233], v32 offset:49152
    ds_read_b64_tr_b16 a[234:235], v32 offset:51200
    v_mfma_f32_16x16x32_bf16 v[136:139], a[72:75], v[200:203], v[136:139]
    s_nop 0
    ds_read_b64_tr_b16 a[64:65], v18 offset:8192
    ds_read_b64_tr_b16 a[66:67], v18 offset:8704
    v_mfma_f32_16x16x32_bf16 v[152:155], a[72:75], v[204:207], v[152:155]
    ds_read_b64_tr_b16 a[236:237], v33 offset:49152
    ds_read_b64_tr_b16 a[238:239], v33 offset:51200
    v_mfma_f32_16x16x32_bf16 v[140:143], a[76:79], v[200:203], v[140:143]
    ds_read_b64_tr_b16 a[68:69], v19 offset:8192
    ds_read_b64_tr_b16 a[70:71], v19 offset:8704
    v_mfma_f32_16x16x32_bf16 v[156:159], a[76:79], v[204:207], v[156:159]
    v_mfma_f32_16x16x32_bf16 v[160:163], a[80:83], v[200:203], v[160:163]
    ds_read_b64_tr_b16 a[72:73], v22 offset:8192
    ds_read_b64_tr_b16 a[74:75], v22 offset:8704
    v_mfma_f32_16x16x32_bf16 v[176:179], a[80:83], v[204:207], v[176:179]
    s_waitcnt lgkmcnt(10)
    v_mfma_f32_16x16x32_bf16 v[164:167], a[84:87], v[200:203], v[164:167]
    s_nop 0
    ds_read_b64_tr_b16 a[76:77], v23 offset:8192
    ds_read_b64_tr_b16 a[78:79], v23 offset:8704
    v_mfma_f32_16x16x32_bf16 v[180:183], a[84:87], v[204:207], v[180:183]
    buffer_load_dwordx4 v11, s[28:31], s5 offen offset:1024 lds
    v_mfma_f32_16x16x32_bf16 v[168:171], a[88:91], v[200:203], v[168:171]
    ds_read_b64_tr_b16 a[80:81], v20 offset:8192
    ds_read_b64_tr_b16 a[82:83], v20 offset:8704
    v_mfma_f32_16x16x32_bf16 v[184:187], a[88:91], v[204:207], v[184:187]
    v_mfma_f32_16x16x32_bf16 v[172:175], a[92:95], v[200:203], v[172:175]
    ds_read_b64_tr_b16 a[84:85], v21 offset:8192
    ds_read_b64_tr_b16 a[86:87], v21 offset:8704
    v_mfma_f32_16x16x32_bf16 v[188:191], a[92:95], v[204:207], v[188:191]
    s_waitcnt lgkmcnt(6)
    v_mfma_f32_16x16x32_bf16 v[128:131], a[64:67], v[208:211], v[128:131]
    s_waitcnt vmcnt(6)
    ds_read_b64_tr_b16 a[88:89], v24 offset:8192
    ds_read_b64_tr_b16 a[90:91], v24 offset:8704
    v_mfma_f32_16x16x32_bf16 v[144:147], a[64:67], v[212:215], v[144:147]
    ds_read_b64_tr_b16 a[240:241], v30 offset:57344
    ds_read_b64_tr_b16 a[242:243], v30 offset:59392
    v_mfma_f32_16x16x32_bf16 v[132:135], a[68:71], v[208:211], v[132:135]
    ds_read_b64_tr_b16 a[92:93], v25 offset:8192
    ds_read_b64_tr_b16 a[94:95], v25 offset:8704
    v_mfma_f32_16x16x32_bf16 v[148:151], a[68:71], v[212:215], v[148:151]
    ds_read_b64_tr_b16 a[244:245], v31 offset:57344
    ds_read_b64_tr_b16 a[246:247], v31 offset:59392
    v_mfma_f32_16x16x32_bf16 v[136:139], a[72:75], v[208:211], v[136:139]
    ds_read_b64_tr_b16 a[64:65], v18 offset:12288
    ds_read_b64_tr_b16 a[66:67], v18 offset:12800
    v_mfma_f32_16x16x32_bf16 v[152:155], a[72:75], v[212:215], v[152:155]
    s_waitcnt lgkmcnt(10)
    buffer_load_dwordx4 v12, s[28:31], s5 offen offset:2048 lds
    v_mfma_f32_16x16x32_bf16 v[140:143], a[76:79], v[208:211], v[140:143]
    s_nop 0
    ds_read_b64_tr_b16 a[68:69], v19 offset:12288
    ds_read_b64_tr_b16 a[70:71], v19 offset:12800
    v_mfma_f32_16x16x32_bf16 v[156:159], a[76:79], v[212:215], v[156:159]
    ds_read_b64_tr_b16 a[248:249], v32 offset:57344
    ds_read_b64_tr_b16 a[250:251], v32 offset:59392
    v_mfma_f32_16x16x32_bf16 v[160:163], a[80:83], v[208:211], v[160:163]
    ds_read_b64_tr_b16 a[72:73], v22 offset:12288
    ds_read_b64_tr_b16 a[74:75], v22 offset:12800
    v_mfma_f32_16x16x32_bf16 v[176:179], a[80:83], v[212:215], v[176:179]
    ds_read_b64_tr_b16 a[252:253], v33 offset:57344
    ds_read_b64_tr_b16 a[254:255], v33 offset:59392
    v_mfma_f32_16x16x32_bf16 v[164:167], a[84:87], v[208:211], v[164:167]
    ds_read_b64_tr_b16 a[76:77], v23 offset:12288
    ds_read_b64_tr_b16 a[78:79], v23 offset:12800
    v_mfma_f32_16x16x32_bf16 v[180:183], a[84:87], v[212:215], v[180:183]
    s_waitcnt lgkmcnt(10)
    buffer_load_dwordx4 v13, s[28:31], s5 offen offset:3072 lds
    v_mfma_f32_16x16x32_bf16 v[168:171], a[88:91], v[208:211], v[168:171]
    s_nop 0
    ds_read_b64_tr_b16 a[80:81], v20 offset:12288
    ds_read_b64_tr_b16 a[82:83], v20 offset:12800
    v_mfma_f32_16x16x32_bf16 v[184:187], a[88:91], v[212:215], v[184:187]
    s_lshl3_add_u32 s62, s15, s62
    s_add_u32 m0, s60, 49152
    v_mfma_f32_16x16x32_bf16 v[172:175], a[92:95], v[208:211], v[172:175]
    s_nop 0
    ds_read_b64_tr_b16 a[84:85], v21 offset:12288
    ds_read_b64_tr_b16 a[86:87], v21 offset:12800
    v_mfma_f32_16x16x32_bf16 v[188:191], a[92:95], v[212:215], v[188:191]
    buffer_load_dwordx4 v14, s[44:47], s62 offen offset:0 lds
    v_mfma_f32_16x16x32_bf16 v[128:131], a[64:67], v[216:219], v[128:131]
    ds_read_b64_tr_b16 a[88:89], v24 offset:12288
    ds_read_b64_tr_b16 a[90:91], v24 offset:12800
    v_mfma_f32_16x16x32_bf16 v[144:147], a[64:67], v[220:223], v[144:147]
    s_waitcnt lgkmcnt(6)
    v_mfma_f32_16x16x32_bf16 v[132:135], a[68:71], v[216:219], v[132:135]
    s_nop 0
    ds_read_b64_tr_b16 a[92:93], v25 offset:12288
    ds_read_b64_tr_b16 a[94:95], v25 offset:12800
    v_mfma_f32_16x16x32_bf16 v[148:151], a[68:71], v[220:223], v[148:151]
    s_waitcnt vmcnt(5)
    buffer_load_dwordx4 v15, s[44:47], s62 offen offset:1024 lds
    v_mfma_f32_16x16x32_bf16 v[136:139], a[72:75], v[216:219], v[136:139]
    s_barrier
    ds_read_b64_tr_b16 a[64:65], v18 offset:16384
    ds_read_b64_tr_b16 a[66:67], v18 offset:16896
    v_mfma_f32_16x16x32_bf16 v[152:155], a[72:75], v[220:223], v[152:155]
    v_mfma_f32_16x16x32_bf16 v[140:143], a[76:79], v[216:219], v[140:143]
    ds_read_b64_tr_b16 a[68:69], v19 offset:16384
    ds_read_b64_tr_b16 a[70:71], v19 offset:16896
    v_mfma_f32_16x16x32_bf16 v[156:159], a[76:79], v[220:223], v[156:159]
    s_waitcnt lgkmcnt(6)
    v_mfma_f32_16x16x32_bf16 v[160:163], a[80:83], v[216:219], v[160:163]
    s_nop 0
    ds_read_b64_tr_b16 a[72:73], v22 offset:16384
    ds_read_b64_tr_b16 a[74:75], v22 offset:16896
    v_mfma_f32_16x16x32_bf16 v[176:179], a[80:83], v[220:223], v[176:179]
    buffer_load_dwordx4 v16, s[44:47], s62 offen offset:2048 lds
    v_mfma_f32_16x16x32_bf16 v[164:167], a[84:87], v[216:219], v[164:167]
    ds_read_b64_tr_b16 a[76:77], v23 offset:16384
    ds_read_b64_tr_b16 a[78:79], v23 offset:16896
    v_mfma_f32_16x16x32_bf16 v[180:183], a[84:87], v[220:223], v[180:183]
    v_mfma_f32_16x16x32_bf16 v[168:171], a[88:91], v[216:219], v[168:171]
    ds_read_b64_tr_b16 a[80:81], v18 offset:20480
    ds_read_b64_tr_b16 a[82:83], v18 offset:20992
    v_mfma_f32_16x16x32_bf16 v[184:187], a[88:91], v[220:223], v[184:187]
    s_waitcnt lgkmcnt(6)
    v_mfma_f32_16x16x32_bf16 v[172:175], a[92:95], v[216:219], v[172:175]
    s_nop 0
    ds_read_b64_tr_b16 a[84:85], v19 offset:20480
    ds_read_b64_tr_b16 a[86:87], v19 offset:20992
    v_mfma_f32_16x16x32_bf16 v[188:191], a[92:95], v[220:223], v[188:191]
    v_mfma_f32_16x16x32_bf16 v[128:131], a[64:67], v[224:227], v[128:131]
    ds_read_b64_tr_b16 a[88:89], v22 offset:20480
    ds_read_b64_tr_b16 a[90:91], v22 offset:20992
    v_mfma_f32_16x16x32_bf16 v[144:147], a[64:67], v[228:231], v[144:147]
    buffer_load_dwordx4 v17, s[44:47], s62 offen offset:3072 lds
    v_mfma_f32_16x16x32_bf16 v[132:135], a[68:71], v[224:227], v[132:135]
    s_add_u32 s4, s4, 2
    ds_read_b64_tr_b16 a[92:93], v23 offset:20480
    ds_read_b64_tr_b16 a[94:95], v23 offset:20992
    v_mfma_f32_16x16x32_bf16 v[148:151], a[68:71], v[228:231], v[148:151]
    s_waitcnt lgkmcnt(6)
    s_and_b32 s4, s4, 7
    s_mul_i32 s5, s4, 229376
    v_mfma_f32_16x16x32_bf16 v[136:139], a[72:75], v[224:227], v[136:139]
    s_add_u32 m0, s60, 40960
    ds_read_b64_tr_b16 a[64:65], v18 offset:24576
    ds_read_b64_tr_b16 a[66:67], v18 offset:25088
    v_mfma_f32_16x16x32_bf16 v[152:155], a[72:75], v[228:231], v[152:155]
    v_mfma_f32_16x16x32_bf16 v[140:143], a[76:79], v[224:227], v[140:143]
    s_nop 0
    ds_read_b64_tr_b16 a[68:69], v19 offset:24576
    ds_read_b64_tr_b16 a[70:71], v19 offset:25088
    v_mfma_f32_16x16x32_bf16 v[156:159], a[76:79], v[228:231], v[156:159]
    v_mfma_f32_16x16x32_bf16 v[128:131], a[80:83], v[232:235], v[128:131]
    ds_read_b64_tr_b16 a[72:73], v22 offset:24576
    ds_read_b64_tr_b16 a[74:75], v22 offset:25088
    v_mfma_f32_16x16x32_bf16 v[144:147], a[80:83], v[236:239], v[144:147]
    s_waitcnt lgkmcnt(6)
    v_mfma_f32_16x16x32_bf16 v[132:135], a[84:87], v[232:235], v[132:135]
    s_nop 0
    ds_read_b64_tr_b16 a[76:77], v23 offset:24576
    ds_read_b64_tr_b16 a[78:79], v23 offset:25088
    v_mfma_f32_16x16x32_bf16 v[148:151], a[84:87], v[236:239], v[148:151]
    buffer_load_dwordx4 v10, s[28:31], s5 offen offset:0 lds
    v_mfma_f32_16x16x32_bf16 v[136:139], a[88:91], v[232:235], v[136:139]
    ds_read_b64_tr_b16 a[80:81], v18 offset:28672
    ds_read_b64_tr_b16 a[82:83], v18 offset:29184
    v_mfma_f32_16x16x32_bf16 v[152:155], a[88:91], v[236:239], v[152:155]
    v_mfma_f32_16x16x32_bf16 v[140:143], a[92:95], v[232:235], v[140:143]
    ds_read_b64_tr_b16 a[84:85], v19 offset:28672
    ds_read_b64_tr_b16 a[86:87], v19 offset:29184
    v_mfma_f32_16x16x32_bf16 v[156:159], a[92:95], v[236:239], v[156:159]
    s_waitcnt lgkmcnt(6)
    v_mfma_f32_16x16x32_bf16 v[128:131], a[64:67], v[240:243], v[128:131]
    s_nop 0
    ds_read_b64_tr_b16 a[88:89], v22 offset:28672
    ds_read_b64_tr_b16 a[90:91], v22 offset:29184
    v_mfma_f32_16x16x32_bf16 v[144:147], a[64:67], v[244:247], v[144:147]
    v_mfma_f32_16x16x32_bf16 v[132:135], a[68:71], v[240:243], v[132:135]
    ds_read_b64_tr_b16 a[92:93], v23 offset:28672
    ds_read_b64_tr_b16 a[94:95], v23 offset:29184
    v_mfma_f32_16x16x32_bf16 v[148:151], a[68:71], v[244:247], v[148:151]
    buffer_load_dwordx4 v11, s[28:31], s5 offen offset:1024 lds
    v_mfma_f32_16x16x32_bf16 v[136:139], a[72:75], v[240:243], v[136:139]
    ds_read_b64_tr_b16 a[64:65], v20 offset:16384
    ds_read_b64_tr_b16 a[66:67], v20 offset:16896
    v_mfma_f32_16x16x32_bf16 v[152:155], a[72:75], v[244:247], v[152:155]
    s_waitcnt lgkmcnt(6)
    v_mfma_f32_16x16x32_bf16 v[140:143], a[76:79], v[240:243], v[140:143]
    s_nop 0
    ds_read_b64_tr_b16 a[68:69], v21 offset:16384
    ds_read_b64_tr_b16 a[70:71], v21 offset:16896
    v_mfma_f32_16x16x32_bf16 v[156:159], a[76:79], v[244:247], v[156:159]
    v_mfma_f32_16x16x32_bf16 v[128:131], a[80:83], v[248:251], v[128:131]
    ds_read_b64_tr_b16 a[72:73], v24 offset:16384
    ds_read_b64_tr_b16 a[74:75], v24 offset:16896
    v_mfma_f32_16x16x32_bf16 v[144:147], a[80:83], v[252:255], v[144:147]
    buffer_load_dwordx4 v12, s[28:31], s5 offen offset:2048 lds
    v_mfma_f32_16x16x32_bf16 v[132:135], a[84:87], v[248:251], v[132:135]
    ds_read_b64_tr_b16 a[76:77], v25 offset:16384
    ds_read_b64_tr_b16 a[78:79], v25 offset:16896
    v_mfma_f32_16x16x32_bf16 v[148:151], a[84:87], v[252:255], v[148:151]
    s_waitcnt lgkmcnt(6)
    v_mfma_f32_16x16x32_bf16 v[136:139], a[88:91], v[248:251], v[136:139]
L_padB4:
    s_cbranch_execz L_padret
    ds_read_b64_tr_b16 a[80:81], v20 offset:20480
    ds_read_b64_tr_b16 a[82:83], v20 offset:20992
    v_mfma_f32_16x16x32_bf16 v[152:155], a[88:91], v[252:255], v[152:155]
    buffer_load_dwordx4 v13, s[28:31], s5 offen offset:3072 lds
    v_mfma_f32_16x16x32_bf16 v[140:143], a[92:95], v[248:251], v[140:143]
    s_add_u32 s4, s4, 2
    ds_read_b64_tr_b16 a[84:85], v21 offset:20480
    ds_read_b64_tr_b16 a[86:87], v21 offset:20992
    v_mfma_f32_16x16x32_bf16 v[156:159], a[92:95], v[252:255], v[156:159]
    s_and_b32 s4, s4, 7
    s_mul_i32 s5, s4, 229376
    v_mfma_f32_16x16x32_bf16 v[160:163], a[64:67], v[224:227], v[160:163]
    s_mov_b32 m0, s60
    ds_read_b64_tr_b16 a[88:89], v24 offset:20480
    ds_read_b64_tr_b16 a[90:91], v24 offset:20992
    v_mfma_f32_16x16x32_bf16 v[176:179], a[64:67], v[228:231], v[176:179]
    s_waitcnt lgkmcnt(6)
    v_pk_mul_f32 v[136:137], v[128:129], v[136:137]
    v_pk_mul_f32 v[128:129], v[128:129], v[34:35] op_sel:[0,0] op_sel_hi:[1,0]
    v_pk_mul_f32 v[138:139], v[130:131], v[138:139]
    v_pk_mul_f32 v[130:131], v[130:131], v[34:35] op_sel:[0,0] op_sel_hi:[1,0]
    v_pk_mul_f32 v[140:141], v[132:133], v[140:141]
    v_mfma_f32_16x16x32_bf16 v[164:167], a[68:71], v[224:227], v[164:167]
    ds_read_b64_tr_b16 a[92:93], v25 offset:20480
    ds_read_b64_tr_b16 a[94:95], v25 offset:20992
    v_mfma_f32_16x16x32_bf16 v[180:183], a[68:71], v[228:231], v[180:183]
    v_exp_f32 v128, v128
    v_exp_f32 v129, v129
    v_exp_f32_e64 v130, v130
    v_pk_mul_f32 v[132:133], v[132:133], v[34:35] op_sel:[0,0] op_sel_hi:[1,0]
    v_pk_fma_f32 v[128:129], v[128:129], v[36:37], v[36:37] op_sel:[0,0,0] op_sel_hi:[1,0,0]
    v_pk_mul_f32 v[142:143], v[134:135], v[142:143]
    v_pk_mul_f32 v[134:135], v[134:135], v[34:35] op_sel:[0,0] op_sel_hi:[1,0]
    v_mfma_f32_16x16x32_bf16 v[168:171], a[72:75], v[224:227], v[168:171]
    ds_read_b64_tr_b16 a[64:65], v20 offset:24576
    ds_read_b64_tr_b16 a[66:67], v20 offset:25088
    v_mfma_f32_16x16x32_bf16 v[184:187], a[72:75], v[228:231], v[184:187]
    buffer_load_dwordx4 v10, s[28:31], s5 offen offset:0 lds
    v_exp_f32 v131, v131
    v_exp_f32 v132, v132
    v_pk_fma_f32 v[130:131], v[130:131], v[36:37], v[36:37] op_sel:[0,0,0] op_sel_hi:[1,0,0]
    v_pk_mul_f32 v[152:153], v[144:145], v[152:153]
    v_pk_mul_f32 v[144:145], v[144:145], v[34:35] op_sel:[0,1] op_sel_hi:[1,1]
    v_pk_mul_f32 v[154:155], v[146:147], v[154:155]
    v_mfma_f32_16x16x32_bf16 v[172:175], a[76:79], v[224:227], v[172:175]
    ds_read_b64_tr_b16 a[68:69], v21 offset:24576
    ds_read_b64_tr_b16 a[70:71], v21 offset:25088
    v_mfma_f32_16x16x32_bf16 v[188:191], a[76:79], v[228:231], v[188:191]
    s_waitcnt lgkmcnt(6)
    v_exp_f32 v133, v133
    v_rcp_f32 v128, v128
    v_rcp_f32 v129, v129
    v_pk_fma_f32 v[132:133], v[132:133], v[36:37], v[36:37] op_sel:[0,0,0] op_sel_hi:[1,0,0]
    v_pk_mul_f32 v[136:137], v[128:129], v[136:137]
    v_pk_mul_f32 v[146:147], v[146:147], v[34:35] op_sel:[0,1] op_sel_hi:[1,1]
    v_pk_mul_f32 v[156:157], v[148:149], v[156:157]
    v_mfma_f32_16x16x32_bf16 v[160:163], a[80:83], v[232:235], v[160:163]
    ds_read_b64_tr_b16 a[72:73], v24 offset:24576
    ds_read_b64_tr_b16 a[74:75], v24 offset:25088
    v_mfma_f32_16x16x32_bf16 v[176:179], a[80:83], v[236:239], v[176:179]
    buffer_load_dwordx4 v11, s[28:31], s5 offen offset:1024 lds
    v_exp_f32 v134, v134
    v_exp_f32 v135, v135
    v_pk_mul_f32 v[148:149], v[148:149], v[34:35] op_sel:[0,1] op_sel_hi:[1,1]
    v_pk_fma_f32 v[134:135], v[134:135], v[36:37], v[36:37] op_sel:[0,0,0] op_sel_hi:[1,0,0]
    v_rcp_f32_e64 v130, v130
    v_mfma_f32_16x16x32_bf16 v[164:167], a[84:87], v[232:235], v[164:167]
    ds_read_b64_tr_b16 a[76:77], v25 offset:24576
    ds_read_b64_tr_b16 a[78:79], v25 offset:25088
    v_mfma_f32_16x16x32_bf16 v[180:183], a[84:87], v[236:239], v[180:183]
    v_rcp_f32 v131, v131
    v_exp_f32 v144, v144
    v_exp_f32_e64 v145, v145
    v_pk_mul_f32 v[138:139], v[130:131], v[138:139]
    v_pk_fma_f32 v[144:145], v[144:145], v[36:37], v[36:37] op_sel:[0,1,1] op_sel_hi:[1,1,1]
    v_pk_mul_f32 v[158:159], v[150:151], v[158:159]
    v_pk_mul_f32 v[150:151], v[150:151], v[34:35] op_sel:[0,1] op_sel_hi:[1,1]
    v_mfma_f32_16x16x32_bf16 v[168:171], a[88:91], v[232:235], v[168:171]
    ds_read_b64_tr_b16 a[80:81], v20 offset:28672
    ds_read_b64_tr_b16 a[82:83], v20 offset:29184
    v_mfma_f32_16x16x32_bf16 v[184:187], a[88:91], v[236:239], v[184:187]
    s_waitcnt lgkmcnt(6)
    buffer_load_dwordx4 v12, s[28:31], s5 offen offset:2048 lds
    v_rcp_f32 v132, v132
    v_rcp_f32_e64 v133, v133
    v_cvt_pk_bf16_f32 v128, v136, v137
    v_pk_mul_f32 v[140:141], v[132:133], v[140:141]
    v_exp_f32_e64 v146, v146
    v_mfma_f32_16x16x32_bf16 v[172:175], a[92:95], v[232:235], v[172:175]
    ds_read_b64_tr_b16 a[84:85], v21 offset:28672
    ds_read_b64_tr_b16 a[86:87], v21 offset:29184
    v_mfma_f32_16x16x32_bf16 v[188:191], a[92:95], v[236:239], v[188:191]
    v_exp_f32 v147, v147
    v_rcp_f32 v134, v134
    v_rcp_f32_e64 v135, v135
    v_pk_fma_f32 v[146:147], v[146:147], v[36:37], v[36:37] op_sel:[0,1,1] op_sel_hi:[1,1,1]
    v_pk_mul_f32 v[142:143], v[134:135], v[142:143]
    v_cvt_pk_bf16_f32 v129, v138, v139
    v_cvt_pk_bf16_f32 v130, v140, v141
    v_mfma_f32_16x16x32_bf16 v[160:163], a[64:67], v[240:243], v[160:163]
    ds_read_b64_tr_b16 a[88:89], v24 offset:28672
    ds_read_b64_tr_b16 a[90:91], v24 offset:29184
    v_mfma_f32_16x16x32_bf16 v[176:179], a[64:67], v[244:247], v[176:179]
    buffer_load_dword v38, off, s[36:39], s79 offset:0 sc1
    v_exp_f32 v148, v148
    v_exp_f32 v149, v149
    v_rcp_f32_e64 v144, v144
    v_pk_fma_f32 v[148:149], v[148:149], v[36:37], v[36:37] op_sel:[0,1,1] op_sel_hi:[1,1,1]
    v_cvt_pk_bf16_f32 v131, v142, v143
    v_mfma_f32_16x16x32_bf16 v[164:167], a[68:71], v[240:243], v[164:167]
    ds_read_b64_tr_b16 a[92:93], v25 offset:28672
    ds_read_b64_tr_b16 a[94:95], v25 offset:29184
    v_mfma_f32_16x16x32_bf16 v[180:183], a[68:71], v[244:247], v[180:183]
    s_waitcnt lgkmcnt(6) vmcnt(4)
    buffer_load_dwordx4 v13, s[28:31], s5 offen offset:3072 lds
    v_rcp_f32 v145, v145
    v_exp_f32_e64 v150, v150
    v_pk_mul_f32 v[152:153], v[144:145], v[152:153]
    v_exp_f32_e64 v151, v151
    v_cvt_pk_bf16_f32 v144, v152, v153
    v_mfma_f32_16x16x32_bf16 v[168:171], a[72:75], v[240:243], v[168:171]
    s_barrier
    ds_read_b64_tr_b16 a[64:65], v26 offset:32768
    ds_read_b64_tr_b16 a[66:67], v26 offset:33024
    v_mfma_f32_16x16x32_bf16 v[184:187], a[72:75], v[244:247], v[184:187]
    v_rcp_f32 v146, v146
    v_rcp_f32 v147, v147
    v_rcp_f32 v148, v148
    v_pk_fma_f32 v[150:151], v[150:151], v[36:37], v[36:37] op_sel:[0,1,1] op_sel_hi:[1,1,1]
    v_pk_mul_f32 v[154:155], v[146:147], v[154:155]
    v_rcp_f32_e64 v149, v149
    v_mfma_f32_16x16x32_bf16 v[172:175], a[76:79], v[240:243], v[172:175]
    s_add_u32 s4, s4, 2
    ds_read_b64_tr_b16 a[68:69], v27 offset:32768
    ds_read_b64_tr_b16 a[70:71], v27 offset:33024
    v_mfma_f32_16x16x32_bf16 v[188:191], a[76:79], v[244:247], v[188:191]
    v_rcp_f32 v150, v150
    v_rcp_f32_e64 v151, v151
    v_cvt_pk_bf16_f32 v145, v154, v155
    v_pk_mul_f32 v[156:157], v[148:149], v[156:157]
    v_pk_mul_f32 v[158:159], v[150:151], v[158:159]
    v_cvt_pk_bf16_f32 v146, v156, v157
    v_cvt_pk_bf16_f32 v147, v158, v159
    s_and_b32 s4, s4, 7
    v_mfma_f32_16x16x32_bf16 v[160:163], a[80:83], v[248:251], v[160:163]
    s_mul_i32 s5, s4, 229376
    ds_read_b64_tr_b16 a[72:73], v28 offset:32768
    ds_read_b64_tr_b16 a[74:75], v28 offset:33024
    buffer_store_dwordx4 v[128:131], v1, s[36:39], s68 offen offset:0 sc1
    v_mfma_f32_16x16x32_bf16 v[176:179], a[80:83], v[252:255], v[176:179]
    s_waitcnt lgkmcnt(6)
    s_add_u32 m0, s60, 8192
    v_mfma_f32_16x16x32_bf16 v[164:167], a[84:87], v[248:251], v[164:167]
    ds_read_b64_tr_b16 a[76:77], v29 offset:32768
    ds_read_b64_tr_b16 a[78:79], v29 offset:33024
    v_mfma_f32_16x16x32_bf16 v[180:183], a[84:87], v[252:255], v[180:183]
    buffer_load_dwordx4 v10, s[28:31], s5 offen offset:0 lds
    v_mfma_f32_16x16x32_bf16 v[168:171], a[88:91], v[248:251], v[168:171]
    ds_read_b64_tr_b16 a[80:81], v26 offset:34816
    ds_read_b64_tr_b16 a[82:83], v26 offset:35072
    buffer_store_dwordx4 v[144:147], v1, s[36:39], s68 offen offset:1024 sc1
    v_mfma_f32_16x16x32_bf16 v[184:187], a[88:91], v[252:255], v[184:187]
    v_mfma_f32_16x16x32_bf16 v[172:175], a[92:95], v[248:251], v[172:175]
    ds_read_b64_tr_b16 a[84:85], v27 offset:34816
    ds_read_b64_tr_b16 a[86:87], v27 offset:35072
    v_mfma_f32_16x16x32_bf16 v[188:191], a[92:95], v[252:255], v[188:191]
    s_waitcnt lgkmcnt(6)
    v_mfma_f32_16x16x32_bf16 v[64:67], a[64:67], a[0:3], 0
    s_nop 0
    ds_read_b64_tr_b16 a[88:89], v28 offset:34816
    ds_read_b64_tr_b16 a[90:91], v28 offset:35072
    v_mfma_f32_16x16x32_bf16 v[80:83], a[64:67], a[4:7], 0
    v_pk_mul_f32 v[168:169], v[160:161], v[168:169]
    v_pk_mul_f32 v[160:161], v[160:161], v[34:35] op_sel:[0,0] op_sel_hi:[1,0]
    v_pk_mul_f32 v[170:171], v[162:163], v[170:171]
    v_pk_mul_f32 v[162:163], v[162:163], v[34:35] op_sel:[0,0] op_sel_hi:[1,0]
    v_pk_mul_f32 v[172:173], v[164:165], v[172:173]
    v_mfma_f32_16x16x32_bf16 v[68:71], a[68:71], a[0:3], 0
    ds_read_b64_tr_b16 a[92:93], v29 offset:34816
    ds_read_b64_tr_b16 a[94:95], v29 offset:35072
    v_mfma_f32_16x16x32_bf16 v[84:87], a[68:71], a[4:7], 0
    buffer_load_dwordx4 v11, s[28:31], s5 offen offset:1024 lds
    v_exp_f32 v160, v160
    v_exp_f32 v161, v161
    v_pk_mul_f32 v[164:165], v[164:165], v[34:35] op_sel:[0,0] op_sel_hi:[1,0]
    v_pk_fma_f32 v[160:161], v[160:161], v[36:37], v[36:37] op_sel:[0,0,0] op_sel_hi:[1,0,0]
    v_pk_mul_f32 v[174:175], v[166:167], v[174:175]
    v_pk_mul_f32 v[166:167], v[166:167], v[34:35] op_sel:[0,0] op_sel_hi:[1,0]
    v_mfma_f32_16x16x32_bf16 v[72:75], a[72:75], a[0:3], 0
    ds_read_b64_tr_b16 a[64:65], v26 offset:36864
    ds_read_b64_tr_b16 a[66:67], v26 offset:37120
    v_mfma_f32_16x16x32_bf16 v[88:91], a[72:75], a[4:7], 0
    s_waitcnt lgkmcnt(6)
    buffer_load_dwordx4 v12, s[28:31], s5 offen offset:2048 lds
    s_waitcnt vmcnt(6)
    v_readfirstlane_b32 s72, v38
    s_nop 0
    s_cmp_ge_u32 s72, 4
    s_cbranch_scc0 L_slow_EB
L_back_EB:
    v_pk_mul_f32 v[184:185], v[176:177], v[184:185]
    v_pk_mul_f32 v[176:177], v[176:177], v[34:35] op_sel:[0,1] op_sel_hi:[1,1]
    v_pk_mul_f32 v[186:187], v[178:179], v[186:187]
    v_pk_mul_f32 v[178:179], v[178:179], v[34:35] op_sel:[0,1] op_sel_hi:[1,1]
    v_exp_f32_e64 v162, v162
    v_mfma_f32_16x16x32_bf16 v[76:79], a[76:79], a[0:3], 0
    ds_read_b64_tr_b16 a[68:69], v27 offset:36864
    ds_read_b64_tr_b16 a[70:71], v27 offset:37120
    v_mfma_f32_16x16x32_bf16 v[92:95], a[76:79], a[4:7], 0
    v_exp_f32 v163, v163
    v_exp_f32 v164, v164
    v_exp_f32_e64 v165, v165
    v_pk_fma_f32 v[162:163], v[162:163], v[36:37], v[36:37] op_sel:[0,0,0] op_sel_hi:[1,0,0]
    v_pk_fma_f32 v[164:165], v[164:165], v[36:37], v[36:37] op_sel:[0,0,0] op_sel_hi:[1,0,0]
    v_rcp_f32_e64 v160, v160
    v_mfma_f32_16x16x32_bf16 v[64:67], a[80:83], a[8:11], v[64:67]
    ds_read_b64_tr_b16 a[72:73], v28 offset:36864
    ds_read_b64_tr_b16 a[74:75], v28 offset:37120
    v_mfma_f32_16x16x32_bf16 v[80:83], a[80:83], a[12:15], v[80:83]
    buffer_load_dwordx4 v13, s[28:31], s5 offen offset:3072 lds
    v_rcp_f32 v161, v161
    v_exp_f32 v166, v166
    v_pk_mul_f32 v[168:169], v[160:161], v[168:169]
    v_pk_mul_f32 v[188:189], v[180:181], v[188:189]
    v_pk_mul_f32 v[180:181], v[180:181], v[34:35] op_sel:[0,1] op_sel_hi:[1,1]
    v_cvt_pk_bf16_f32 v160, v168, v169
    v_mfma_f32_16x16x32_bf16 v[68:71], a[84:87], a[8:11], v[68:71]
    ds_read_b64_tr_b16 a[76:77], v29 offset:36864
    ds_read_b64_tr_b16 a[78:79], v29 offset:37120
    v_mfma_f32_16x16x32_bf16 v[84:87], a[84:87], a[12:15], v[84:87]
    s_waitcnt lgkmcnt(6)
    v_exp_f32 v167, v167
    v_rcp_f32_e64 v162, v162
    v_pk_fma_f32 v[166:167], v[166:167], v[36:37], v[36:37] op_sel:[0,0,0] op_sel_hi:[1,0,0]
    v_pk_mul_f32 v[190:191], v[182:183], v[190:191]
    v_pk_mul_f32 v[182:183], v[182:183], v[34:35] op_sel:[0,1] op_sel_hi:[1,1]
    v_rcp_f32 v163, v163
    s_lshl3_add_u32 s62, s13, s62
    v_mfma_f32_16x16x32_bf16 v[72:75], a[88:91], a[8:11], v[72:75]
    s_add_u32 m0, s60, 57344
    ds_read_b64_tr_b16 a[80:81], v26 offset:38912
    ds_read_b64_tr_b16 a[82:83], v26 offset:39168
    v_mfma_f32_16x16x32_bf16 v[88:91], a[88:91], a[12:15], v[88:91]
    v_exp_f32 v176, v176
    v_exp_f32 v177, v177
    v_rcp_f32_e64 v164, v164
    v_pk_mul_f32 v[170:171], v[162:163], v[170:171]
    v_pk_fma_f32 v[176:177], v[176:177], v[36:37], v[36:37] op_sel:[0,1,1] op_sel_hi:[1,1,1]
    v_rcp_f32_e64 v165, v165
    v_mfma_f32_16x16x32_bf16 v[76:79], a[92:95], a[8:11], v[76:79]
    ds_read_b64_tr_b16 a[84:85], v27 offset:38912
    ds_read_b64_tr_b16 a[86:87], v27 offset:39168
    v_mfma_f32_16x16x32_bf16 v[92:95], a[92:95], a[12:15], v[92:95]
    s_add_u32 s65, s8, s86
    v_exp_f32 v178, v178
    v_exp_f32 v179, v179
    v_rcp_f32 v166, v166
    v_pk_mul_f32 v[172:173], v[164:165], v[172:173]
    v_pk_fma_f32 v[178:179], v[178:179], v[36:37], v[36:37] op_sel:[0,1,1] op_sel_hi:[1,1,1]
    v_cvt_pk_bf16_f32 v161, v170, v171
    v_mfma_f32_16x16x32_bf16 v[64:67], a[64:67], a[16:19], v[64:67]
    ds_read_b64_tr_b16 a[88:89], v28 offset:38912
    ds_read_b64_tr_b16 a[90:91], v28 offset:39168
    v_mfma_f32_16x16x32_bf16 v[80:83], a[64:67], a[20:23], v[80:83]
    s_waitcnt lgkmcnt(6)
    v_rcp_f32 v167, v167
    v_exp_f32 v180, v180
    v_exp_f32 v181, v181
    v_pk_mul_f32 v[174:175], v[166:167], v[174:175]
    v_pk_fma_f32 v[180:181], v[180:181], v[36:37], v[36:37] op_sel:[0,1,1] op_sel_hi:[1,1,1]
    v_rcp_f32_e64 v176, v176
    v_mfma_f32_16x16x32_bf16 v[68:71], a[68:71], a[16:19], v[68:71]
    ds_read_b64_tr_b16 a[92:93], v29 offset:38912
    ds_read_b64_tr_b16 a[94:95], v29 offset:39168
    v_mfma_f32_16x16x32_bf16 v[84:87], a[68:71], a[20:23], v[84:87]
    v_rcp_f32_e64 v177, v177
    v_cvt_pk_bf16_f32 v162, v172, v173
    v_exp_f32_e64 v182, v182
    v_pk_mul_f32 v[184:185], v[176:177], v[184:185]
    v_exp_f32 v183, v183
    v_rcp_f32 v178, v178
    v_mfma_f32_16x16x32_bf16 v[72:75], a[72:75], a[16:19], v[72:75]
    ds_read_b64_tr_b16 a[64:65], v26 offset:40960
    ds_read_b64_tr_b16 a[66:67], v26 offset:41216
    v_mfma_f32_16x16x32_bf16 v[88:91], a[72:75], a[20:23], v[88:91]
    buffer_load_dwordx4 a[0:3], v1, s[36:39], s65 offen offset:0 sc1
    v_rcp_f32_e64 v179, v179
    v_cvt_pk_bf16_f32 v163, v174, v175
    v_pk_fma_f32 v[182:183], v[182:183], v[36:37], v[36:37] op_sel:[0,1,1] op_sel_hi:[1,1,1]
    v_pk_mul_f32 v[186:187], v[178:179], v[186:187]
    v_rcp_f32_e64 v180, v180
    v_cvt_pk_bf16_f32 v176, v184, v185
    v_mfma_f32_16x16x32_bf16 v[76:79], a[76:79], a[16:19], v[76:79]
    ds_read_b64_tr_b16 a[68:69], v27 offset:40960
    ds_read_b64_tr_b16 a[70:71], v27 offset:41216
    v_mfma_f32_16x16x32_bf16 v[92:95], a[76:79], a[20:23], v[92:95]
    s_waitcnt lgkmcnt(6)
    v_rcp_f32 v181, v181
    v_rcp_f32 v182, v182
    v_rcp_f32 v183, v183
    v_pk_mul_f32 v[188:189], v[180:181], v[188:189]
    v_pk_mul_f32 v[190:191], v[182:183], v[190:191]
    v_cvt_pk_bf16_f32 v177, v186, v187
    v_cvt_pk_bf16_f32 v178, v188, v189
    v_mfma_f32_16x16x32_bf16 v[64:67], a[80:83], a[24:27], v[64:67]
    ds_read_b64_tr_b16 a[72:73], v28 offset:40960
    ds_read_b64_tr_b16 a[74:75], v28 offset:41216
    v_mfma_f32_16x16x32_bf16 v[80:83], a[80:83], a[28:31], v[80:83]
    buffer_load_dwordx4 a[4:7], v1, s[36:39], s65 offen offset:1024 sc1
    v_cvt_pk_bf16_f32 v179, v190, v191
    s_add_u32 s19, s68, 4096
    v_mfma_f32_16x16x32_bf16 v[68:71], a[84:87], a[24:27], v[68:71]
    ds_read_b64_tr_b16 a[76:77], v29 offset:40960
    ds_read_b64_tr_b16 a[78:79], v29 offset:41216
    buffer_store_dwordx4 v[160:163], v1, s[36:39], s19 offen offset:0 sc1
    v_mfma_f32_16x16x32_bf16 v[84:87], a[84:87], a[28:31], v[84:87]
    v_mfma_f32_16x16x32_bf16 v[72:75], a[88:91], a[24:27], v[72:75]
    ds_read_b64_tr_b16 a[80:81], v26 offset:43008
    ds_read_b64_tr_b16 a[82:83], v26 offset:43264
    v_mfma_f32_16x16x32_bf16 v[88:91], a[88:91], a[28:31], v[88:91]
    s_waitcnt lgkmcnt(6)
    v_mfma_f32_16x16x32_bf16 v[76:79], a[92:95], a[24:27], v[76:79]
    s_nop 0
    ds_read_b64_tr_b16 a[84:85], v27 offset:43008
    ds_read_b64_tr_b16 a[86:87], v27 offset:43264
    buffer_store_dwordx4 v[176:179], v1, s[36:39], s19 offen offset:1024 sc1
    v_mfma_f32_16x16x32_bf16 v[92:95], a[92:95], a[28:31], v[92:95]
    buffer_load_dwordx4 a[8:11], v1, s[36:39], s65 offen offset:2048 sc1
    v_mfma_f32_16x16x32_bf16 v[64:67], a[64:67], a[32:35], v[64:67]
    ds_read_b64_tr_b16 a[88:89], v28 offset:43008
    ds_read_b64_tr_b16 a[90:91], v28 offset:43264
    v_mfma_f32_16x16x32_bf16 v[80:83], a[64:67], a[36:39], v[80:83]
    v_mfma_f32_16x16x32_bf16 v[68:71], a[68:71], a[32:35], v[68:71]
    ds_read_b64_tr_b16 a[92:93], v29 offset:43008
    ds_read_b64_tr_b16 a[94:95], v29 offset:43264
    v_mfma_f32_16x16x32_bf16 v[84:87], a[68:71], a[36:39], v[84:87]
    s_waitcnt lgkmcnt(6)
    v_mfma_f32_16x16x32_bf16 v[72:75], a[72:75], a[32:35], v[72:75]
    s_nop 0
    ds_read_b64_tr_b16 a[64:65], v26 offset:45056
    ds_read_b64_tr_b16 a[66:67], v26 offset:45312
    v_mfma_f32_16x16x32_bf16 v[88:91], a[72:75], a[36:39], v[88:91]
    v_mfma_f32_16x16x32_bf16 v[76:79], a[76:79], a[32:35], v[76:79]
    ds_read_b64_tr_b16 a[68:69], v27 offset:45056
    ds_read_b64_tr_b16 a[70:71], v27 offset:45312
    v_mfma_f32_16x16x32_bf16 v[92:95], a[76:79], a[36:39], v[92:95]
    buffer_load_dwordx4 a[12:15], v1, s[36:39], s65 offen offset:3072 sc1
    v_mfma_f32_16x16x32_bf16 v[64:67], a[80:83], a[40:43], v[64:67]
    s_add_u32 s65, s12, s65
    ds_read_b64_tr_b16 a[72:73], v28 offset:45056
    ds_read_b64_tr_b16 a[74:75], v28 offset:45312
    v_mfma_f32_16x16x32_bf16 v[80:83], a[80:83], a[44:47], v[80:83]
    s_waitcnt lgkmcnt(6)
    buffer_load_dwordx4 a[16:19], v1, s[36:39], s65 offen offset:0 sc1
    v_mfma_f32_16x16x32_bf16 v[68:71], a[84:87], a[40:43], v[68:71]
    ds_read_b64_tr_b16 a[76:77], v29 offset:45056
    ds_read_b64_tr_b16 a[78:79], v29 offset:45312
    v_mfma_f32_16x16x32_bf16 v[84:87], a[84:87], a[44:47], v[84:87]
    v_mfma_f32_16x16x32_bf16 v[72:75], a[88:91], a[40:43], v[72:75]
    ds_read_b64_tr_b16 a[80:81], v26 offset:47104
    ds_read_b64_tr_b16 a[82:83], v26 offset:47360
    v_mfma_f32_16x16x32_bf16 v[88:91], a[88:91], a[44:47], v[88:91]
    v_mfma_f32_16x16x32_bf16 v[76:79], a[92:95], a[40:43], v[76:79]
    ds_read_b64_tr_b16 a[84:85], v27 offset:47104
    ds_read_b64_tr_b16 a[86:87], v27 offset:47360
    v_mfma_f32_16x16x32_bf16 v[92:95], a[92:95], a[44:47], v[92:95]
    s_waitcnt lgkmcnt(6)
    v_mfma_f32_16x16x32_bf16 v[64:67], a[64:67], a[48:51], v[64:67]
    s_nop 0
    ds_read_b64_tr_b16 a[88:89], v28 offset:47104
    ds_read_b64_tr_b16 a[90:91], v28 offset:47360
    v_mfma_f32_16x16x32_bf16 v[80:83], a[64:67], a[52:55], v[80:83]
    buffer_load_dwordx4 a[20:23], v1, s[36:39], s65 offen offset:1024 sc1
    v_mfma_f32_16x16x32_bf16 v[68:71], a[68:71], a[48:51], v[68:71]
    ds_read_b64_tr_b16 a[92:93], v29 offset:47104
    ds_read_b64_tr_b16 a[94:95], v29 offset:47360
    v_mfma_f32_16x16x32_bf16 v[84:87], a[68:71], a[52:55], v[84:87]
    s_waitcnt vmcnt(8)
    buffer_load_dwordx4 a[24:27], v1, s[36:39], s65 offen offset:2048 sc1
    v_mfma_f32_16x16x32_bf16 v[72:75], a[72:75], a[48:51], v[72:75]
    s_barrier
    ds_read_b64_tr_b16 a[64:65], v26 offset:0
    ds_read_b64_tr_b16 a[66:67], v26 offset:256
    v_mfma_f32_16x16x32_bf16 v[88:91], a[72:75], a[52:55], v[88:91]
    s_waitcnt lgkmcnt(6)
    buffer_load_dwordx4 a[28:31], v1, s[36:39], s65 offen offset:3072 sc1
    v_mfma_f32_16x16x32_bf16 v[76:79], a[76:79], a[48:51], v[76:79]
    s_add_u32 s65, s17, s65
    ds_read_b64_tr_b16 a[68:69], v27 offset:0
    ds_read_b64_tr_b16 a[70:71], v27 offset:256
    v_mfma_f32_16x16x32_bf16 v[92:95], a[76:79], a[52:55], v[92:95]
    v_mfma_f32_16x16x32_bf16 v[64:67], a[80:83], a[56:59], v[64:67]
    ds_read_b64_tr_b16 a[72:73], v28 offset:0
    ds_read_b64_tr_b16 a[74:75], v28 offset:256
    v_mfma_f32_16x16x32_bf16 v[80:83], a[80:83], a[60:63], v[80:83]
    buffer_load_dwordx4 a[32:35], v1, s[36:39], s65 offen offset:0 sc1
    v_mfma_f32_16x16x32_bf16 v[68:71], a[84:87], a[56:59], v[68:71]
    ds_read_b64_tr_b16 a[76:77], v29 offset:0
    ds_read_b64_tr_b16 a[78:79], v29 offset:256
    v_mfma_f32_16x16x32_bf16 v[84:87], a[84:87], a[60:63], v[84:87]
    s_waitcnt lgkmcnt(6)
    v_mfma_f32_16x16x32_bf16 v[72:75], a[88:91], a[56:59], v[72:75]
    s_nop 0
    ds_read_b64_tr_b16 a[80:81], v26 offset:2048
    ds_read_b64_tr_b16 a[82:83], v26 offset:2304
    v_mfma_f32_16x16x32_bf16 v[88:91], a[88:91], a[60:63], v[88:91]
    v_mfma_f32_16x16x32_bf16 v[76:79], a[92:95], a[56:59], v[76:79]
    ds_read_b64_tr_b16 a[84:85], v27 offset:2048
    ds_read_b64_tr_b16 a[86:87], v27 offset:2304
    v_mfma_f32_16x16x32_bf16 v[92:95], a[92:95], a[60:63], v[92:95]
    v_mfma_f32_16x16x32_bf16 v[64:67], a[64:67], v[192:195], v[64:67]
    ds_read_b64_tr_b16 a[88:89], v28 offset:2048
    ds_read_b64_tr_b16 a[90:91], v28 offset:2304
    v_mfma_f32_16x16x32_bf16 v[80:83], a[64:67], v[196:199], v[80:83]
    s_waitcnt lgkmcnt(6)
    v_mfma_f32_16x16x32_bf16 v[68:71], a[68:71], v[192:195], v[68:71]
    s_nop 0
    ds_read_b64_tr_b16 a[92:93], v29 offset:2048
    ds_read_b64_tr_b16 a[94:95], v29 offset:2304
    v_mfma_f32_16x16x32_bf16 v[84:87], a[68:71], v[196:199], v[84:87]
    buffer_load_dwordx4 a[36:39], v1, s[36:39], s65 offen offset:1024 sc1
    v_mfma_f32_16x16x32_bf16 v[72:75], a[72:75], v[192:195], v[72:75]
    ds_read_b64_tr_b16 a[64:65], v26 offset:4096
    ds_read_b64_tr_b16 a[66:67], v26 offset:4352
    v_mfma_f32_16x16x32_bf16 v[88:91], a[72:75], v[196:199], v[88:91]
    v_mfma_f32_16x16x32_bf16 v[76:79], a[76:79], v[192:195], v[76:79]
    ds_read_b64_tr_b16 a[68:69], v27 offset:4096
    ds_read_b64_tr_b16 a[70:71], v27 offset:4352
    v_mfma_f32_16x16x32_bf16 v[92:95], a[76:79], v[196:199], v[92:95]
    s_waitcnt lgkmcnt(6)
    v_mfma_f32_16x16x32_bf16 v[64:67], a[80:83], v[200:203], v[64:67]
    s_nop 0
    ds_read_b64_tr_b16 a[72:73], v28 offset:4096
    ds_read_b64_tr_b16 a[74:75], v28 offset:4352
    v_mfma_f32_16x16x32_bf16 v[80:83], a[80:83], v[204:207], v[80:83]
    v_mfma_f32_16x16x32_bf16 v[68:71], a[84:87], v[200:203], v[68:71]
    ds_read_b64_tr_b16 a[76:77], v29 offset:4096
    ds_read_b64_tr_b16 a[78:79], v29 offset:4352
    v_mfma_f32_16x16x32_bf16 v[84:87], a[84:87], v[204:207], v[84:87]
    buffer_load_dwordx4 a[40:43], v1, s[36:39], s65 offen offset:2048 sc1
    v_mfma_f32_16x16x32_bf16 v[72:75], a[88:91], v[200:203], v[72:75]
    ds_read_b64_tr_b16 a[80:81], v26 offset:6144
    ds_read_b64_tr_b16 a[82:83], v26 offset:6400
    v_mfma_f32_16x16x32_bf16 v[88:91], a[88:91], v[204:207], v[88:91]
    s_waitcnt lgkmcnt(6) vmcnt(9)
    s_add_u32 s72, s78, 128
    s_atomic_add s3, s[36:37], s72
    v_mfma_f32_16x16x32_bf16 v[76:79], a[92:95], v[200:203], v[76:79]
    s_nop 0
    ds_read_b64_tr_b16 a[84:85], v27 offset:6144
    ds_read_b64_tr_b16 a[86:87], v27 offset:6400
    v_mfma_f32_16x16x32_bf16 v[92:95], a[92:95], v[204:207], v[92:95]
    buffer_load_dwordx4 a[44:47], v1, s[36:39], s65 offen offset:3072 sc1
    v_mfma_f32_16x16x32_bf16 v[64:67], a[64:67], v[208:211], v[64:67]
    s_add_u32 s65, s13, s65
    ds_read_b64_tr_b16 a[88:89], v28 offset:6144
    ds_read_b64_tr_b16 a[90:91], v28 offset:6400
    v_mfma_f32_16x16x32_bf16 v[80:83], a[64:67], v[212:215], v[80:83]
    v_mfma_f32_16x16x32_bf16 v[68:71], a[68:71], v[208:211], v[68:71]
    s_nop 0
    ds_read_b64_tr_b16 a[92:93], v29 offset:6144
    ds_read_b64_tr_b16 a[94:95], v29 offset:6400
    v_mfma_f32_16x16x32_bf16 v[84:87], a[68:71], v[212:215], v[84:87]
    s_waitcnt lgkmcnt(6)
    v_mfma_f32_16x16x32_bf16 v[72:75], a[72:75], v[208:211], v[72:75]
    s_nop 0
    ds_read_b64_tr_b16 a[64:65], v26 offset:8192
    ds_read_b64_tr_b16 a[66:67], v26 offset:8448
    v_mfma_f32_16x16x32_bf16 v[88:91], a[72:75], v[212:215], v[88:91]
    buffer_load_dwordx4 a[48:51], v1, s[36:39], s65 offen offset:0 sc1
    v_mfma_f32_16x16x32_bf16 v[76:79], a[76:79], v[208:211], v[76:79]
    ds_read_b64_tr_b16 a[68:69], v27 offset:8192
    ds_read_b64_tr_b16 a[70:71], v27 offset:8448
    v_mfma_f32_16x16x32_bf16 v[92:95], a[76:79], v[212:215], v[92:95]
    v_mfma_f32_16x16x32_bf16 v[64:67], a[80:83], v[216:219], v[64:67]
    ds_read_b64_tr_b16 a[72:73], v28 offset:8192
    ds_read_b64_tr_b16 a[74:75], v28 offset:8448
    v_mfma_f32_16x16x32_bf16 v[80:83], a[80:83], v[220:223], v[80:83]
    s_waitcnt lgkmcnt(6)
    buffer_load_dwordx4 a[52:55], v1, s[36:39], s65 offen offset:1024 sc1
    v_mfma_f32_16x16x32_bf16 v[68:71], a[84:87], v[216:219], v[68:71]
    s_nop 0
    ds_read_b64_tr_b16 a[76:77], v29 offset:8192
    ds_read_b64_tr_b16 a[78:79], v29 offset:8448
    v_mfma_f32_16x16x32_bf16 v[84:87], a[84:87], v[220:223], v[84:87]
    v_mfma_f32_16x16x32_bf16 v[72:75], a[88:91], v[216:219], v[72:75]
    ds_read_b64_tr_b16 a[80:81], v26 offset:10240
    ds_read_b64_tr_b16 a[82:83], v26 offset:10496
    v_mfma_f32_16x16x32_bf16 v[88:91], a[88:91], v[220:223], v[88:91]
    v_mfma_f32_16x16x32_bf16 v[76:79], a[92:95], v[216:219], v[76:79]
    ds_read_b64_tr_b16 a[84:85], v27 offset:10240
    ds_read_b64_tr_b16 a[86:87], v27 offset:10496
    v_mfma_f32_16x16x32_bf16 v[92:95], a[92:95], v[220:223], v[92:95]
    s_waitcnt lgkmcnt(6)
    buffer_load_dwordx4 a[56:59], v1, s[36:39], s65 offen offset:2048 sc1
    v_mfma_f32_16x16x32_bf16 v[64:67], a[64:67], v[224:227], v[64:67]
    s_nop 0
    ds_read_b64_tr_b16 a[88:89], v28 offset:10240
    ds_read_b64_tr_b16 a[90:91], v28 offset:10496
    v_mfma_f32_16x16x32_bf16 v[80:83], a[64:67], v[228:231], v[80:83]
    v_mfma_f32_16x16x32_bf16 v[68:71], a[68:71], v[224:227], v[68:71]
    ds_read_b64_tr_b16 a[92:93], v29 offset:10240
    ds_read_b64_tr_b16 a[94:95], v29 offset:10496
    v_mfma_f32_16x16x32_bf16 v[84:87], a[68:71], v[228:231], v[84:87]
    buffer_load_dwordx4 a[60:63], v1, s[36:39], s65 offen offset:3072 sc1
    v_mfma_f32_16x16x32_bf16 v[72:75], a[72:75], v[224:227], v[72:75]
    ds_read_b64_tr_b16 a[64:65], v26 offset:12288
    ds_read_b64_tr_b16 a[66:67], v26 offset:12544
    v_mfma_f32_16x16x32_bf16 v[88:91], a[72:75], v[228:231], v[88:91]
    s_waitcnt lgkmcnt(6)
    v_mfma_f32_16x16x32_bf16 v[76:79], a[76:79], v[224:227], v[76:79]
    s_nop 0
    ds_read_b64_tr_b16 a[68:69], v27 offset:12288
    ds_read_b64_tr_b16 a[70:71], v27 offset:12544
    v_mfma_f32_16x16x32_bf16 v[92:95], a[76:79], v[228:231], v[92:95]
    v_mfma_f32_16x16x32_bf16 v[64:67], a[80:83], v[232:235], v[64:67]
    ds_read_b64_tr_b16 a[72:73], v28 offset:12288
    ds_read_b64_tr_b16 a[74:75], v28 offset:12544
    v_mfma_f32_16x16x32_bf16 v[80:83], a[80:83], v[236:239], v[80:83]
    buffer_load_dwordx4 v14, s[44:47], s62 offen offset:0 lds
    v_mfma_f32_16x16x32_bf16 v[68:71], a[84:87], v[232:235], v[68:71]
    ds_read_b64_tr_b16 a[76:77], v29 offset:12288
    ds_read_b64_tr_b16 a[78:79], v29 offset:12544
    v_mfma_f32_16x16x32_bf16 v[84:87], a[84:87], v[236:239], v[84:87]
    s_waitcnt lgkmcnt(6)
    v_mfma_f32_16x16x32_bf16 v[72:75], a[88:91], v[232:235], v[72:75]
    s_nop 0
    ds_read_b64_tr_b16 a[80:81], v26 offset:14336
    ds_read_b64_tr_b16 a[82:83], v26 offset:14592
    v_mfma_f32_16x16x32_bf16 v[88:91], a[88:91], v[236:239], v[88:91]
    buffer_load_dwordx4 v15, s[44:47], s62 offen offset:1024 lds
    v_mfma_f32_16x16x32_bf16 v[76:79], a[92:95], v[232:235], v[76:79]
    ds_read_b64_tr_b16 a[84:85], v27 offset:14336
    ds_read_b64_tr_b16 a[86:87], v27 offset:14592
    v_mfma_f32_16x16x32_bf16 v[92:95], a[92:95], v[236:239], v[92:95]
    v_mfma_f32_16x16x32_bf16 v[64:67], a[64:67], v[240:243], v[64:67]
    ds_read_b64_tr_b16 a[88:89], v28 offset:14336
    ds_read_b64_tr_b16 a[90:91], v28 offset:14592
    v_mfma_f32_16x16x32_bf16 v[80:83], a[64:67], v[244:247], v[80:83]
    s_waitcnt lgkmcnt(6)
    v_mfma_f32_16x16x32_bf16 v[68:71], a[68:71], v[240:243], v[68:71]
    s_nop 0
    ds_read_b64_tr_b16 a[92:93], v29 offset:14336
    ds_read_b64_tr_b16 a[94:95], v29 offset:14592
    v_mfma_f32_16x16x32_bf16 v[84:87], a[68:71], v[244:247], v[84:87]
    buffer_load_dwordx4 v16, s[44:47], s62 offen offset:2048 lds
    v_mfma_f32_16x16x32_bf16 v[72:75], a[72:75], v[240:243], v[72:75]
    v_mfma_f32_16x16x32_bf16 v[88:91], a[72:75], v[244:247], v[88:91]
    v_mfma_f32_16x16x32_bf16 v[76:79], a[76:79], v[240:243], v[76:79]
    v_mfma_f32_16x16x32_bf16 v[92:95], a[76:79], v[244:247], v[92:95]
    s_waitcnt lgkmcnt(2)
    buffer_load_dwordx4 v17, s[44:47], s62 offen offset:3072 lds
    v_mfma_f32_16x16x32_bf16 v[64:67], a[80:83], v[248:251], v[64:67]
    v_mfma_f32_16x16x32_bf16 v[80:83], a[80:83], v[252:255], v[80:83]
    s_lshl3_add_u32 s62, s10, s84
    s_add_u32 m0, s99, 0
    v_mfma_f32_16x16x32_bf16 v[68:71], a[84:87], v[248:251], v[68:71]
    v_mfma_f32_16x16x32_bf16 v[84:87], a[84:87], v[252:255], v[84:87]
    v_mfma_f32_16x16x32_bf16 v[72:75], a[88:91], v[248:251], v[72:75]
    v_mfma_f32_16x16x32_bf16 v[88:91], a[88:91], v[252:255], v[88:91]
    s_nop 0
    ds_read_b32 v55, v30
    s_waitcnt lgkmcnt(1)
    buffer_load_dwordx4 v14, s[44:47], s62 offen offset:0 lds
    v_mfma_f32_16x16x32_bf16 v[76:79], a[92:95], v[248:251], v[76:79]
L_padB5:
    s_cbranch_execz L_padret
    v_mfma_f32_16x16x32_bf16 v[92:95], a[92:95], v[252:255], v[92:95]
    s_barrier
    v_mfma_f32_16x16x32_bf16 v[192:195], a[96:99], a[0:3], 0
    buffer_load_dwordx4 v15, s[44:47], s62 offen offset:1024 lds
    v_pk_mul_f32 v[72:73], v[64:65], v[72:73]
    v_pk_mul_f32 v[64:65], v[64:65], v[34:35] op_sel:[0,0] op_sel_hi:[1,0]
    v_pk_mul_f32 v[74:75], v[66:67], v[74:75]
    v_pk_mul_f32 v[66:67], v[66:67], v[34:35] op_sel:[0,0] op_sel_hi:[1,0]
    v_pk_mul_f32 v[76:77], v[68:69], v[76:77]
    v_pk_mul_f32 v[68:69], v[68:69], v[34:35] op_sel:[0,0] op_sel_hi:[1,0]
    v_pk_mul_f32 v[78:79], v[70:71], v[78:79]
    v_mfma_f32_16x16x32_bf16 v[196:199], a[100:103], a[0:3], 0
    buffer_load_dwordx4 v16, s[44:47], s62 offen offset:2048 lds
    v_exp_f32 v64, v64
    v_exp_f32_e64 v65, v65
    v_pk_mul_f32 v[70:71], v[70:71], v[34:35] op_sel:[0,0] op_sel_hi:[1,0]
    v_pk_fma_f32 v[64:65], v[64:65], v[36:37], v[36:37] op_sel:[0,0,0] op_sel_hi:[1,0,0]
    v_pk_mul_f32 v[88:89], v[80:81], v[88:89]
    v_pk_mul_f32 v[80:81], v[80:81], v[34:35] op_sel:[0,1] op_sel_hi:[1,1]
    v_pk_mul_f32 v[90:91], v[82:83], v[90:91]
    v_pk_mul_f32 v[82:83], v[82:83], v[34:35] op_sel:[0,1] op_sel_hi:[1,1]
    v_mfma_f32_16x16x32_bf16 v[200:203], a[104:107], a[0:3], 0
    buffer_load_dwordx4 v17, s[44:47], s62 offen offset:3072 lds
    v_exp_f32 v66, v66
    v_exp_f32 v67, v67
    v_exp_f32_e64 v68, v68
    v_pk_fma_f32 v[66:67], v[66:67], v[36:37], v[36:37] op_sel:[0,0,0] op_sel_hi:[1,0,0]
    v_exp_f32_e64 v69, v69
    v_mbcnt_lo_u32_b32 v5, -1, 0
    v_mfma_f32_16x16x32_bf16 v[204:207], a[108:111], a[0:3], 0
    s_lshl3_add_u32 s62, s12, s62
    v_rcp_f32 v64, v64
    v_rcp_f32 v65, v65
    v_exp_f32 v70, v70
    v_pk_fma_f32 v[68:69], v[68:69], v[36:37], v[36:37] op_sel:[0,0,0] op_sel_hi:[1,0,0]
    v_pk_mul_f32 v[72:73], v[64:65], v[72:73]
    v_pk_mul_f32 v[92:93], v[84:85], v[92:93]
    v_pk_mul_f32 v[84:85], v[84:85], v[34:35] op_sel:[0,1] op_sel_hi:[1,1]
    v_exp_f32_e64 v71, v71
    v_mfma_f32_16x16x32_bf16 v[208:211], a[96:99], a[4:7], 0
    s_add_u32 m0, s99, 4096
    v_rcp_f32 v66, v66
    v_rcp_f32 v67, v67
    v_exp_f32_e64 v80, v80
    v_pk_fma_f32 v[70:71], v[70:71], v[36:37], v[36:37] op_sel:[0,0,0] op_sel_hi:[1,0,0]
    v_pk_mul_f32 v[74:75], v[66:67], v[74:75]
    v_pk_mul_f32 v[94:95], v[86:87], v[94:95]
    v_pk_mul_f32 v[86:87], v[86:87], v[34:35] op_sel:[0,1] op_sel_hi:[1,1]
    v_exp_f32_e64 v81, v81
    v_mfma_f32_16x16x32_bf16 v[212:215], a[100:103], a[4:7], 0
    buffer_load_dwordx4 v14, s[44:47], s62 offen offset:0 lds
    v_rcp_f32 v68, v68
    v_rcp_f32 v69, v69
    v_pk_fma_f32 v[80:81], v[80:81], v[36:37], v[36:37] op_sel:[0,1,1] op_sel_hi:[1,1,1]
    v_pk_mul_f32 v[76:77], v[68:69], v[76:77]
    v_cvt_pk_bf16_f32 v64, v72, v73
    v_exp_f32_e64 v82, v82
    v_cvt_pk_bf16_f32 v65, v74, v75
    v_mfma_f32_16x16x32_bf16 v[216:219], a[104:107], a[4:7], 0
    buffer_load_dwordx4 v15, s[44:47], s62 offen offset:1024 lds
    v_exp_f32 v83, v83
    v_rcp_f32 v70, v70
    v_pk_fma_f32 v[82:83], v[82:83], v[36:37], v[36:37] op_sel:[0,1,1] op_sel_hi:[1,1,1]
    v_rcp_f32 v71, v71
    v_exp_f32 v84, v84
    v_pk_mul_f32 v[78:79], v[70:71], v[78:79]
    v_mfma_f32_16x16x32_bf16 v[220:223], a[108:111], a[4:7], 0
    buffer_load_dwordx4 v16, s[44:47], s62 offen offset:2048 lds
    v_exp_f32 v85, v85
    v_rcp_f32 v80, v80
    v_pk_fma_f32 v[84:85], v[84:85], v[36:37], v[36:37] op_sel:[0,1,1] op_sel_hi:[1,1,1]
    v_rcp_f32_e64 v81, v81
    v_cvt_pk_bf16_f32 v66, v76, v77
    v_pk_mul_f32 v[88:89], v[80:81], v[88:89]
    v_cvt_pk_bf16_f32 v67, v78, v79
    s_waitcnt vmcnt(23)
    v_mfma_f32_16x16x32_bf16 v[224:227], a[96:99], a[8:11], 0
    buffer_load_dword v38, off, s[36:39], s79 offset:128 sc1
    v_exp_f32 v86, v86
    v_exp_f32 v87, v87
    v_rcp_f32 v82, v82
    v_rcp_f32_e64 v83, v83
    v_mbcnt_hi_u32_b32 v5, -1, v5
    v_lshlrev_b32_e64 v5, 4, v5
    v_mfma_f32_16x16x32_bf16 v[228:231], a[100:103], a[8:11], 0
    buffer_store_dwordx4 v[64:67], v1, s[36:39], s67 offen offset:0 sc1
    v_rcp_f32 v84, v84
    v_rcp_f32 v85, v85
    v_pk_fma_f32 v[86:87], v[86:87], v[36:37], v[36:37] op_sel:[0,1,1] op_sel_hi:[1,1,1]
    v_pk_mul_f32 v[90:91], v[82:83], v[90:91]
    v_pk_mul_f32 v[92:93], v[84:85], v[92:93]
    v_cvt_pk_bf16_f32 v80, v88, v89
    v_rcp_f32_e64 v86, v86
    v_mfma_f32_16x16x32_bf16 v[232:235], a[104:107], a[8:11], 0
    buffer_load_dwordx4 v17, s[44:47], s62 offen offset:3072 lds
    v_rcp_f32_e64 v87, v87
    v_cvt_pk_bf16_f32 v81, v90, v91
    v_pk_mul_f32 v[94:95], v[86:87], v[94:95]
    v_cvt_pk_bf16_f32 v82, v92, v93
    v_cvt_pk_bf16_f32 v83, v94, v95
    v_and_b32 v41, 0x70, v5
    v_lshrrev_b32 v7, 7, v5
    v_lshlrev_b32 v8, 1, v41
    v_lshlrev_b32_e64 v6, 4, v7
    v_mfma_f32_16x16x32_bf16 v[236:239], a[108:111], a[8:11], 0
    s_lshl3_add_u32 s62, s11, s85
    buffer_store_dwordx4 v[80:83], v1, s[36:39], s67 offen offset:1024 sc1
    v_xor_b32 v8, v8, v6
    v_lshl_add_u32 v41, v7, 10, v41
    v_lshl_add_u32 v8, v7, 8, v8
    s_mul_i32 s73, s75, 2176
    v_xor_b32 v8, s73, v8
    s_lshl_b32 s73, s61, 13
    v_add_u32 v6, s73, v8
    v_xor_b32 v7, 16, v6
    v_add_u32 v8, 65536, v6
    v_add_u32 v9, 65536, v7
    v_mfma_f32_16x16x32_bf16 v[240:243], a[96:99], a[12:15], 0
    ds_read_b64_tr_b16 a[64:65], v30 offset:49152
    ds_read_b64_tr_b16 a[66:67], v30 offset:51200
    v_mfma_f32_16x16x32_bf16 v[244:247], a[100:103], a[12:15], 0
    s_add_u32 m0, s60, 16384
    ds_read_b64_tr_b16 a[68:69], v31 offset:49152
    ds_read_b64_tr_b16 a[70:71], v31 offset:51200
    v_mfma_f32_16x16x32_bf16 v[248:251], a[104:107], a[12:15], 0
    buffer_load_dwordx4 v14, s[48:51], s62 offen offset:0 lds
    v_mfma_f32_16x16x32_bf16 v[252:255], a[108:111], a[12:15], 0
    ds_read_b64_tr_b16 a[72:73], v32 offset:49152
    ds_read_b64_tr_b16 a[74:75], v32 offset:51200
    s_waitcnt vmcnt(26)
    v_mfma_f32_16x16x32_bf16 v[192:195], a[112:115], a[16:19], v[192:195]
    s_nop 0
    ds_read_b64_tr_b16 a[76:77], v33 offset:49152
    ds_read_b64_tr_b16 a[78:79], v33 offset:51200
    v_mfma_f32_16x16x32_bf16 v[196:199], a[116:119], a[16:19], v[196:199]
    s_waitcnt vmcnt(12)
    buffer_load_dwordx4 v15, s[48:51], s62 offen offset:1024 lds
    v_mfma_f32_16x16x32_bf16 v[200:203], a[120:123], a[16:19], v[200:203]
    s_nop 0
    ds_read_b64_tr_b16 a[80:81], v30 offset:57344
    ds_read_b64_tr_b16 a[82:83], v30 offset:59392
    v_mfma_f32_16x16x32_bf16 v[204:207], a[124:127], a[16:19], v[204:207]
    ds_read_b64_tr_b16 a[84:85], v31 offset:57344
    ds_read_b64_tr_b16 a[86:87], v31 offset:59392
    v_mfma_f32_16x16x32_bf16 v[208:211], a[112:115], a[20:23], v[208:211]
    ds_read_b64_tr_b16 a[88:89], v32 offset:57344
    ds_read_b64_tr_b16 a[90:91], v32 offset:59392
    v_mfma_f32_16x16x32_bf16 v[212:215], a[116:119], a[20:23], v[212:215]
    ds_read_b64_tr_b16 a[92:93], v33 offset:57344
    ds_read_b64_tr_b16 a[94:95], v33 offset:59392
    v_mfma_f32_16x16x32_bf16 v[216:219], a[120:123], a[20:23], v[216:219]
    s_waitcnt vmcnt(9)
    buffer_load_dwordx4 v16, s[48:51], s62 offen offset:2048 lds
    v_mfma_f32_16x16x32_bf16 v[220:223], a[124:127], a[20:23], v[220:223]
    s_nop 0
    ds_read_b64_tr_b16 a[96:97], v48 offset:0
    ds_read_b64_tr_b16 a[98:99], v48 offset:2048
    v_mfma_f32_16x16x32_bf16 v[224:227], a[112:115], a[24:27], v[224:227]
    ds_read_b64_tr_b16 a[100:101], v49 offset:0
    ds_read_b64_tr_b16 a[102:103], v49 offset:2048
    v_mfma_f32_16x16x32_bf16 v[228:231], a[116:119], a[24:27], v[228:231]
    ds_read_b64_tr_b16 a[104:105], v50 offset:0
    ds_read_b64_tr_b16 a[106:107], v50 offset:2048
    v_mfma_f32_16x16x32_bf16 v[232:235], a[120:123], a[24:27], v[232:235]
    buffer_load_dwordx4 v17, s[48:51], s62 offen offset:3072 lds
    v_mfma_f32_16x16x32_bf16 v[236:239], a[124:127], a[24:27], v[236:239]
    s_lshl3_add_u32 s62, s12, s62
    ds_read_b64_tr_b16 a[108:109], v51 offset:0
    ds_read_b64_tr_b16 a[110:111], v51 offset:2048
    v_mfma_f32_16x16x32_bf16 v[240:243], a[112:115], a[28:31], v[240:243]
    s_add_u32 m0, s60, 24576
    v_and_b32 v3, 0xf0, v5
    v_lshrrev_b32 v4, 4, v5
    v_mfma_f32_16x16x32_bf16 v[244:247], a[116:119], a[28:31], v[244:247]
    v_and_b32 v4, 0x30, v4
    v_xor_b32 v4, v3, v4
    v_mfma_f32_16x16x32_bf16 v[248:251], a[120:123], a[28:31], v[248:251]
    v_lshl_add_u32 v4, v3, 4, v4
    v_add_u32_e64 v2, s60, v4
    v_mfma_f32_16x16x32_bf16 v[252:255], a[124:127], a[28:31], v[252:255]
    buffer_load_dwordx4 v14, s[48:51], s62 offen offset:0 lds
    v_mfma_f32_16x16x32_bf16 v[192:195], a[128:131], a[32:35], v[192:195]
    v_xor_b32_e64 v3, 64, v2
    v_xor_b32 v4, 128, v2
    v_mfma_f32_16x16x32_bf16 v[196:199], a[132:135], a[32:35], v[196:199]
    v_xor_b32 v5, 192, v2
    v_mfma_f32_16x16x32_bf16 v[200:203], a[136:139], a[32:35], v[200:203]
    v_mfma_f32_16x16x32_bf16 v[204:207], a[140:143], a[32:35], v[204:207]
    buffer_load_dwordx4 v15, s[48:51], s62 offen offset:1024 lds
    v_mfma_f32_16x16x32_bf16 v[208:211], a[128:131], a[36:39], v[208:211]
    v_mfma_f32_16x16x32_bf16 v[212:215], a[132:135], a[36:39], v[212:215]
    v_mfma_f32_16x16x32_bf16 v[216:219], a[136:139], a[36:39], v[216:219]
    v_mfma_f32_16x16x32_bf16 v[220:223], a[140:143], a[36:39], v[220:223]
    buffer_load_dwordx4 v16, s[48:51], s62 offen offset:2048 lds
    v_mfma_f32_16x16x32_bf16 v[224:227], a[128:131], a[40:43], v[224:227]
    s_waitcnt vmcnt(10)
    v_readfirstlane_b32 s72, v38
    s_nop 0
    s_cmp_ge_u32 s72, 8
    s_cbranch_scc0 L_slow_M2B
L_back_M2B:
    v_mfma_f32_16x16x32_bf16 v[228:231], a[132:135], a[40:43], v[228:231]
    v_mfma_f32_16x16x32_bf16 v[232:235], a[136:139], a[40:43], v[232:235]
    v_mfma_f32_16x16x32_bf16 v[236:239], a[140:143], a[40:43], v[236:239]
    v_mfma_f32_16x16x32_bf16 v[240:243], a[128:131], a[44:47], v[240:243]
    v_mfma_f32_16x16x32_bf16 v[244:247], a[132:135], a[44:47], v[244:247]
    v_mfma_f32_16x16x32_bf16 v[248:251], a[136:139], a[44:47], v[248:251]
    v_mfma_f32_16x16x32_bf16 v[252:255], a[140:143], a[44:47], v[252:255]
    v_mfma_f32_16x16x32_bf16 v[192:195], a[144:147], a[48:51], v[192:195]
    buffer_load_dwordx4 v17, s[48:51], s62 offen offset:3072 lds
    v_mfma_f32_16x16x32_bf16 v[196:199], a[148:151], a[48:51], v[196:199]
    s_lshl3_add_u32 s62, s14, s62
    s_add_u32 m0, s60, 32768
    v_mfma_f32_16x16x32_bf16 v[200:203], a[152:155], a[48:51], v[200:203]
    v_mfma_f32_16x16x32_bf16 v[204:207], a[156:159], a[48:51], v[204:207]
    v_mfma_f32_16x16x32_bf16 v[208:211], a[144:147], a[52:55], v[208:211]
    v_mfma_f32_16x16x32_bf16 v[212:215], a[148:151], a[52:55], v[212:215]
    s_waitcnt vmcnt(9)
    buffer_load_dwordx4 v14, s[48:51], s62 offen offset:0 lds
    v_mfma_f32_16x16x32_bf16 v[216:219], a[152:155], a[52:55], v[216:219]
    s_nop 0
    ds_read_b64_tr_b16 a[112:113], v48 offset:4096
    ds_read_b64_tr_b16 a[114:115], v48 offset:6144
    v_mfma_f32_16x16x32_bf16 v[220:223], a[156:159], a[52:55], v[220:223]
    ds_read_b64_tr_b16 a[116:117], v49 offset:4096
    ds_read_b64_tr_b16 a[118:119], v49 offset:6144
    v_mfma_f32_16x16x32_bf16 v[224:227], a[144:147], a[56:59], v[224:227]
    ds_read_b64_tr_b16 a[120:121], v50 offset:4096
    ds_read_b64_tr_b16 a[122:123], v50 offset:6144
    v_mfma_f32_16x16x32_bf16 v[228:231], a[148:151], a[56:59], v[228:231]
    buffer_load_dwordx4 v15, s[48:51], s62 offen offset:1024 lds
    v_mfma_f32_16x16x32_bf16 v[232:235], a[152:155], a[56:59], v[232:235]
    ds_read_b64_tr_b16 a[124:125], v51 offset:4096
    ds_read_b64_tr_b16 a[126:127], v51 offset:6144
    v_mfma_f32_16x16x32_bf16 v[236:239], a[156:159], a[56:59], v[236:239]
    s_waitcnt vmcnt(10)
    s_add_u32 s72, s78, 256
    s_atomic_add s3, s[36:37], s72
    v_mfma_f32_16x16x32_bf16 v[240:243], a[144:147], a[60:63], v[240:243]
    v_mfma_f32_16x16x32_bf16 v[244:247], a[148:151], a[60:63], v[244:247]
    v_mfma_f32_16x16x32_bf16 v[248:251], a[152:155], a[60:63], v[248:251]
    buffer_load_dwordx4 v16, s[48:51], s62 offen offset:2048 lds
    v_mfma_f32_16x16x32_bf16 v[252:255], a[156:159], a[60:63], v[252:255]
    buffer_load_dwordx4 v17, s[48:51], s62 offen offset:3072 lds
    s_add_u32 s65, s9, s86
    buffer_load_dwordx4 v[128:131], v1, s[36:39], s65 offen offset:0 sc1
    s_waitcnt vmcnt(9)
    buffer_load_dwordx4 v[132:135], v1, s[36:39], s65 offen offset:1024 sc1
    ds_read_b64_tr_b16 a[128:129], v30 offset:16384
    ds_read_b64_tr_b16 a[130:131], v30 offset:18432
    ds_read_b64_tr_b16 a[132:133], v31 offset:16384
    ds_read_b64_tr_b16 a[134:135], v31 offset:18432
    ds_read_b64_tr_b16 a[136:137], v32 offset:16384
    ds_read_b64_tr_b16 a[138:139], v32 offset:18432
    ds_read_b64_tr_b16 a[140:141], v33 offset:16384
    ds_read_b64_tr_b16 a[142:143], v33 offset:18432
    buffer_load_dwordx4 v[136:139], v1, s[36:39], s65 offen offset:2048 sc1
    buffer_load_dwordx4 v[140:143], v1, s[36:39], s65 offen offset:3072 sc1
    s_lshl3_add_u32 s62, s13, s62
    s_add_u32 m0, s60, 40960
    s_nop 0
    buffer_load_dwordx4 v14, s[48:51], s62 offen offset:0 lds
    s_waitcnt vmcnt(9)
    buffer_load_dwordx4 v15, s[48:51], s62 offen offset:1024 lds
    ds_read_b64_tr_b16 a[144:145], v30 offset:24576
    ds_read_b64_tr_b16 a[146:147], v30 offset:26624
    ds_read_b64_tr_b16 a[148:149], v31 offset:24576
    ds_read_b64_tr_b16 a[150:151], v31 offset:26624
    ds_read_b64_tr_b16 a[152:153], v32 offset:24576
    ds_read_b64_tr_b16 a[154:155], v32 offset:26624
    ds_read_b64_tr_b16 a[156:157], v33 offset:24576
    ds_read_b64_tr_b16 a[158:159], v33 offset:26624
    buffer_load_dwordx4 v16, s[48:51], s62 offen offset:2048 lds
    buffer_load_dwordx4 v17, s[48:51], s62 offen offset:3072 lds
    s_add_u32 s65, s12, s65
    buffer_load_dwordx4 v[144:147], v1, s[36:39], s65 offen offset:0 sc1
    buffer_load_dwordx4 v[148:151], v1, s[36:39], s65 offen offset:1024 sc1
    buffer_load_dwordx4 v[152:155], v1, s[36:39], s65 offen offset:2048 sc1
    s_waitcnt vmcnt(9)
    v_mfma_f32_16x16x32_bf16 v[192:195], a[160:163], v[128:131], v[192:195]
    buffer_load_dwordx4 v[156:159], v1, s[36:39], s65 offen offset:3072 sc1
    v_mfma_f32_16x16x32_bf16 v[196:199], a[164:167], v[128:131], v[196:199]
    s_add_u32 s65, s14, s65
    v_mfma_f32_16x16x32_bf16 v[200:203], a[168:171], v[128:131], v[200:203]
    v_mfma_f32_16x16x32_bf16 v[204:207], a[172:175], v[128:131], v[204:207]
    v_mfma_f32_16x16x32_bf16 v[208:211], a[160:163], v[132:135], v[208:211]
    buffer_load_dwordx4 v[160:163], v1, s[36:39], s65 offen offset:0 sc1
    v_mfma_f32_16x16x32_bf16 v[212:215], a[164:167], v[132:135], v[212:215]
    v_mfma_f32_16x16x32_bf16 v[216:219], a[168:171], v[132:135], v[216:219]
    v_mfma_f32_16x16x32_bf16 v[220:223], a[172:175], v[132:135], v[220:223]
    s_waitcnt vmcnt(9)
    v_mfma_f32_16x16x32_bf16 v[224:227], a[160:163], v[136:139], v[224:227]
    buffer_load_dwordx4 v[164:167], v1, s[36:39], s65 offen offset:1024 sc1
    v_mfma_f32_16x16x32_bf16 v[228:231], a[164:167], v[136:139], v[228:231]
    v_mfma_f32_16x16x32_bf16 v[232:235], a[168:171], v[136:139], v[232:235]
    v_mfma_f32_16x16x32_bf16 v[236:239], a[172:175], v[136:139], v[236:239]
    v_mfma_f32_16x16x32_bf16 v[240:243], a[160:163], v[140:143], v[240:243]
    buffer_load_dwordx4 v[168:171], v1, s[36:39], s65 offen offset:2048 sc1
    v_mfma_f32_16x16x32_bf16 v[244:247], a[164:167], v[140:143], v[244:247]
    v_mfma_f32_16x16x32_bf16 v[248:251], a[168:171], v[140:143], v[248:251]
    v_mfma_f32_16x16x32_bf16 v[252:255], a[172:175], v[140:143], v[252:255]
    ds_read_b64_tr_b16 a[160:161], v30 offset:32768
    ds_read_b64_tr_b16 a[162:163], v30 offset:34816
    ds_read_b64_tr_b16 a[164:165], v31 offset:32768
    ds_read_b64_tr_b16 a[166:167], v31 offset:34816
    ds_read_b64_tr_b16 a[168:169], v32 offset:32768
    ds_read_b64_tr_b16 a[170:171], v32 offset:34816
    buffer_load_dwordx4 v[172:175], v1, s[36:39], s65 offen offset:3072 sc1
    ds_read_b64_tr_b16 a[172:173], v33 offset:32768
    ds_read_b64_tr_b16 a[174:175], v33 offset:34816
    s_add_u32 s65, s13, s65
    buffer_load_dwordx4 v[176:179], v1, s[36:39], s65 offen offset:0 sc1
    buffer_load_dwordx4 v[180:183], v1, s[36:39], s65 offen offset:1024 sc1
    buffer_load_dwordx4 v[184:187], v1, s[36:39], s65 offen offset:2048 sc1
    s_waitcnt vmcnt(9)
    v_mfma_f32_16x16x32_bf16 v[192:195], a[176:179], v[144:147], v[192:195]
    buffer_load_dwordx4 v[188:191], v1, s[36:39], s65 offen offset:3072 sc1
    v_mfma_f32_16x16x32_bf16 v[196:199], a[180:183], v[144:147], v[196:199]
    s_add_u32 s65, s16, s65
    v_mfma_f32_16x16x32_bf16 v[200:203], a[184:187], v[144:147], v[200:203]
    v_mfma_f32_16x16x32_bf16 v[204:207], a[188:191], v[144:147], v[204:207]
    v_mfma_f32_16x16x32_bf16 v[208:211], a[176:179], v[148:151], v[208:211]
    buffer_load_dwordx4 a[0:3], v1, s[36:39], s65 offen offset:0 sc1
    v_mfma_f32_16x16x32_bf16 v[212:215], a[180:183], v[148:151], v[212:215]
    v_mfma_f32_16x16x32_bf16 v[216:219], a[184:187], v[148:151], v[216:219]
    v_mfma_f32_16x16x32_bf16 v[220:223], a[188:191], v[148:151], v[220:223]
    s_waitcnt vmcnt(9)
    v_mfma_f32_16x16x32_bf16 v[224:227], a[176:179], v[152:155], v[224:227]
    buffer_load_dwordx4 a[4:7], v1, s[36:39], s65 offen offset:1024 sc1
    v_mfma_f32_16x16x32_bf16 v[228:231], a[180:183], v[152:155], v[228:231]
    v_mfma_f32_16x16x32_bf16 v[232:235], a[184:187], v[152:155], v[232:235]
    v_mfma_f32_16x16x32_bf16 v[236:239], a[188:191], v[152:155], v[236:239]
    v_mfma_f32_16x16x32_bf16 v[240:243], a[176:179], v[156:159], v[240:243]
    buffer_load_dwordx4 a[8:11], v1, s[36:39], s65 offen offset:2048 sc1
    v_mfma_f32_16x16x32_bf16 v[244:247], a[180:183], v[156:159], v[244:247]
    v_mfma_f32_16x16x32_bf16 v[248:251], a[184:187], v[156:159], v[248:251]
    v_mfma_f32_16x16x32_bf16 v[252:255], a[188:191], v[156:159], v[252:255]
    ds_read_b64_tr_b16 a[176:177], v30 offset:40960
    ds_read_b64_tr_b16 a[178:179], v30 offset:43008
    ds_read_b64_tr_b16 a[180:181], v31 offset:40960
    ds_read_b64_tr_b16 a[182:183], v31 offset:43008
    ds_read_b64_tr_b16 a[184:185], v32 offset:40960
    ds_read_b64_tr_b16 a[186:187], v32 offset:43008
    s_waitcnt vmcnt(9)
    v_mfma_f32_16x16x32_bf16 v[192:195], a[192:195], v[160:163], v[192:195]
    buffer_load_dwordx4 a[12:15], v1, s[36:39], s65 offen offset:3072 sc1
    v_mfma_f32_16x16x32_bf16 v[196:199], a[196:199], v[160:163], v[196:199]
    s_add_u32 s65, s12, s65
    ds_read_b64_tr_b16 a[188:189], v33 offset:40960
    ds_read_b64_tr_b16 a[190:191], v33 offset:43008
    v_mfma_f32_16x16x32_bf16 v[200:203], a[200:203], v[160:163], v[200:203]
    v_mfma_f32_16x16x32_bf16 v[204:207], a[204:207], v[160:163], v[204:207]
    v_mfma_f32_16x16x32_bf16 v[208:211], a[192:195], v[164:167], v[208:211]
    buffer_load_dwordx4 a[16:19], v1, s[36:39], s65 offen offset:0 sc1
    v_mfma_f32_16x16x32_bf16 v[212:215], a[196:199], v[164:167], v[212:215]
    v_mfma_f32_16x16x32_bf16 v[216:219], a[200:203], v[164:167], v[216:219]
    v_mfma_f32_16x16x32_bf16 v[220:223], a[204:207], v[164:167], v[220:223]
    s_waitcnt vmcnt(9)
    v_mfma_f32_16x16x32_bf16 v[224:227], a[192:195], v[168:171], v[224:227]
    buffer_load_dwordx4 a[20:23], v1, s[36:39], s65 offen offset:1024 sc1
    v_mfma_f32_16x16x32_bf16 v[228:231], a[196:199], v[168:171], v[228:231]
    v_mfma_f32_16x16x32_bf16 v[232:235], a[200:203], v[168:171], v[232:235]
    v_mfma_f32_16x16x32_bf16 v[236:239], a[204:207], v[168:171], v[236:239]
    v_mfma_f32_16x16x32_bf16 v[240:243], a[192:195], v[172:175], v[240:243]
    buffer_load_dwordx4 a[24:27], v1, s[36:39], s65 offen offset:2048 sc1
    v_mfma_f32_16x16x32_bf16 v[244:247], a[196:199], v[172:175], v[244:247]
    v_mfma_f32_16x16x32_bf16 v[248:251], a[200:203], v[172:175], v[248:251]
    v_mfma_f32_16x16x32_bf16 v[252:255], a[204:207], v[172:175], v[252:255]
    s_waitcnt vmcnt(9)
    v_mfma_f32_16x16x32_bf16 v[192:195], a[208:211], v[176:179], v[192:195]
    buffer_load_dwordx4 a[28:31], v1, s[36:39], s65 offen offset:3072 sc1
    v_mfma_f32_16x16x32_bf16 v[196:199], a[212:215], v[176:179], v[196:199]
    s_add_u32 s65, s15, s65
    v_mfma_f32_16x16x32_bf16 v[200:203], a[216:219], v[176:179], v[200:203]
    v_mfma_f32_16x16x32_bf16 v[204:207], a[220:223], v[176:179], v[204:207]
    v_mfma_f32_16x16x32_bf16 v[208:211], a[208:211], v[180:183], v[208:211]
    buffer_load_dwordx4 a[32:35], v1, s[36:39], s65 offen offset:0 sc1
    v_mfma_f32_16x16x32_bf16 v[212:215], a[212:215], v[180:183], v[212:215]
    v_mfma_f32_16x16x32_bf16 v[216:219], a[216:219], v[180:183], v[216:219]
    v_mfma_f32_16x16x32_bf16 v[220:223], a[220:223], v[180:183], v[220:223]
    s_waitcnt vmcnt(9)
    v_mfma_f32_16x16x32_bf16 v[224:227], a[208:211], v[184:187], v[224:227]
    buffer_load_dwordx4 a[36:39], v1, s[36:39], s65 offen offset:1024 sc1
    v_mfma_f32_16x16x32_bf16 v[228:231], a[212:215], v[184:187], v[228:231]
    v_mfma_f32_16x16x32_bf16 v[232:235], a[216:219], v[184:187], v[232:235]
    v_mfma_f32_16x16x32_bf16 v[236:239], a[220:223], v[184:187], v[236:239]
    v_mfma_f32_16x16x32_bf16 v[240:243], a[208:211], v[188:191], v[240:243]
    buffer_load_dwordx4 a[40:43], v1, s[36:39], s65 offen offset:2048 sc1
    v_mfma_f32_16x16x32_bf16 v[244:247], a[212:215], v[188:191], v[244:247]
    v_mfma_f32_16x16x32_bf16 v[248:251], a[216:219], v[188:191], v[248:251]
    v_mfma_f32_16x16x32_bf16 v[252:255], a[220:223], v[188:191], v[252:255]
    s_waitcnt vmcnt(9)
    v_mfma_f32_16x16x32_bf16 v[192:195], a[224:227], a[0:3], v[192:195]
    buffer_load_dwordx4 a[44:47], v1, s[36:39], s65 offen offset:3072 sc1
    v_mfma_f32_16x16x32_bf16 v[196:199], a[228:231], a[0:3], v[196:199]
    s_add_u32 s65, s13, s65
    buffer_load_dword v54, off, s[36:39], s79 offset:256 sc1
    v_mfma_f32_16x16x32_bf16 v[200:203], a[232:235], a[0:3], v[200:203]
    v_mfma_f32_16x16x32_bf16 v[204:207], a[236:239], a[0:3], v[204:207]
    v_mfma_f32_16x16x32_bf16 v[208:211], a[224:227], a[4:7], v[208:211]
    v_mfma_f32_16x16x32_bf16 v[212:215], a[228:231], a[4:7], v[212:215]
    v_mfma_f32_16x16x32_bf16 v[216:219], a[232:235], a[4:7], v[216:219]
    buffer_load_dwordx4 a[48:51], v1, s[36:39], s65 offen offset:0 sc1
    v_mfma_f32_16x16x32_bf16 v[220:223], a[236:239], a[4:7], v[220:223]
    s_waitcnt vmcnt(10)
    v_mfma_f32_16x16x32_bf16 v[224:227], a[224:227], a[8:11], v[224:227]
    v_mfma_f32_16x16x32_bf16 v[228:231], a[228:231], a[8:11], v[228:231]
    v_mfma_f32_16x16x32_bf16 v[232:235], a[232:235], a[8:11], v[232:235]
    buffer_load_dwordx4 a[52:55], v1, s[36:39], s65 offen offset:1024 sc1
    v_mfma_f32_16x16x32_bf16 v[236:239], a[236:239], a[8:11], v[236:239]
    v_mfma_f32_16x16x32_bf16 v[240:243], a[224:227], a[12:15], v[240:243]
    v_mfma_f32_16x16x32_bf16 v[244:247], a[228:231], a[12:15], v[244:247]
    v_mfma_f32_16x16x32_bf16 v[248:251], a[232:235], a[12:15], v[248:251]
    v_mfma_f32_16x16x32_bf16 v[252:255], a[236:239], a[12:15], v[252:255]
    buffer_load_dwordx4 a[56:59], v1, s[36:39], s65 offen offset:2048 sc1
    s_waitcnt vmcnt(10)
    v_mfma_f32_16x16x32_bf16 v[192:195], a[240:243], a[16:19], v[192:195]
    v_mfma_f32_16x16x32_bf16 v[196:199], a[244:247], a[16:19], v[196:199]
    v_mfma_f32_16x16x32_bf16 v[200:203], a[248:251], a[16:19], v[200:203]
    v_mfma_f32_16x16x32_bf16 v[204:207], a[252:255], a[16:19], v[204:207]
    buffer_load_dwordx4 a[60:63], v1, s[36:39], s65 offen offset:3072 sc1
    v_mfma_f32_16x16x32_bf16 v[208:211], a[240:243], a[20:23], v[208:211]
    v_mfma_f32_16x16x32_bf16 v[212:215], a[244:247], a[20:23], v[212:215]
    v_mfma_f32_16x16x32_bf16 v[216:219], a[248:251], a[20:23], v[216:219]
    v_mfma_f32_16x16x32_bf16 v[220:223], a[252:255], a[20:23], v[220:223]
    s_waitcnt vmcnt(9)
    v_mfma_f32_16x16x32_bf16 v[224:227], a[240:243], a[24:27], v[224:227]
    v_mfma_f32_16x16x32_bf16 v[228:231], a[244:247], a[24:27], v[228:231]
    v_mfma_f32_16x16x32_bf16 v[232:235], a[248:251], a[24:27], v[232:235]
    v_mfma_f32_16x16x32_bf16 v[236:239], a[252:255], a[24:27], v[236:239]
    v_mfma_f32_16x16x32_bf16 v[240:243], a[240:243], a[28:31], v[240:243]
    v_mfma_f32_16x16x32_bf16 v[244:247], a[244:247], a[28:31], v[244:247]
    v_mfma_f32_16x16x32_bf16 v[248:251], a[248:251], a[28:31], v[248:251]
    v_mfma_f32_16x16x32_bf16 v[252:255], a[252:255], a[28:31], v[252:255]
    buffer_load_dwordx4 v[80:83], v41, s[24:27], s88 offen
    buffer_load_dwordx4 v[84:87], v41, s[24:27], s89 offen
    s_waitcnt vmcnt(9) lgkmcnt(15)
    v_mfma_f32_16x16x32_bf16 v[192:195], a[64:67], a[32:35], v[192:195]
    v_mfma_f32_16x16x32_bf16 v[196:199], a[68:71], a[32:35], v[196:199]
    v_mfma_f32_16x16x32_bf16 v[200:203], a[72:75], a[32:35], v[200:203]
    v_mfma_f32_16x16x32_bf16 v[204:207], a[76:79], a[32:35], v[204:207]
    v_mfma_f32_16x16x32_bf16 v[208:211], a[64:67], a[36:39], v[208:211]
    v_mfma_f32_16x16x32_bf16 v[212:215], a[68:71], a[36:39], v[212:215]
    v_mfma_f32_16x16x32_bf16 v[216:219], a[72:75], a[36:39], v[216:219]
    v_mfma_f32_16x16x32_bf16 v[220:223], a[76:79], a[36:39], v[220:223]
    s_waitcnt vmcnt(7)
    v_mfma_f32_16x16x32_bf16 v[224:227], a[64:67], a[40:43], v[224:227]
    s_waitcnt vmcnt(6)
    v_readfirstlane_b32 s72, v54
    s_nop 0
    s_cmp_ge_u32 s72, 8
    s_cbranch_scc0 L_slow_ZB
L_back_ZB:
    v_mfma_f32_16x16x32_bf16 v[228:231], a[68:71], a[40:43], v[228:231]
    s_add_u32 s65, s10, s86
    v_mfma_f32_16x16x32_bf16 v[232:235], a[72:75], a[40:43], v[232:235]
    buffer_load_dwordx4 v[128:131], v1, s[36:39], s65 offen offset:0 sc1
    v_mfma_f32_16x16x32_bf16 v[236:239], a[76:79], a[40:43], v[236:239]
    buffer_load_dwordx4 v[132:135], v1, s[36:39], s65 offen offset:1024 sc1
    v_mfma_f32_16x16x32_bf16 v[240:243], a[64:67], a[44:47], v[240:243]
    buffer_load_dwordx4 v[136:139], v1, s[36:39], s65 offen offset:2048 sc1
    v_mfma_f32_16x16x32_bf16 v[244:247], a[68:71], a[44:47], v[244:247]
    v_mfma_f32_16x16x32_bf16 v[248:251], a[72:75], a[44:47], v[248:251]
    v_mfma_f32_16x16x32_bf16 v[252:255], a[76:79], a[44:47], v[252:255]
    s_waitcnt vmcnt(7)
    v_mfma_f32_16x16x32_bf16 v[192:195], a[80:83], a[48:51], v[192:195]
    buffer_load_dwordx4 v[140:143], v1, s[36:39], s65 offen offset:3072 sc1
    v_mfma_f32_16x16x32_bf16 v[196:199], a[84:87], a[48:51], v[196:199]
    s_add_u32 s65, s12, s65
    v_mfma_f32_16x16x32_bf16 v[200:203], a[88:91], a[48:51], v[200:203]
    v_mfma_f32_16x16x32_bf16 v[204:207], a[92:95], a[48:51], v[204:207]
    v_mfma_f32_16x16x32_bf16 v[208:211], a[80:83], a[52:55], v[208:211]
    buffer_load_dwordx4 v[144:147], v1, s[36:39], s65 offen offset:0 sc1
    v_mfma_f32_16x16x32_bf16 v[212:215], a[84:87], a[52:55], v[212:215]
    v_mfma_f32_16x16x32_bf16 v[216:219], a[88:91], a[52:55], v[216:219]
    v_mfma_f32_16x16x32_bf16 v[220:223], a[92:95], a[52:55], v[220:223]
    buffer_load_dwordx4 v[148:151], v1, s[36:39], s65 offen offset:1024 sc1
    s_waitcnt vmcnt(8)
    v_mfma_f32_16x16x32_bf16 v[224:227], a[80:83], a[56:59], v[224:227]
    v_mfma_f32_16x16x32_bf16 v[228:231], a[84:87], a[56:59], v[228:231]
    v_mfma_f32_16x16x32_bf16 v[232:235], a[88:91], a[56:59], v[232:235]
    v_mfma_f32_16x16x32_bf16 v[236:239], a[92:95], a[56:59], v[236:239]
    buffer_load_dwordx4 v[152:155], v1, s[36:39], s65 offen offset:2048 sc1
    v_mfma_f32_16x16x32_bf16 v[240:243], a[80:83], a[60:63], v[240:243]
    v_mfma_f32_16x16x32_bf16 v[244:247], a[84:87], a[60:63], v[244:247]
    v_mfma_f32_16x16x32_bf16 v[248:251], a[88:91], a[60:63], v[248:251]
    v_mfma_f32_16x16x32_bf16 v[252:255], a[92:95], a[60:63], v[252:255]
    buffer_load_dwordx4 v[156:159], v1, s[36:39], s65 offen offset:3072 sc1
    s_add_u32 s65, s11, s87
    s_add_u32 s20, s12, s65
    s_add_u32 s21, s14, s20
    s_add_u32 s22, s13, s21
    buffer_load_dwordx4 v[160:163], v1, s[36:39], s65 offen offset:0 sc1
    buffer_load_dwordx4 v[176:179], v1, s[36:39], s20 offen offset:0 sc1
    buffer_load_dwordx4 a[0:3], v1, s[36:39], s21 offen offset:0 sc1
    s_waitcnt vmcnt(9)
    v_mfma_f32_16x16x32_bf16 v[192:195], a[96:99], v[128:131], v[192:195]
    buffer_load_dwordx4 a[16:19], v1, s[36:39], s22 offen offset:0 sc1
    v_mfma_f32_16x16x32_bf16 v[196:199], a[100:103], v[128:131], v[196:199]
    v_lshlrev_b32 v64, 16, v80
    v_and_b32 v65, 0xffff0000, v80
    v_mfma_f32_16x16x32_bf16 v[200:203], a[104:107], v[128:131], v[200:203]
    v_lshlrev_b32_e64 v66, 16, v81
    v_and_b32 v67, 0xffff0000, v81
    v_mfma_f32_16x16x32_bf16 v[204:207], a[108:111], v[128:131], v[204:207]
    v_lshlrev_b32_e64 v68, 16, v82
    v_and_b32 v69, 0xffff0000, v82
    v_mfma_f32_16x16x32_bf16 v[208:211], a[96:99], v[132:135], v[208:211]
    buffer_load_dwordx4 v[164:167], v1, s[36:39], s65 offen offset:1024 sc1
    v_mfma_f32_16x16x32_bf16 v[212:215], a[100:103], v[132:135], v[212:215]
    v_lshlrev_b32_e64 v70, 16, v83
    v_and_b32 v71, 0xffff0000, v83
    v_mfma_f32_16x16x32_bf16 v[216:219], a[104:107], v[132:135], v[216:219]
    v_lshlrev_b32_e64 v72, 16, v84
    v_and_b32 v73, 0xffff0000, v84
    v_mfma_f32_16x16x32_bf16 v[220:223], a[108:111], v[132:135], v[220:223]
    v_lshlrev_b32_e64 v74, 16, v85
    v_and_b32 v75, 0xffff0000, v85
    v_lshlrev_b32_e64 v76, 16, v86
    v_and_b32 v77, 0xffff0000, v86
    v_lshlrev_b32_e64 v78, 16, v87
    v_and_b32 v79, 0xffff0000, v87
    s_waitcnt vmcnt(9)
    v_mfma_f32_16x16x32_bf16 v[224:227], a[96:99], v[136:139], v[224:227]
    buffer_load_dwordx4 v[180:183], v1, s[36:39], s20 offen offset:1024 sc1
    v_mfma_f32_16x16x32_bf16 v[228:231], a[100:103], v[136:139], v[228:231]
    v_mfma_f32_16x16x32_bf16 v[232:235], a[104:107], v[136:139], v[232:235]
    v_mfma_f32_16x16x32_bf16 v[236:239], a[108:111], v[136:139], v[236:239]
    v_mfma_f32_16x16x32_bf16 v[240:243], a[96:99], v[140:143], v[240:243]
    buffer_load_dwordx4 a[4:7], v1, s[36:39], s21 offen offset:1024 sc1
    v_mfma_f32_16x16x32_bf16 v[244:247], a[100:103], v[140:143], v[244:247]
    v_mfma_f32_16x16x32_bf16 v[248:251], a[104:107], v[140:143], v[248:251]
    v_mfma_f32_16x16x32_bf16 v[252:255], a[108:111], v[140:143], v[252:255]
    s_waitcnt vmcnt(9)
    v_mfma_f32_16x16x32_bf16 v[192:195], a[112:115], v[144:147], v[192:195]
    buffer_load_dwordx4 a[20:23], v1, s[36:39], s22 offen offset:1024 sc1
    v_mfma_f32_16x16x32_bf16 v[196:199], a[116:119], v[144:147], v[196:199]
    v_mfma_f32_16x16x32_bf16 v[200:203], a[120:123], v[144:147], v[200:203]
    v_mfma_f32_16x16x32_bf16 v[204:207], a[124:127], v[144:147], v[204:207]
    v_mfma_f32_16x16x32_bf16 v[208:211], a[112:115], v[148:151], v[208:211]
    buffer_load_dwordx4 v[168:171], v1, s[36:39], s65 offen offset:2048 sc1
    v_mfma_f32_16x16x32_bf16 v[212:215], a[116:119], v[148:151], v[212:215]
    v_mfma_f32_16x16x32_bf16 v[216:219], a[120:123], v[148:151], v[216:219]
    v_mfma_f32_16x16x32_bf16 v[220:223], a[124:127], v[148:151], v[220:223]
    s_waitcnt vmcnt(9)
    v_mfma_f32_16x16x32_bf16 v[224:227], a[112:115], v[152:155], v[224:227]
    buffer_load_dwordx4 v[184:187], v1, s[36:39], s20 offen offset:2048 sc1
    v_mfma_f32_16x16x32_bf16 v[228:231], a[116:119], v[152:155], v[228:231]
    v_mfma_f32_16x16x32_bf16 v[232:235], a[120:123], v[152:155], v[232:235]
    v_mfma_f32_16x16x32_bf16 v[236:239], a[124:127], v[152:155], v[236:239]
    v_mfma_f32_16x16x32_bf16 v[240:243], a[112:115], v[156:159], v[240:243]
    buffer_load_dwordx4 a[8:11], v1, s[36:39], s21 offen offset:2048 sc1
    v_mfma_f32_16x16x32_bf16 v[244:247], a[116:119], v[156:159], v[244:247]
    v_mfma_f32_16x16x32_bf16 v[248:251], a[120:123], v[156:159], v[248:251]
    v_mfma_f32_16x16x32_bf16 v[252:255], a[124:127], v[156:159], v[252:255]
    s_waitcnt vmcnt(10)
    v_mfma_f32_16x16x32_bf16 v[192:195], a[128:131], v[160:163], v[192:195]
    v_mfma_f32_16x16x32_bf16 v[196:199], a[132:135], v[160:163], v[196:199]
    buffer_load_dwordx4 a[24:27], v1, s[36:39], s22 offen offset:2048 sc1
    v_mfma_f32_16x16x32_bf16 v[200:203], a[136:139], v[160:163], v[200:203]
L_padB6:
    s_cbranch_execz L_padret
    v_mfma_f32_16x16x32_bf16 v[204:207], a[140:143], v[160:163], v[204:207]
    s_waitcnt vmcnt(10)
    v_mfma_f32_16x16x32_bf16 v[192:195], a[144:147], v[176:179], v[192:195]
    v_mfma_f32_16x16x32_bf16 v[196:199], a[148:151], v[176:179], v[196:199]
    buffer_load_dwordx4 v[172:175], v1, s[36:39], s65 offen offset:3072 sc1
    v_mfma_f32_16x16x32_bf16 v[200:203], a[152:155], v[176:179], v[200:203]
    v_mfma_f32_16x16x32_bf16 v[204:207], a[156:159], v[176:179], v[204:207]
    s_waitcnt vmcnt(10) lgkmcnt(8)
    v_mfma_f32_16x16x32_bf16 v[192:195], a[160:163], a[0:3], v[192:195]
    v_mfma_f32_16x16x32_bf16 v[196:199], a[164:167], a[0:3], v[196:199]
    v_mfma_f32_16x16x32_bf16 v[200:203], a[168:171], a[0:3], v[200:203]
    buffer_load_dwordx4 v[188:191], v1, s[36:39], s20 offen offset:3072 sc1
    v_mfma_f32_16x16x32_bf16 v[204:207], a[172:175], a[0:3], v[204:207]
    s_waitcnt vmcnt(10) lgkmcnt(0)
    v_mfma_f32_16x16x32_bf16 v[192:195], a[176:179], a[16:19], v[192:195]
    v_mfma_f32_16x16x32_bf16 v[196:199], a[180:183], a[16:19], v[196:199]
    v_mfma_f32_16x16x32_bf16 v[200:203], a[184:187], a[16:19], v[200:203]
    buffer_load_dwordx4 a[12:15], v1, s[36:39], s21 offen offset:3072 sc1
    v_mfma_f32_16x16x32_bf16 v[204:207], a[188:191], a[16:19], v[204:207]
    s_nop 3
    ds_write_b128 v2, v[192:195] offset:16384
    s_waitcnt vmcnt(10)
    v_mfma_f32_16x16x32_bf16 v[208:211], a[128:131], v[164:167], v[208:211]
    ds_write_b128 v3, v[196:199] offset:16384
    v_mfma_f32_16x16x32_bf16 v[212:215], a[132:135], v[164:167], v[212:215]
    ds_write_b128 v4, v[200:203] offset:16384
    v_mfma_f32_16x16x32_bf16 v[216:219], a[136:139], v[164:167], v[216:219]
    ds_write_b128 v5, v[204:207] offset:16384
    v_mfma_f32_16x16x32_bf16 v[220:223], a[140:143], v[164:167], v[220:223]
    buffer_load_dwordx4 a[28:31], v1, s[36:39], s22 offen offset:3072 sc1
    s_waitcnt vmcnt(10)
    v_mfma_f32_16x16x32_bf16 v[208:211], a[144:147], v[180:183], v[208:211]
    v_mfma_f32_16x16x32_bf16 v[212:215], a[148:151], v[180:183], v[212:215]
    v_mfma_f32_16x16x32_bf16 v[216:219], a[152:155], v[180:183], v[216:219]
    v_mfma_f32_16x16x32_bf16 v[220:223], a[156:159], v[180:183], v[220:223]
    s_waitcnt vmcnt(9)
    v_mfma_f32_16x16x32_bf16 v[208:211], a[160:163], a[4:7], v[208:211]
    v_mfma_f32_16x16x32_bf16 v[212:215], a[164:167], a[4:7], v[212:215]
    v_mfma_f32_16x16x32_bf16 v[216:219], a[168:171], a[4:7], v[216:219]
    v_mfma_f32_16x16x32_bf16 v[220:223], a[172:175], a[4:7], v[220:223]
    s_waitcnt vmcnt(8)
    v_mfma_f32_16x16x32_bf16 v[208:211], a[176:179], a[20:23], v[208:211]
    v_mfma_f32_16x16x32_bf16 v[212:215], a[180:183], a[20:23], v[212:215]
    v_mfma_f32_16x16x32_bf16 v[216:219], a[184:187], a[20:23], v[216:219]
    v_mfma_f32_16x16x32_bf16 v[220:223], a[188:191], a[20:23], v[220:223]
    s_nop 4
    ds_write_b128 v2, v[208:211] offset:24576
    s_waitcnt vmcnt(7)
    v_mfma_f32_16x16x32_bf16 v[224:227], a[128:131], v[168:171], v[224:227]
    s_nop 0
    ds_write_b128 v3, v[212:215] offset:24576
    v_mfma_f32_16x16x32_bf16 v[228:231], a[132:135], v[168:171], v[228:231]
    ds_write_b128 v4, v[216:219] offset:24576
    v_mfma_f32_16x16x32_bf16 v[232:235], a[136:139], v[168:171], v[232:235]
    ds_write_b128 v5, v[220:223] offset:24576
    v_mfma_f32_16x16x32_bf16 v[236:239], a[140:143], v[168:171], v[236:239]
    s_waitcnt vmcnt(6)
    v_mfma_f32_16x16x32_bf16 v[224:227], a[144:147], v[184:187], v[224:227]
    v_mfma_f32_16x16x32_bf16 v[228:231], a[148:151], v[184:187], v[228:231]
    v_mfma_f32_16x16x32_bf16 v[232:235], a[152:155], v[184:187], v[232:235]
    v_mfma_f32_16x16x32_bf16 v[236:239], a[156:159], v[184:187], v[236:239]
    s_waitcnt vmcnt(5)
    v_mfma_f32_16x16x32_bf16 v[224:227], a[160:163], a[8:11], v[224:227]
    s_waitcnt lgkmcnt(0)
    s_barrier
    v_mfma_f32_16x16x32_bf16 v[228:231], a[164:167], a[8:11], v[228:231]
    ds_read_b128 v[96:99], v6 offset:16384
    ds_read_b128 v[100:103], v7 offset:16384
    v_mfma_f32_16x16x32_bf16 v[232:235], a[168:171], a[8:11], v[232:235]
    ds_read_b128 v[104:107], v6 offset:20480
    ds_read_b128 v[108:111], v7 offset:20480
    v_mfma_f32_16x16x32_bf16 v[236:239], a[172:175], a[8:11], v[236:239]
    ds_read_b128 v[112:115], v8 offset:16384
    ds_read_b128 v[116:119], v9 offset:16384
    s_waitcnt vmcnt(4)
    v_mfma_f32_16x16x32_bf16 v[224:227], a[176:179], a[24:27], v[224:227]
    s_nop 0
    ds_read_b128 v[120:123], v8 offset:20480
    ds_read_b128 v[124:127], v9 offset:20480
    v_mfma_f32_16x16x32_bf16 v[228:231], a[180:183], a[24:27], v[228:231]
    v_mfma_f32_16x16x32_bf16 v[232:235], a[184:187], a[24:27], v[232:235]
    v_mfma_f32_16x16x32_bf16 v[236:239], a[188:191], a[24:27], v[236:239]
    s_nop 2
    ds_write_b128 v2, v[224:227] offset:32768
    s_waitcnt vmcnt(3)
    v_mfma_f32_16x16x32_bf16 v[240:243], a[128:131], v[172:175], v[240:243]
    s_waitcnt lgkmcnt(7)
    ds_write_b128 v3, v[228:231] offset:32768
    v_add_f32_e64 v64, v64, v96
    s_waitcnt vmcnt(2)
    v_mfma_f32_16x16x32_bf16 v[240:243], a[144:147], v[188:191], v[240:243]
    ds_write_b128 v4, v[232:235] offset:32768
    v_add_f32 v65, v65, v97
    s_waitcnt vmcnt(1)
    v_mfma_f32_16x16x32_bf16 v[240:243], a[160:163], a[12:15], v[240:243]
    ds_write_b128 v5, v[236:239] offset:32768
    v_add_f32 v66, v66, v98
    s_waitcnt vmcnt(0)
    v_mfma_f32_16x16x32_bf16 v[240:243], a[176:179], a[28:31], v[240:243]
    v_add_f32 v67, v67, v99
    v_add_f32 v68, v68, v100
    v_add_f32_e64 v69, v69, v101
    v_mfma_f32_16x16x32_bf16 v[244:247], a[132:135], v[172:175], v[244:247]
    v_add_f32 v70, v70, v102
    v_add_f32 v71, v71, v103
    v_mfma_f32_16x16x32_bf16 v[244:247], a[148:151], v[188:191], v[244:247]
    s_waitcnt lgkmcnt(8)
    v_add_f32 v64, v64, v104
    v_add_f32 v65, v65, v105
    v_add_f32 v66, v66, v106
    v_mfma_f32_16x16x32_bf16 v[244:247], a[164:167], a[12:15], v[244:247]
    ds_write_b128 v2, v[240:243] offset:40960
    v_add_f32_e64 v67, v67, v107
    v_mfma_f32_16x16x32_bf16 v[244:247], a[180:183], a[28:31], v[244:247]
    v_add_f32 v68, v68, v108
    v_add_f32 v69, v69, v109
    v_add_f32_e64 v70, v70, v110
    v_mfma_f32_16x16x32_bf16 v[248:251], a[136:139], v[172:175], v[248:251]
    v_add_f32_e64 v71, v71, v111
    v_mfma_f32_16x16x32_bf16 v[248:251], a[152:155], v[188:191], v[248:251]
    s_waitcnt lgkmcnt(7)
    v_add_f32 v64, v64, v112
    v_add_f32 v65, v65, v113
    v_add_f32 v66, v66, v114
    v_mfma_f32_16x16x32_bf16 v[248:251], a[168:171], a[12:15], v[248:251]
    ds_write_b128 v3, v[244:247] offset:40960
    v_add_f32_e64 v67, v67, v115
    v_mfma_f32_16x16x32_bf16 v[248:251], a[184:187], a[28:31], v[248:251]
    v_add_f32 v68, v68, v116
    v_add_f32 v69, v69, v117
    v_add_f32_e64 v70, v70, v118
    v_mfma_f32_16x16x32_bf16 v[252:255], a[140:143], v[172:175], v[252:255]
    v_add_f32_e64 v71, v71, v119
    v_mfma_f32_16x16x32_bf16 v[252:255], a[156:159], v[188:191], v[252:255]
    s_waitcnt lgkmcnt(6)
    v_add_f32 v64, v64, v120
    v_add_f32 v65, v65, v121
    v_add_f32 v66, v66, v122
    v_mfma_f32_16x16x32_bf16 v[252:255], a[172:175], a[12:15], v[252:255]
    ds_write_b128 v4, v[248:251] offset:40960
    v_add_f32_e64 v67, v67, v123
    v_mfma_f32_16x16x32_bf16 v[252:255], a[188:191], a[28:31], v[252:255]
    v_add_f32 v68, v68, v124
    v_add_f32 v69, v69, v125
    v_add_f32 v70, v70, v126
    s_nop 4
    ds_write_b128 v5, v[252:255] offset:40960
    v_add_f32_e64 v71, v71, v127
    v_cvt_pk_bf16_f32 v80, v64, v65
    v_cvt_pk_bf16_f32 v81, v66, v67
    v_cvt_pk_bf16_f32 v82, v68, v69
    v_cvt_pk_bf16_f32 v83, v70, v71
    buffer_store_dwordx4 v[80:83], v41, s[52:55], s88 offen sc1
    s_waitcnt lgkmcnt(0)
    s_barrier
    ds_read_b128 v[96:99], v6 offset:32768
    ds_read_b128 v[100:103], v7 offset:32768
    ds_read_b128 v[104:107], v6 offset:36864
    ds_read_b128 v[108:111], v7 offset:36864
    ds_read_b128 v[112:115], v8 offset:32768
    ds_read_b128 v[116:119], v9 offset:32768
    ds_read_b128 v[120:123], v8 offset:36864
    ds_read_b128 v[124:127], v9 offset:36864
    s_waitcnt lgkmcnt(6)
    v_pk_add_f32 v[72:73], v[72:73], v[96:97]
    v_pk_add_f32 v[74:75], v[74:75], v[98:99]
    v_pk_add_f32 v[76:77], v[76:77], v[100:101]
    v_pk_add_f32 v[78:79], v[78:79], v[102:103]
    s_waitcnt lgkmcnt(4)
    v_pk_add_f32 v[72:73], v[72:73], v[104:105]
    v_pk_add_f32 v[74:75], v[74:75], v[106:107]
    v_pk_add_f32 v[76:77], v[76:77], v[108:109]
    v_pk_add_f32 v[78:79], v[78:79], v[110:111]
    s_waitcnt lgkmcnt(2)
    v_pk_add_f32 v[72:73], v[72:73], v[112:113]
    v_pk_add_f32 v[74:75], v[74:75], v[114:115]
    v_pk_add_f32 v[76:77], v[76:77], v[116:117]
    v_pk_add_f32 v[78:79], v[78:79], v[118:119]
    s_waitcnt lgkmcnt(0)
    v_pk_add_f32 v[72:73], v[72:73], v[120:121]
    v_pk_add_f32 v[74:75], v[74:75], v[122:123]
    v_pk_add_f32 v[76:77], v[76:77], v[124:125]
    v_pk_add_f32 v[78:79], v[78:79], v[126:127]
    v_cvt_pk_bf16_f32 v84, v72, v73
    v_cvt_pk_bf16_f32 v85, v74, v75
    v_cvt_pk_bf16_f32 v86, v76, v77
    v_cvt_pk_bf16_f32 v87, v78, v79
    buffer_store_dwordx4 v[84:87], v41, s[52:55], s89 offen sc1
    s_endpgm
    .p2align 3
L_slow_initA:
    s_cmp_eq_u32 s93, 0
    s_cbranch_scc1 L_back_initA
    s_sub_u32 s93, s93, 1
    s_sleep 8
    buffer_load_dword v38, off, s[40:43], 0 offset:0 sc1
    s_waitcnt vmcnt(0)
    v_readfirstlane_b32 s72, v38
    s_nop 0
    s_cmp_ge_u32 s72, 9
    s_cbranch_scc0 L_slow_initA
    s_branch L_back_initA
L_slow_EA:
    s_cmp_eq_u32 s93, 0
    s_cbranch_scc1 L_back_EA
    s_sub_u32 s93, s93, 1
    s_add_u32 s72, s79, 0
    s_load_dword s72, s[36:37], s72 glc
    s_waitcnt lgkmcnt(0)
    s_cmp_ge_u32 s72, 4
    s_cbranch_scc1 L_back_EA
    s_sleep 2
    s_branch L_slow_EA
L_slow_M2A:
    s_cmp_eq_u32 s93, 0
    s_cbranch_scc1 L_back_M2A
    s_sub_u32 s93, s93, 1
    s_add_u32 s72, s79, 128
    s_load_dword s72, s[36:37], s72 glc
    s_waitcnt lgkmcnt(0)
    s_cmp_ge_u32 s72, 8
    s_cbranch_scc1 L_back_M2A
    s_sleep 2
    s_branch L_slow_M2A
L_slow_kv:
    s_cmp_eq_u32 s93, 0
    s_cbranch_scc1 L_back_kv
    s_sub_u32 s93, s93, 1
    s_add_u32 s72, s77, 0
    s_load_dword s72, s[36:37], s72 glc
    s_waitcnt lgkmcnt(0)
    s_cmp_ge_u32 s72, 16
    s_cbranch_scc1 L_back_kv
    s_sleep 2
    s_branch L_slow_kv
L_slow_ZA:
    s_cmp_eq_u32 s93, 0
    s_cbranch_scc1 L_back_ZA
    s_sub_u32 s93, s93, 1
    s_add_u32 s72, s79, 256
    s_load_dword s72, s[36:37], s72 glc
    s_waitcnt lgkmcnt(0)
    s_cmp_ge_u32 s72, 8
    s_cbranch_scc1 L_back_ZA
    s_sleep 2
    s_branch L_slow_ZA
L_slow_initB:
    s_cmp_eq_u32 s93, 0
    s_cbranch_scc1 L_back_initB
    s_sub_u32 s93, s93, 1
    s_sleep 8
    buffer_load_dword v38, off, s[40:43], 0 offset:0 sc1
    s_waitcnt vmcnt(0)
    v_readfirstlane_b32 s72, v38
    s_nop 0
    s_cmp_ge_u32 s72, 9
    s_cbranch_scc0 L_slow_initB
    s_branch L_back_initB
L_slow_EB:
    s_cmp_eq_u32 s93, 0
    s_cbranch_scc1 L_back_EB
    s_sub_u32 s93, s93, 1
    s_add_u32 s72, s79, 0
    s_load_dword s72, s[36:37], s72 glc
    s_waitcnt lgkmcnt(0)
    s_cmp_ge_u32 s72, 4
    s_cbranch_scc1 L_back_EB
    s_sleep 2
    s_branch L_slow_EB
L_slow_M2B:
    s_cmp_eq_u32 s93, 0
    s_cbranch_scc1 L_back_M2B
    s_sub_u32 s93, s93, 1
    s_add_u32 s72, s79, 128
    s_load_dword s72, s[36:37], s72 glc
    s_waitcnt lgkmcnt(0)
    s_cmp_ge_u32 s72, 8
    s_cbranch_scc1 L_back_M2B
    s_sleep 2
    s_branch L_slow_M2B
L_slow_ZB:
    s_cmp_eq_u32 s93, 0
    s_cbranch_scc1 L_back_ZB
    s_sub_u32 s93, s93, 1
    s_add_u32 s72, s79, 256
    s_load_dword s72, s[36:37], s72 glc
    s_waitcnt lgkmcnt(0)
    s_cmp_ge_u32 s72, 8
    s_cbranch_scc1 L_back_ZB
    s_sleep 2
    s_branch L_slow_ZB
L_end:
    s_endpgm
.section .rodata,"a"
.p2align 6
.amdhsa_kernel parallel_sum__linear_attn_block__swiglu_ffn__prompt_kernel
  .amdhsa_next_free_vgpr 512
  .amdhsa_next_free_sgpr 102
  .amdhsa_accum_offset 256
  .amdhsa_group_segment_fixed_size 0
  .amdhsa_kernarg_size 80
  .amdhsa_user_sgpr_count 2
  .amdhsa_user_sgpr_kernarg_segment_ptr 1
  .amdhsa_system_sgpr_workgroup_id_x 1
.end_amdhsa_kernel
```
